```python
import torch

def _softmax(x, axis=-1):
    return torch.softmax(x, dim=axis)
def _gelu(x):
    return torch.nn.functional.gelu(x, approximate="tanh")
def _silu(x):
    return torch.nn.functional.silu(x)
def _sigmoid(x):
    return torch.sigmoid(x)
def _layernorm(x, axis=-1, eps=1e-5):
    m = x.mean(dim=axis, keepdim=True)
    v = x.var(dim=axis, keepdim=True, unbiased=False)
    return (x - m) / torch.sqrt(v + eps)
def _scatter_add(tgt, idx, src, axis=0):
    return tgt.clone().index_add_(axis, idx, src)
def _segment_sum(src, seg, n):
    out = torch.zeros((n,) + src.shape[1:], dtype=src.dtype)
    return out.index_add_(0, seg, src)
def _pad(x, pw):
    flat = tuple(v for pair in reversed(pw) for v in pair)
    return torch.nn.functional.pad(x, flat)

kernel_name = 'recurrent_scan__ssm_conv_s5__glu_gated_swiglu__prompt'

def setup_inputs():

    _w = (lambda a: (lambda t: t.to(torch.bfloat16) if t.is_floating_point() else t)(torch.as_tensor(a)))
    def _A_setup():
        B, S, D = 1, 2048, 640
        P = D
        Lambda_re = -0.5 * (lambda _x: torch.exp(torch.as_tensor(_x)))((lambda *s: torch.randn(*s, dtype=torch.bfloat16) * 0.8)(P))
        Lambda_im = (lambda *s: torch.randn(*s, dtype=torch.bfloat16) * 0.8)(P) * 1.0
        B_re = (lambda *s: torch.randn(*s, dtype=torch.bfloat16) * 0.8)(P, D) * (D ** -0.5)
        B_im = (lambda *s: torch.randn(*s, dtype=torch.bfloat16) * 0.8)(P, D) * (D ** -0.5)
        C_re = (lambda *s: torch.randn(*s, dtype=torch.bfloat16) * 0.8)(D, P) * (P ** -0.5)
        C_im = (lambda *s: torch.randn(*s, dtype=torch.bfloat16) * 0.8)(D, P) * (P ** -0.5)
        log_dt = (lambda *s: torch.randn(*s, dtype=torch.bfloat16) * 0.8)(P) * 0.3 - 2.0
        Dskip = (lambda *s: torch.randn(*s, dtype=torch.bfloat16) * 0.8)(D)
        return {
            "x": _w((lambda *s: torch.randn(*s, dtype=torch.bfloat16) * 0.05)(B, S, D)),
            "Lambda_re": _w(Lambda_re),
            "Lambda_im": _w(Lambda_im),
            "B_re": _w(B_re),
            "B_im": _w(B_im),
            "C_re": _w(C_re),
            "C_im": _w(C_im),
            "log_dt": _w(log_dt),
            "Dskip": _w(Dskip),
        }
    _A_in = _A_setup()

    def _B_setup():
        B, S, D, F = 1, 2048, 640, 1536
        return {
            "x": _w((lambda *s: torch.randn(*s, dtype=torch.bfloat16) * 0.05)(B, S, D)),
            "w1": _w((lambda *s: torch.randn(*s, dtype=torch.bfloat16) * 0.2)(D, F) * (2.0 / D) ** 0.5),
            "w3": _w((lambda *s: torch.randn(*s, dtype=torch.bfloat16) * 0.2)(D, F) * (2.0 / D) ** 0.5),
            "w2": _w((lambda *s: torch.randn(*s, dtype=torch.bfloat16) * 0.2)(F, D) * (2.0 / F) ** 0.5),
        }
    _B_in = _B_setup()

    return {
        "A_x": _A_in["x"],
        "A_Lambda_re": _A_in["Lambda_re"],
        "A_Lambda_im": _A_in["Lambda_im"],
        "A_B_re": _A_in["B_re"],
        "A_B_im": _A_in["B_im"],
        "A_C_re": _A_in["C_re"],
        "A_C_im": _A_in["C_im"],
        "A_log_dt": _A_in["log_dt"],
        "A_Dskip": _A_in["Dskip"],
        "B_x": _B_in["x"],
        "B_w1": _B_in["w1"],
        "B_w3": _B_in["w3"],
        "B_w2": _B_in["w2"],
    }

def reference(A_x, A_Lambda_re, A_Lambda_im, A_B_re, A_B_im, A_C_re, A_C_im, A_log_dt, A_Dskip, B_x, B_w1, B_w3, B_w2):
    def _A_ref(x, Lambda_re, Lambda_im, B_re, B_im, C_re, C_im, log_dt, Dskip):
        Bsz, L, H = x.shape
        Lam = Lambda_re + 1j * Lambda_im
        Bmat = B_re + 1j * B_im
        Cmat = C_re + 1j * C_im
        dt = torch.exp(log_dt)
        Lam_bar = torch.exp(dt * Lam)
        B_bar = ((Lam_bar - 1.0) / Lam)[:, None] * Bmat
        Bu = torch.einsum("bld,pd->blp", x + 0j, B_bar)
        h = torch.zeros_like(Bu[:, 0, :])
        hs = []
        for t in range(L):
            h = Lam_bar[None, :] * h + Bu[:, t, :]
            hs.append(h)
        hseq = torch.stack(hs, 1)
        y = 2.0 * torch.einsum("blp,dp->bld", hseq, Cmat).real + x * Dskip[None, None, :]
        return y

    def _B_ref(x, w1, w3, w2):
        gate = torch.einsum("bsd,df->bsf", x, w1)
        up = torch.einsum("bsd,df->bsf", x, w3)
        h = _silu(gate) * up
        out = torch.einsum("bsf,fd->bsd", h, w2)
        return out

    x = A_x
    xn = _layernorm(x, axis=-1)
    s = _A_ref(xn, A_Lambda_re, A_Lambda_im, A_B_re, A_B_im, A_C_re, A_C_im, A_log_dt, A_Dskip)
    g = _silu(_B_ref(xn, B_w1, B_w3, B_w2))
    return x + s * g
```

```asm
; @launch grid=(256,1,1) block=(256,1,1) lds=161792
.amdgcn_target "amdgcn-amd-amdhsa--gfx950"
.text
.globl recurrent_scan__ssm_conv_s5__glu_gated_swiglu__prompt_kernel
.p2align 8
.type recurrent_scan__ssm_conv_s5__glu_gated_swiglu__prompt_kernel,@function
recurrent_scan__ssm_conv_s5__glu_gated_swiglu__prompt_kernel:
    s_cmp_ge_u32 s2, 256
    s_cbranch_scc1 K1_done
    s_load_dwordx2 s[20:21], s[0:1], 0
    s_getpc_b64 s[12:13]
K1_pc:
    s_lshr_b32 s16, s2, 3
    s_lshl_b32 s16, s16, 11
    v_lshlrev_b32 v2, 3, v0
    v_and_b32 v2, 0xffffff80, v2
    v_add_u32 v2, s16, v2
    v_min_u32 v2, CODE_END-K1_pc, v2
    v_mov_b32 v255, s13
    v_add_co_u32 v254, vcc, s12, v2
    s_nop 1
    v_addc_co_u32 v255, vcc, 0, v255, vcc
    global_load_dword v3, v[254:255], off
    s_load_dwordx2 s[4:5], s[0:1], 120
    s_load_dwordx2 s[24:25], s[0:1], 96
    s_load_dwordx4 s[68:71], s[0:1], 40
    s_load_dwordx4 s[48:51], s[0:1], 24
    s_load_dwordx4 s[52:55], s[0:1], 80
    s_load_dwordx4 s[56:59], s[0:1], 8
    s_load_dwordx2 s[60:61], s[0:1], 56
    v_lshrrev_b32 v1, 6, v0
    s_and_b32 s37, s2, 7
    s_lshr_b32 s38, s2, 3
    v_readfirstlane_b32 s3, v1
    s_and_b32 s28, s37, 1
    s_lshl_b32 s28, s28, 3
    s_lshr_b32 s29, s38, 2
    s_add_u32 s28, s28, s29
    s_lshr_b32 s29, s37, 1
    s_lshl_b32 s29, s29, 2
    s_and_b32 s38, s38, 3
    s_add_u32 s29, s29, s38
    s_lshr_b32 s30, s29, 1
    v_and_b32 v1, 63, v0
    v_lshlrev_b32 v2, 4, v1
    s_lshl_b32 s72, s28, 2
    s_lshr_b32 s73, s29, 2
    s_add_u32 s72, s72, s73
    s_and_b32 s73, s29, 3
    v_and_b32 v190, 7, v1
    v_lshrrev_b32 v191, 3, v1
    v_lshrrev_b32 v114, 2, v190
    v_lshlrev_b32 v114, 4, v114
    v_and_b32 v102, 3, v190
    v_add_u32 v114, v114, v102
    s_lshl_b32 s74, s72, 5
    s_lshl_b32 s75, s73, 2
    s_add_u32 s74, s74, s75
    s_mul_i32 s74, s74, 1280
    s_lshl_b32 s75, s3, 7
    s_add_u32 s74, s74, s75
    v_mul_u32_u24 v114, 1280, v114
    v_lshlrev_b32 v102, 4, v191
    v_add3_u32 v114, v114, v102, s74
    s_cmp_lt_u32 s3, 2
    s_cselect_b32 s75, 0, 0x80000000
    s_add_u32 s74, s75, 1024
    v_add_u32 v115, s74, v114
    v_mov_b32 v102, 0x11f2000
    s_waitcnt lgkmcnt(0)
    s_mov_b32 s22, 2621440
    s_mov_b32 s23, 0x20000
    s_mov_b32 s8, s4
    s_mov_b32 s9, s5
    s_mov_b32 s10, 0x11f2080
    s_mov_b32 s11, 0x20000
    buffer_load_dwordx4 v[64:67], v114, s[20:23], 0 offen
    buffer_load_dwordx4 v[68:71], v114, s[20:23], 0 offen offset:512
    buffer_load_dwordx4 v[72:75], v115, s[20:23], 0 offen
    buffer_load_dword v119, v102, s[8:11], 0 offen sc1
    s_mul_i32 s41, s30, 5
    s_and_b32 s74, s29, 1
    s_add_u32 s41, s41, s74
    s_lshl_b32 s74, s41, 5
    v_lshlrev_b32 v127, 1, v1
    v_add_u32 v127, s74, v127
    s_mov_b32 s18, 1280
    s_mov_b32 s19, 0x20000
    s_mov_b32 s16, s56
    s_mov_b32 s17, s57
    buffer_load_ushort v124, v127, s[16:19], 0 offen
    s_mov_b32 s16, s58
    s_mov_b32 s17, s59
    buffer_load_ushort v125, v127, s[16:19], 0 offen
    s_mov_b32 s16, s60
    s_mov_b32 s17, s61
    buffer_load_ushort v126, v127, s[16:19], 0 offen
    s_mul_i32 s74, s72, 40960
    s_lshl_b32 s72, s3, 12
    s_add_u32 s74, s74, s72
    s_lshl_b32 s72, s73, 7
    s_add_u32 s74, s74, s72
    v_lshlrev_b32 v116, 9, v191
    v_lshlrev_b32 v102, 4, v190
    v_add3_u32 v116, v116, v102, s74
    v_add_u32 v117, 16384, v116
    s_add_u32 s74, s75, 32768
    v_add_u32 v118, s74, v116
    v_lshlrev_b32 v103, 5, v190
    v_add_u32 v103, 143360, v103
    s_lshl_b32 s72, s3, 3
    v_add_u32 v104, s72, v103
    s_and_b32 s72, s3, 1
    s_lshr_b32 s73, s3, 1
    s_cmp_eq_u32 s72, 0
    s_cselect_b32 s12, s52, s54
    s_cselect_b32 s13, s53, s55
    s_cselect_b32 s16, s48, s50
    s_cselect_b32 s17, s49, s51
    s_mov_b32 s15, 0x20000
    s_mov_b32 s18, 819200
    s_mov_b32 s19, 0x20000
    s_mov_b32 s14, 1966080
    s_mul_i32 s41, s30, 5
    s_and_b32 s74, s29, 1
    s_add_u32 s41, s41, s74
    s_mul_i32 s34, s41, 20480
    s_and_b32 s62, s29, 3
    s_mul_i32 s62, s62, 0
    s_and_b32 s75, s28, 7
    s_add_u32 s62, s62, s75
    s_cmp_ge_u32 s62, 10
    s_cselect_b32 s75, 10, 0
    s_sub_u32 s62, s62, s75
    s_mov_b32 s63, s62
    s_mul_i32 s76, s30, 384
    s_lshl_b32 s77, s72, 2
    s_cmp_eq_u32 s74, 0
    s_cselect_b32 s12, s12, s16
    s_cselect_b32 s13, s13, s17
    s_cselect_b32 s14, s14, s18
    s_cselect_b32 s76, s76, s34
    s_cselect_b32 s77, 0, s77
    s_cselect_b32 s78, 1, 3
    s_cselect_b32 s79, 2, 0
    s_cselect_b32 s75, 0, 0x80000000
    s_cselect_b32 s37, 3072, 0
    s_cselect_b32 s38, 0, 1280
    s_add_u32 s37, s37, s38
    v_lshrrev_b32 v197, 1, v191
    v_and_b32 v198, s78, v197
    v_lshlrev_b32 v198, s79, v198
    v_add_u32 v198, s77, v198
    v_xor_b32 v198, v198, v190
    v_lshlrev_b32 v198, 4, v198
    s_lshl_b32 s78, s73, 5
    v_add_u32 v199, s78, v191
    v_mul_u32_u24 v199, s37, v199
    v_add_u32 v192, v198, v199
    s_lshl_b32 s78, s37, 3
    s_sub_u32 s78, s78, 1024
    v_add_u32 v193, s78, v192
    v_add_u32 v194, s78, v193
    v_add_u32 v195, s78, v194
    s_lshl_b32 s78, s72, 2
    v_add_u32 v197, s78, v197
    v_xor_b32 v197, v197, v190
    v_lshlrev_b32 v197, 4, v197
    s_lshl_b32 s78, s73, 3
    v_add_u32 v199, s78, v191
    v_mul_u32_u24 v199, 1280, v199
    v_add3_u32 v196, v197, v199, s75
    s_cmp_eq_u32 s74, 0
    s_cselect_b32 s75, 0, 1
    s_mul_i32 s75, s75, -196480
    s_add_u32 s75, s75, 196608
    s_lshl_b32 s35, s72, 13
    s_lshl_b32 s78, s73, 12
    s_add_u32 s35, s35, s78
    s_lshl_b32 s77, s72, 11
    s_lshl_b32 s78, s73, 10
    s_add_u32 s77, s77, s78
    s_add_u32 s77, s77, 16384
    s_add_u32 m0, s35, 0
    s_mul_i32 s45, s62, s75
    s_add_u32 s45, s45, s76
    buffer_load_dwordx4 v192, s[12:15], s45 offen offset:0  lds
    buffer_load_dwordx4 v193, s[12:15], s45 offen offset:1024  lds
    buffer_load_dwordx4 v194, s[12:15], s45 offen offset:2048  lds
    buffer_load_dwordx4 v195, s[12:15], s45 offen offset:3072  lds
    s_add_u32 m0, s77, 0
    s_lshl_b32 s45, s62, 7
    s_add_u32 s45, s45, s34
    buffer_load_dwordx4 v196, s[16:19], s45 offen  lds
    s_mov_b32 s72, 0x3f803f80
    v_mov_b32 v100, 0
    v_mov_b32 v101, 0
    v_mov_b32 v102, 0
    v_mov_b32 v105, 0
    s_waitcnt vmcnt(11)
    v_dot2_f32_bf16 v102, v64, s72, v102
    v_dot2_f32_bf16 v105, v64, v64, v105
    v_dot2_f32_bf16 v100, v65, s72, v100
    v_dot2_f32_bf16 v101, v65, v65, v101
    v_dot2_f32_bf16 v102, v66, s72, v102
    v_dot2_f32_bf16 v105, v66, v66, v105
    v_dot2_f32_bf16 v100, v67, s72, v100
    v_dot2_f32_bf16 v101, v67, v67, v101
    s_waitcnt vmcnt(10)
    v_dot2_f32_bf16 v102, v68, s72, v102
    v_dot2_f32_bf16 v105, v68, v68, v105
    v_dot2_f32_bf16 v100, v69, s72, v100
    v_dot2_f32_bf16 v101, v69, v69, v101
    v_dot2_f32_bf16 v102, v70, s72, v102
    v_dot2_f32_bf16 v105, v70, v70, v105
    v_dot2_f32_bf16 v100, v71, s72, v100
    v_dot2_f32_bf16 v101, v71, v71, v101
    s_waitcnt vmcnt(9)
    v_dot2_f32_bf16 v102, v72, s72, v102
    v_dot2_f32_bf16 v105, v72, v72, v105
    v_dot2_f32_bf16 v100, v73, s72, v100
    v_dot2_f32_bf16 v101, v73, v73, v101
    v_dot2_f32_bf16 v102, v74, s72, v102
    v_dot2_f32_bf16 v105, v74, v74, v105
    v_dot2_f32_bf16 v100, v75, s72, v100
    v_dot2_f32_bf16 v101, v75, v75, v101
    s_nop 1
    v_add_f32 v100, v100, v102
    v_add_f32 v101, v101, v105
    s_nop 0
    v_add_f32_dpp v100, v100, v100 row_ror:8 row_mask:0xf bank_mask:0xf
    v_add_f32_dpp v101, v101, v101 row_ror:8 row_mask:0xf bank_mask:0xf
    v_mov_b32 v102, v100
    v_mov_b32 v105, v101
    s_nop 0
    v_permlane16_swap_b32 v100, v102
    v_permlane16_swap_b32 v101, v105
    v_add_f32 v100, v100, v102
    v_add_f32 v101, v101, v105
    v_mov_b32 v102, v100
    v_mov_b32 v105, v101
    s_nop 0
    v_permlane32_swap_b32 v100, v102
    v_permlane32_swap_b32 v101, v105
    v_add_f32 v100, v100, v102
    v_add_f32 v101, v101, v105
    ds_write_b64 v104, v[100:101]
    v_lshlrev_b32 v76, 16, v64
    v_and_b32 v77, 0xffff0000, v64
    v_lshlrev_b32 v78, 16, v65
    v_and_b32 v79, 0xffff0000, v65
    v_lshlrev_b32 v80, 16, v66
    v_and_b32 v81, 0xffff0000, v66
    v_lshlrev_b32 v82, 16, v67
    v_and_b32 v83, 0xffff0000, v67
    v_lshlrev_b32 v84, 16, v68
    v_and_b32 v85, 0xffff0000, v68
    v_lshlrev_b32 v86, 16, v69
    v_and_b32 v87, 0xffff0000, v69
    v_lshlrev_b32 v88, 16, v70
    v_and_b32 v89, 0xffff0000, v70
    v_lshlrev_b32 v90, 16, v71
    v_and_b32 v91, 0xffff0000, v71
    v_lshlrev_b32 v92, 16, v72
    v_and_b32 v93, 0xffff0000, v72
    v_lshlrev_b32 v94, 16, v73
    v_and_b32 v95, 0xffff0000, v73
    v_lshlrev_b32 v96, 16, v74
    v_and_b32 v97, 0xffff0000, v74
    v_lshlrev_b32 v98, 16, v75
    v_and_b32 v99, 0xffff0000, v75
    s_waitcnt vmcnt(8)
    v_readfirstlane_b32 s43, v119
    s_add_u32 s43, s43, 0x9e3779b1
    s_cmp_eq_u32 s43, 0
    s_cselect_b32 s43, 1, s43
    s_waitcnt lgkmcnt(0)
    s_barrier
    ds_read_b128 v[106:109], v103
    ds_read_b128 v[110:113], v103 offset:16
    s_waitcnt lgkmcnt(1)
    v_pk_add_f32 v[106:107], v[106:107], v[108:109]
    s_waitcnt lgkmcnt(0)
    v_pk_add_f32 v[110:111], v[110:111], v[112:113]
    v_pk_add_f32 v[106:107], v[106:107], v[110:111]
    v_mul_f32 v106, 0x3acccccd, v106
    v_mul_f32 v107, 0x3acccccd, v107
    v_fma_f32 v107, -v106, v106, v107
    v_max_f32 v107, 0, v107
    v_cvt_pk_bf16_f32 v108, v106, v107
    v_and_b32 v107, 0xffff0000, v108
    v_lshlrev_b32 v106, 16, v108
    v_add_f32 v107, 0x3727c5ac, v107
    v_cvt_pk_bf16_f32 v107, v107, v107
    v_lshlrev_b32 v107, 16, v107
    v_sqrt_f32 v107, v107
    s_nop 0
    v_cvt_pk_bf16_f32 v107, v107, v107
    v_lshlrev_b32 v107, 16, v107
    v_rcp_f32 v108, v107
    v_sub_f32 v106, 0, v106
    v_mov_b32 v107, v106
    v_mov_b32 v109, v108
    v_pk_add_f32 v[76:77], v[76:77], v[106:107]
    v_pk_add_f32 v[78:79], v[78:79], v[106:107]
    v_pk_add_f32 v[80:81], v[80:81], v[106:107]
    v_pk_add_f32 v[82:83], v[82:83], v[106:107]
    v_pk_mul_f32 v[76:77], v[76:77], v[108:109]
    v_pk_mul_f32 v[78:79], v[78:79], v[108:109]
    v_pk_mul_f32 v[80:81], v[80:81], v[108:109]
    v_pk_mul_f32 v[82:83], v[82:83], v[108:109]
    v_cvt_pk_bf16_f32 v64, v76, v77
    v_cvt_pk_bf16_f32 v65, v78, v79
    v_cvt_pk_bf16_f32 v66, v80, v81
    v_cvt_pk_bf16_f32 v67, v82, v83
    buffer_store_dwordx4 v[64:67], v116, s[8:11], 0 offen sc1
    v_pk_add_f32 v[84:85], v[84:85], v[106:107]
    v_pk_add_f32 v[86:87], v[86:87], v[106:107]
    v_pk_add_f32 v[88:89], v[88:89], v[106:107]
    v_pk_add_f32 v[90:91], v[90:91], v[106:107]
    v_pk_mul_f32 v[84:85], v[84:85], v[108:109]
    v_pk_mul_f32 v[86:87], v[86:87], v[108:109]
    v_pk_mul_f32 v[88:89], v[88:89], v[108:109]
    v_pk_mul_f32 v[90:91], v[90:91], v[108:109]
    v_cvt_pk_bf16_f32 v68, v84, v85
    v_cvt_pk_bf16_f32 v69, v86, v87
    v_cvt_pk_bf16_f32 v70, v88, v89
    v_cvt_pk_bf16_f32 v71, v90, v91
    buffer_store_dwordx4 v[68:71], v117, s[8:11], 0 offen sc1
    v_pk_add_f32 v[92:93], v[92:93], v[106:107]
    v_pk_add_f32 v[94:95], v[94:95], v[106:107]
    v_pk_add_f32 v[96:97], v[96:97], v[106:107]
    v_pk_add_f32 v[98:99], v[98:99], v[106:107]
    v_pk_mul_f32 v[92:93], v[92:93], v[108:109]
    v_pk_mul_f32 v[94:95], v[94:95], v[108:109]
    v_pk_mul_f32 v[96:97], v[96:97], v[108:109]
    v_pk_mul_f32 v[98:99], v[98:99], v[108:109]
    v_cvt_pk_bf16_f32 v72, v92, v93
    v_cvt_pk_bf16_f32 v73, v94, v95
    v_cvt_pk_bf16_f32 v74, v96, v97
    v_cvt_pk_bf16_f32 v75, v98, v99
    buffer_store_dwordx4 v[72:75], v118, s[8:11], 0 offen sc1
    s_lshl_b32 s6, s28, 2
    s_lshr_b32 s7, s29, 2
    s_add_u32 s7, s7, s6
    s_lshl_b32 s7, s7, 10
    s_and_b32 s37, s29, 3
    s_lshl_b32 s37, s37, 4
    s_add_u32 s7, s7, s37
    s_lshl_b32 s37, s3, 2
    s_add_u32 s7, s7, s37
    s_add_u32 s7, s7, 0x11e0000
    v_lshrrev_b32 v106, 4, v1
    v_min_u32 v106, 1, v106
    v_lshlrev_b32 v106, 31, v106
    v_lshlrev_b32 v107, 6, v1
    v_or_b32 v106, v106, v107
    v_mov_b32 v107, s43
    s_add_u32 s6, s6, s3
    s_lshl_b32 s6, s6, 4
    s_add_u32 s6, s6, s29
    s_lshl_b32 s6, s6, 6
    s_add_u32 s6, s6, 0x11e0000
    v_and_b32 v108, 15, v1
    v_lshlrev_b32 v108, 2, v108
    s_bitcmp1_b32 s29, 0
    s_cbranch_scc1 K1Q_start
K1P_start:
    v_lshrrev_b32 v208, 3, v1
    v_and_b32 v209, 7, v1
    v_lshrrev_b32 v210, 1, v208
    v_and_b32 v211, 1, v210
    v_lshlrev_b32 v211, 2, v211
    v_xor_b32 v211, v211, v209
    v_lshlrev_b32 v211, 4, v211
    v_mul_u32_u24 v212, 3072, v208
    v_add_u32 v211, v211, v212
    s_lshr_b32 s37, s3, 1
    s_mul_i32 s38, s37, 98304
    v_add_u32 v4, s38, v211
    v_add_u32 v5, 23552, v4
    v_add_u32 v6, 47104, v4
    v_add_u32 v7, 70656, v4
    s_and_b32 s45, s3, 1
    s_lshl_b32 s38, s45, 2
    v_add_u32 v210, s38, v210
    v_xor_b32 v210, v210, v209
    v_lshlrev_b32 v210, 4, v210
    v_mul_u32_u24 v212, 1280, v208
    v_add_u32 v210, v210, v212
    s_mul_i32 s38, s37, 10240
    v_add_u32 v8, s38, v210
    s_lshl_b32 s35, s45, 13
    s_lshl_b32 s38, s37, 12
    s_add_u32 s35, s35, s38
    s_lshl_b32 s36, s45, 11
    s_lshl_b32 s38, s37, 10
    s_add_u32 s36, s36, s38
    s_add_u32 s36, s36, 16384
    s_mul_i32 s32, s30, 384
    s_add_u32 s33, s32, 128
    s_mul_i32 s41, s30, 5
    s_mul_i32 s34, s41, 20480
    s_lshl_b32 s31, s28, 2
    s_add_u32 s31, s31, s3
    s_mul_i32 s31, s31, 40960
    s_cmp_eq_u32 s45, 0
    s_cselect_b32 s12, s52, s54
    s_cselect_b32 s13, s53, s55
    s_cselect_b32 s16, s48, s50
    s_cselect_b32 s17, s49, s51
    s_mov_b32 s14, 1966080
    s_mov_b32 s15, 0x20000
    s_mov_b32 s18, 819200
    s_mov_b32 s19, 0x20000
    s_waitcnt vmcnt(0)
    buffer_store_dword v107, v106, s[8:11], s7 offen sc1
    v_lshlrev_b32 v126, 16, v126
    v_mul_f32 v126, 0x3fb8aa3b, v126
    v_exp_f32 v126, v126
    v_lshlrev_b32 v124, 16, v124
    v_lshlrev_b32 v125, 16, v125
    v_mov_b32 v127, 1.0
    v_cvt_pk_bf16_f32 v126, v126, v126
    v_lshlrev_b32 v126, 16, v126
    v_mul_f32 v142, v126, v124
    v_mul_f32 v143, v126, v125
    v_mul_f32 v138, 0x3fb8aa3b, v142
    v_mul_f32 v139, 0x3e22f983, v143
    v_exp_f32 v138, v138
    v_rndne_f32 v140, v139
    v_sub_f32 v139, v139, v140
    v_cos_f32 v140, v139
    v_sin_f32 v139, v139
    v_mul_f32 v128, v138, v140
    v_mul_f32 v139, v138, v139
    v_mul_f32 v129, v139, v127
    v_mul_f32 v138, 0x41b8aa3b, v142
    v_mul_f32 v139, 0x4022f983, v143
    v_exp_f32 v138, v138
    v_rndne_f32 v140, v139
    v_sub_f32 v139, v139, v140
    v_cos_f32 v140, v139
    v_sin_f32 v139, v139
    v_mul_f32 v132, v138, v140
    v_mul_f32 v139, v138, v139
    v_mul_f32 v133, v139, v127
    v_mul_f32 v138, 0x4338aa3b, v142
    v_mul_f32 v139, 0x41a2f983, v143
    v_exp_f32 v138, v138
    v_rndne_f32 v140, v139
    v_sub_f32 v139, v139, v140
    v_cos_f32 v140, v139
    v_sin_f32 v139, v139
    v_mul_f32 v134, v138, v140
    v_mul_f32 v139, v138, v139
    v_mul_f32 v135, v139, v127
    v_mul_f32 v138, 0x43b8aa3b, v142
    v_mul_f32 v139, 0x4222f983, v143
    v_exp_f32 v138, v138
    v_rndne_f32 v140, v139
    v_sub_f32 v139, v139, v140
    v_cos_f32 v140, v139
    v_sin_f32 v139, v139
    v_mul_f32 v136, v138, v140
    v_mul_f32 v139, v138, v139
    v_mul_f32 v137, v139, v127
    v_add_f32 v141, -1.0, v128
    v_mul_f32 v126, v124, v124
    v_fmac_f32 v126, v125, v125
    v_rcp_f32 v126, v126
    v_mul_f32 v138, v141, v124
    v_fmac_f32 v138, v129, v125
    v_mul_f32 v139, v141, v125
    v_fma_f32 v139, v129, v124, -v139
    v_add_f32 v126, v126, v126
    v_mul_f32 v130, v138, v126
    v_mul_f32 v131, -v139, v126
    v_bfe_u32 v138, v1, 4, 1
    v_lshlrev_b32 v138, 3, v138
    v_and_b32 v140, 7, v1
    v_add_u32 v138, v138, v140
    v_lshlrev_b32 v138, 2, v138
    v_bfe_u32 v139, v1, 3, 1
    v_lshlrev_b32 v139, 31, v139
    v_or_b32 v139, 1.0, v139
    v_mov_b32 v140, v138
    ds_bpermute_b32 v32, v138, v128 offset:0
    ds_bpermute_b32 v33, v138, v129 offset:0
    ds_bpermute_b32 v34, v138, v130 offset:0
    ds_bpermute_b32 v35, v138, v131 offset:0
    ds_bpermute_b32 v48, v140, v132
    ds_bpermute_b32 v49, v140, v133
    ds_bpermute_b32 v50, v140, v134
    ds_bpermute_b32 v51, v140, v135
    ds_bpermute_b32 v52, v140, v136
    ds_bpermute_b32 v53, v140, v137
    s_waitcnt lgkmcnt(8)
    v_mul_f32 v33, v33, v139
    s_waitcnt lgkmcnt(7)
    v_mul_f32 v34, v34, v139
    s_waitcnt lgkmcnt(4)
    v_mul_f32 v49, v49, v139
    s_waitcnt lgkmcnt(2)
    v_mul_f32 v51, v51, v139
    s_waitcnt lgkmcnt(0)
    v_mul_f32 v53, v53, v139
    s_mov_b32 s26, 1966080
    s_mov_b32 s27, 0x20000
    s_lshl_b32 s72, s2, 1
    s_lshr_b32 s73, s3, 1
    s_add_u32 s72, s72, s73
    s_mul_i32 s73, s72, 52429
    s_lshr_b32 s73, s73, 19
    s_mul_i32 s74, s73, 10
    s_sub_u32 s74, s72, s74
    s_and_b32 s75, s3, 1
    s_lshl_b32 s76, s73, 1
    s_add_u32 s76, s76, s75
    s_mul_i32 s76, s76, 20480
    s_lshl_b32 s77, s74, 7
    s_add_u32 s76, s76, s77
    v_bfe_u32 v160, v191, 1, 1
    v_lshlrev_b32 v160, 2, v160
    v_xor_b32 v160, v160, v190
    v_lshlrev_b32 v160, 4, v160
    v_mul_u32_u24 v162, 1280, v191
    v_add_u32 v160, v160, v162
    v_add_u32 v161, 9216, v160
    s_lshl_b32 s77, s3, 11
    s_add_u32 s78, s77, 144384
    s_mov_b32 m0, s78
    s_nop 0
    buffer_load_dwordx4 v160, s[24:27], s76 offen  lds
    buffer_load_dwordx4 v161, s[24:27], s76 offen offset:1024  lds
    v_lshrrev_b32 v168, 4, v1
    v_bfe_u32 v169, v1, 2, 2
    v_and_b32 v170, 3, v1
    v_and_b32 v171, 1, v168
    v_lshrrev_b32 v172, 1, v168
    v_lshlrev_b32 v164, 2, v171
    v_add_u32 v164, v164, v169
    v_lshlrev_b32 v164, 7, v164
    v_lshlrev_b32 v173, 1, v172
    v_lshrrev_b32 v174, 1, v170
    v_add_u32 v173, v173, v174
    v_lshrrev_b32 v174, 1, v169
    v_lshlrev_b32 v174, 2, v174
    v_xor_b32 v173, v173, v174
    v_lshlrev_b32 v173, 4, v173
    v_and_b32 v174, 1, v170
    v_lshlrev_b32 v174, 3, v174
    v_add3_u32 v164, v164, v173, v174
    v_add_u32 v164, s78, v164
    v_xor_b32 v165, 64, v164
    s_lshl_b32 s74, s74, 2
    s_mul_i32 s73, s73, 5
    s_cmp_lt_u32 s2, 240
    s_cselect_b32 s72, 0, 0x80000000
    s_add_u32 s72, s72, 0x300000
    s_lshl_b32 s75, s75, 9
    s_add_u32 s72, s72, s75
    v_lshlrev_b32 v174, 8, v171
    v_and_b32 v169, 15, v1
    v_lshlrev_b32 v169, 4, v169
    v_add3_u32 v169, v169, v174, s72
    v_add_u32 v173, s74, v172
    v_add_u32 v173, 0, v173
    v_mul_u32_u24 v174, 52, v173
    v_lshrrev_b32 v174, 8, v174
    v_mul_u32_u24 v174, 235, v174
    v_add3_u32 v173, v173, v174, s73
    v_lshlrev_b32 v173, 10, v173
    v_add_u32 v166, v173, v169
    v_add_u32 v173, s74, v172
    v_add_u32 v173, 2, v173
    v_mul_u32_u24 v174, 52, v173
    v_lshrrev_b32 v174, 8, v174
    v_mul_u32_u24 v174, 235, v174
    v_add3_u32 v173, v173, v174, s73
    v_lshlrev_b32 v173, 10, v173
    v_add_u32 v167, v173, v169
    s_lshl_b32 s72, s2, 2
    s_add_u32 s72, s72, s3
    s_cmp_ge_u32 s72, 400
    s_cselect_b32 s73, 1, 0
    s_cselect_b32 s74, 400, 0
    s_cselect_b32 s64, s70, s68
    s_cselect_b32 s65, s71, s69
    s_sub_u32 s74, s72, s74
    s_mul_i32 s75, s74, 52429
    s_lshr_b32 s75, s75, 19
    s_mul_i32 s76, s75, 10
    s_sub_u32 s74, s74, s76
    s_mov_b32 s66, 819200
    s_mov_b32 s67, 0x20000
    s_mul_i32 s76, s75, 20480
    s_lshl_b32 s78, s74, 7
    s_add_u32 s76, s76, s78
    v_lshrrev_b32 v173, 1, v191
    v_xor_b32 v173, v173, v190
    v_lshlrev_b32 v173, 4, v173
    v_add_u32 v160, v173, v162
    v_xor_b32 v161, 64, v160
    v_add_u32 v161, 9216, v161
    s_add_u32 s78, s77, 152576
    s_mov_b32 m0, s78
    s_nop 0
    buffer_load_dwordx4 v160, s[64:67], s76 offen  lds
    buffer_load_dwordx4 v161, s[64:67], s76 offen offset:1024  lds
    v_and_b32 v173, 15, v1
    v_lshrrev_b32 v174, 1, v173
    v_xor_b32 v174, v168, v174
    v_lshlrev_b32 v174, 4, v174
    v_lshlrev_b32 v173, 7, v173
    v_add3_u32 v168, v173, v174, s78
    v_xor_b32 v169, 64, v168
    s_mul_i32 s76, s75, 52
    s_lshr_b32 s76, s76, 8
    s_mul_i32 s76, s76, 195
    s_add_u32 s76, s76, s75
    s_mul_i32 s73, s73, 100
    s_add_u32 s76, s76, s73
    s_mul_i32 s74, s74, 10
    s_add_u32 s76, s76, s74
    s_lshl_b32 s76, s76, 10
    s_cmp_lt_u32 s72, 800
    s_cselect_b32 s72, 0, 0x80000000
    s_add_u32 s72, s72, 0x1040000
    s_add_u32 s76, s76, s72
    v_add_u32 v170, s76, v2
    v_add_u32 v171, 5120, v170
    s_add_u32 s46, s4, s6
    s_addc_u32 s47, s5, 0
    s_mov_b32 s100, s43
    s_mov_b32 s101, s43
    s_load_dwordx16 s[64:79], s[46:47], 0 glc
    s_add_u32 s62, s62, 1
    s_cmp_eq_u32 s62, 10
    s_cselect_b32 s62, 0, s62
    s_add_u32 m0, s36, 20480
    s_lshl_b32 s45, s62, 7
    s_add_u32 s45, s45, s34
    buffer_load_dwordx4 v8, s[16:19], s45 offen offset:0  lds
    s_add_u32 m0, s35, 20480
    s_mul_i32 s45, s62, 196608
    s_add_u32 s45, s45, s32
    buffer_load_dwordx4 v4, s[12:15], s45 offen offset:0  lds
    buffer_load_dwordx4 v5, s[12:15], s45 offen offset:1024  lds
    buffer_load_dwordx4 v6, s[12:15], s45 offen offset:2048  lds
    buffer_load_dwordx4 v7, s[12:15], s45 offen offset:3072  lds
    v_and_b32 v208, 31, v1
    v_lshrrev_b32 v209, 5, v1
    v_bfe_u32 v210, v1, 2, 2
    v_and_b32 v211, 3, v1
    v_bfe_u32 v212, v1, 4, 1
    v_lshlrev_b32 v213, 1, v212
    v_lshrrev_b32 v214, 1, v211
    v_add_u32 v213, v213, v214
    v_lshrrev_b32 v214, 1, v210
    v_lshlrev_b32 v214, 2, v214
    v_xor_b32 v213, v213, v214
    v_lshlrev_b32 v213, 4, v213
    v_and_b32 v214, 1, v211
    v_lshlrev_b32 v214, 3, v214
    v_add_u32 v213, v213, v214
    v_lshlrev_b32 v214, 7, v210
    v_add_u32 v213, v213, v214
    v_lshlrev_b32 v214, 10, v209
    v_add_u32 v12, v213, v214
    v_xor_b32 v13, 64, v12
    v_bfe_u32 v215, v208, 3, 1
    v_lshlrev_b32 v213, 11, v215
    v_lshlrev_b32 v214, 10, v212
    v_add_u32 v213, v213, v214
    v_and_b32 v214, 7, v208
    v_lshlrev_b32 v214, 7, v214
    v_add_u32 v213, v213, v214
    v_bfe_u32 v214, v208, 1, 3
    v_xor_b32 v214, v214, v209
    v_lshlrev_b32 v214, 4, v214
    v_xor_b32 v216, 0, v214
    v_add_u32 v14, v213, v216
    v_xor_b32 v216, 32, v214
    v_add_u32 v15, v213, v216
    v_xor_b32 v216, 64, v214
    v_add_u32 v16, v213, v216
    v_xor_b32 v216, 96, v214
    v_add_u32 v17, v213, v216
    s_mov_b32 s44, 0
    s_waitcnt lgkmcnt(0)
    s_cmp_lg_u64 s[64:65], s[100:101]
    s_cbranch_scc1 XP_retry
    s_cmp_lg_u64 s[66:67], s[100:101]
    s_cbranch_scc1 XP_retry
    s_cmp_lg_u64 s[68:69], s[100:101]
    s_cbranch_scc1 XP_retry
    s_cmp_lg_u64 s[70:71], s[100:101]
    s_cbranch_scc1 XP_retry
    s_cmp_lg_u64 s[72:73], s[100:101]
    s_cbranch_scc1 XP_retry
    s_cmp_lg_u64 s[74:75], s[100:101]
    s_cbranch_scc1 XP_retry
    s_cmp_lg_u64 s[76:77], s[100:101]
    s_cbranch_scc1 XP_retry
    s_cmp_lg_u64 s[78:79], s[100:101]
    s_cbranch_scc1 XP_retry
XP_back:
    s_nop 0
    s_load_dwordx2 s[64:65], s[0:1], 0
    s_load_dwordx2 s[66:67], s[0:1], 64
    s_load_dwordx2 s[68:69], s[0:1], 104
    s_mov_b32 s101, s63
    s_lshl_b32 s46, s101, 12
    s_add_u32 s46, s46, s31
    buffer_load_dwordx4 a[0:3], v2, s[8:11], s46 offen offset:0 sc1
    buffer_load_dwordx4 a[4:7], v2, s[8:11], s46 offen offset:1024 sc1
    buffer_load_dwordx4 a[8:11], v2, s[8:11], s46 offen offset:2048 sc1
    buffer_load_dwordx4 a[12:15], v2, s[8:11], s46 offen offset:3072 sc1
    s_add_u32 s101, s101, 1
    s_cmp_eq_u32 s101, 10
    s_cselect_b32 s101, 0, s101
    s_lshl_b32 s46, s101, 12
    s_add_u32 s46, s46, s31
    buffer_load_dwordx4 a[16:19], v2, s[8:11], s46 offen offset:0 sc1
    buffer_load_dwordx4 a[20:23], v2, s[8:11], s46 offen offset:1024 sc1
    buffer_load_dwordx4 a[24:27], v2, s[8:11], s46 offen offset:2048 sc1
    buffer_load_dwordx4 a[28:31], v2, s[8:11], s46 offen offset:3072 sc1
    s_waitcnt lgkmcnt(0)
    s_barrier
    ds_read_b128 a[160:163], v14 offset:16384
    ds_read_b64_tr_b16 a[164:165], v12 offset:0
    ds_read_b64_tr_b16 a[166:167], v12 offset:512
    ds_read_b64_tr_b16 a[168:169], v12 offset:8192
    ds_read_b64_tr_b16 a[170:171], v12 offset:8704
    ds_read_b64_tr_b16 a[172:173], v13 offset:0
    ds_read_b64_tr_b16 a[174:175], v13 offset:512
    ds_read_b64_tr_b16 a[176:177], v13 offset:8192
    ds_read_b64_tr_b16 a[178:179], v13 offset:8704
    ds_read_b128 a[180:183], v15 offset:16384
    ds_read_b64_tr_b16 a[184:185], v12 offset:2048
    ds_read_b64_tr_b16 a[186:187], v12 offset:2560
    s_waitcnt vmcnt(7) lgkmcnt(3)
    v_mfma_f32_32x32x16_bf16 v[64:79], a[0:3], a[160:163], 0
    ds_read_b64_tr_b16 a[188:189], v12 offset:10240
    ds_read_b64_tr_b16 a[190:191], v12 offset:10752
    s_add_u32 s62, s62, 1
    s_cmp_eq_u32 s62, 10
    s_cselect_b32 s62, 0, s62
    v_mfma_f32_32x32x16_bf16 v[80:95], a[164:167], a[0:3], 0
    ds_read_b64_tr_b16 a[160:161], v13 offset:2048
    ds_read_b64_tr_b16 a[162:163], v13 offset:2560
    s_add_u32 m0, s36, 40960
    s_lshl_b32 s45, s62, 7
    s_add_u32 s45, s45, s34
    v_mfma_f32_32x32x16_bf16 v[96:111], a[168:171], a[0:3], 0
    ds_read_b64_tr_b16 a[164:165], v13 offset:10240
    ds_read_b64_tr_b16 a[166:167], v13 offset:10752
    buffer_load_dwordx4 v8, s[16:19], s45 offen offset:0  lds
    s_add_u32 m0, s35, 40960
    s_mul_i32 s45, s62, 196608
    v_mfma_f32_32x32x16_bf16 v[112:127], a[172:175], a[0:3], 0
    ds_read_b128 a[168:171], v16 offset:16384
    s_add_u32 s45, s45, s32
    v_mfma_f32_32x32x16_bf16 v[128:143], a[176:179], a[0:3], 0
    ds_read_b64_tr_b16 a[172:173], v12 offset:4096
    ds_read_b64_tr_b16 a[174:175], v12 offset:4608
    buffer_load_dwordx4 v4, s[12:15], s45 offen offset:0  lds
    s_waitcnt vmcnt(8) lgkmcnt(3)
    v_mfma_f32_32x32x16_bf16 v[64:79], a[4:7], a[180:183], v[64:79]
    ds_read_b64_tr_b16 a[176:177], v12 offset:12288
    ds_read_b64_tr_b16 a[178:179], v12 offset:12800
    v_mfma_f32_32x32x16_bf16 v[80:95], a[184:187], a[4:7], v[80:95]
    ds_read_b64_tr_b16 a[180:181], v13 offset:4096
    ds_read_b64_tr_b16 a[182:183], v13 offset:4608
    buffer_load_dwordx4 v5, s[12:15], s45 offen offset:1024  lds
    v_mfma_f32_32x32x16_bf16 v[96:111], a[188:191], a[4:7], v[96:111]
    ds_read_b64_tr_b16 a[184:185], v13 offset:12288
    ds_read_b64_tr_b16 a[186:187], v13 offset:12800
    v_mfma_f32_32x32x16_bf16 v[112:127], a[160:163], a[4:7], v[112:127]
    ds_read_b128 a[188:191], v17 offset:16384
    buffer_load_dwordx4 v6, s[12:15], s45 offen offset:2048  lds
    v_mfma_f32_32x32x16_bf16 v[128:143], a[164:167], a[4:7], v[128:143]
    ds_read_b64_tr_b16 a[160:161], v12 offset:6144
    ds_read_b64_tr_b16 a[162:163], v12 offset:6656
    ds_read_b64_tr_b16 v[172:173], v164
    ds_read_b64_tr_b16 v[174:175], v164 offset:1024
    ds_read_b64_tr_b16 v[176:177], v165
    ds_read_b64_tr_b16 v[178:179], v165 offset:1024
    ds_read_b128 v[180:183], v168
    ds_read_b128 v[184:187], v169
    s_waitcnt lgkmcnt(4)
    buffer_store_dwordx4 v[172:175], v166, s[8:11], 0 offen sc1
    s_waitcnt lgkmcnt(2)
    buffer_store_dwordx4 v[176:179], v167, s[8:11], 0 offen sc1
    s_waitcnt lgkmcnt(1)
    buffer_store_dwordx4 v[180:183], v170, s[8:11], 0 offen sc1
    s_waitcnt lgkmcnt(0)
    buffer_store_dwordx4 v[184:187], v171, s[8:11], 0 offen sc1
    s_waitcnt vmcnt(13)
    v_mfma_f32_32x32x16_bf16 v[64:79], a[8:11], a[168:171], v[64:79]
    ds_read_b64_tr_b16 a[164:165], v12 offset:14336
    ds_read_b64_tr_b16 a[166:167], v12 offset:14848
    buffer_load_dwordx4 v7, s[12:15], s45 offen offset:3072  lds
    s_add_u32 s101, s101, 1
    v_mfma_f32_32x32x16_bf16 v[80:95], a[172:175], a[8:11], v[80:95]
    ds_read_b64_tr_b16 a[168:169], v13 offset:6144
    ds_read_b64_tr_b16 a[170:171], v13 offset:6656
    s_cmp_eq_u32 s101, 10
    s_cselect_b32 s101, 0, s101
    s_lshl_b32 s46, s101, 12
    v_mfma_f32_32x32x16_bf16 v[96:111], a[176:179], a[8:11], v[96:111]
    ds_read_b64_tr_b16 a[172:173], v13 offset:14336
    ds_read_b64_tr_b16 a[174:175], v13 offset:14848
    s_add_u32 s46, s46, s31
    buffer_load_dwordx4 a[32:35], v2, s[8:11], s46 offen offset:0 sc1
    v_mfma_f32_32x32x16_bf16 v[112:127], a[180:183], a[8:11], v[112:127]
    s_barrier
    ds_read_b128 a[176:179], v14 offset:36864
    v_mfma_f32_32x32x16_bf16 v[128:143], a[184:187], a[8:11], v[128:143]
    ds_read_b64_tr_b16 a[180:181], v12 offset:20480
    ds_read_b64_tr_b16 a[182:183], v12 offset:20992
    buffer_load_dwordx4 a[36:39], v2, s[8:11], s46 offen offset:1024 sc1
    s_waitcnt vmcnt(15) lgkmcnt(3)
    v_mfma_f32_32x32x16_bf16 v[64:79], a[12:15], a[188:191], v[64:79]
    ds_read_b64_tr_b16 a[184:185], v12 offset:28672
    ds_read_b64_tr_b16 a[186:187], v12 offset:29184
    v_mfma_f32_32x32x16_bf16 v[80:95], a[160:163], a[12:15], v[80:95]
    ds_read_b64_tr_b16 a[188:189], v13 offset:20480
    ds_read_b64_tr_b16 a[190:191], v13 offset:20992
    buffer_load_dwordx4 a[40:43], v2, s[8:11], s46 offen offset:2048 sc1
    v_mfma_f32_32x32x16_bf16 v[96:111], a[164:167], a[12:15], v[96:111]
    ds_read_b64_tr_b16 a[160:161], v13 offset:28672
    ds_read_b64_tr_b16 a[162:163], v13 offset:29184
    v_mfma_f32_32x32x16_bf16 v[112:127], a[168:171], a[12:15], v[112:127]
    ds_read_b128 a[164:167], v15 offset:36864
    buffer_load_dwordx4 a[44:47], v2, s[8:11], s46 offen offset:3072 sc1
    s_add_u32 s62, s62, 1
    s_cmp_eq_u32 s62, 10
    s_cselect_b32 s62, 0, s62
    v_mfma_f32_32x32x16_bf16 v[128:143], a[172:175], a[12:15], v[128:143]
    ds_read_b64_tr_b16 a[168:169], v12 offset:22528
    ds_read_b64_tr_b16 a[170:171], v12 offset:23040
    s_add_u32 m0, s36, 61440
    s_lshl_b32 s45, s62, 7
    s_add_u32 s45, s45, s34
    s_waitcnt vmcnt(16) lgkmcnt(3)
    v_mfma_f32_32x32x16_bf16 v[64:79], a[16:19], a[176:179], v[64:79]
    ds_read_b64_tr_b16 a[172:173], v12 offset:30720
    ds_read_b64_tr_b16 a[174:175], v12 offset:31232
    buffer_load_dwordx4 v8, s[16:19], s45 offen offset:0  lds
    s_add_u32 m0, s35, 61440
    v_mfma_f32_32x32x16_bf16 v[80:95], a[180:183], a[16:19], v[80:95]
    ds_read_b64_tr_b16 a[176:177], v13 offset:22528
    ds_read_b64_tr_b16 a[178:179], v13 offset:23040
    s_mul_i32 s45, s62, 196608
    s_add_u32 s45, s45, s32
    v_mfma_f32_32x32x16_bf16 v[96:111], a[184:187], a[16:19], v[96:111]
    ds_read_b64_tr_b16 a[180:181], v13 offset:30720
    ds_read_b64_tr_b16 a[182:183], v13 offset:31232
    buffer_load_dwordx4 v4, s[12:15], s45 offen offset:0  lds
    v_mfma_f32_32x32x16_bf16 v[112:127], a[188:191], a[16:19], v[112:127]
    ds_read_b128 a[184:187], v16 offset:36864
    v_mfma_f32_32x32x16_bf16 v[128:143], a[160:163], a[16:19], v[128:143]
    ds_read_b64_tr_b16 a[188:189], v12 offset:24576
    ds_read_b64_tr_b16 a[190:191], v12 offset:25088
    buffer_load_dwordx4 v5, s[12:15], s45 offen offset:1024  lds
    s_waitcnt vmcnt(18) lgkmcnt(3)
    v_mfma_f32_32x32x16_bf16 v[64:79], a[20:23], a[164:167], v[64:79]
    ds_read_b64_tr_b16 a[160:161], v12 offset:32768
    ds_read_b64_tr_b16 a[162:163], v12 offset:33280
    v_mfma_f32_32x32x16_bf16 v[80:95], a[168:171], a[20:23], v[80:95]
    ds_read_b64_tr_b16 a[164:165], v13 offset:24576
    ds_read_b64_tr_b16 a[166:167], v13 offset:25088
    buffer_load_dwordx4 v6, s[12:15], s45 offen offset:2048  lds
    v_mfma_f32_32x32x16_bf16 v[96:111], a[172:175], a[20:23], v[96:111]
    ds_read_b64_tr_b16 a[168:169], v13 offset:32768
    ds_read_b64_tr_b16 a[170:171], v13 offset:33280
    v_mfma_f32_32x32x16_bf16 v[112:127], a[176:179], a[20:23], v[112:127]
    ds_read_b128 a[172:175], v17 offset:36864
    buffer_load_dwordx4 v7, s[12:15], s45 offen offset:3072  lds
    s_add_u32 s101, s101, 1
    s_cmp_eq_u32 s101, 10
    s_cselect_b32 s101, 0, s101
    v_mfma_f32_32x32x16_bf16 v[128:143], a[180:183], a[20:23], v[128:143]
    ds_read_b64_tr_b16 a[176:177], v12 offset:26624
    ds_read_b64_tr_b16 a[178:179], v12 offset:27136
    s_lshl_b32 s46, s101, 12
    s_add_u32 s46, s46, s31
    s_waitcnt vmcnt(19) lgkmcnt(3)
    v_mfma_f32_32x32x16_bf16 v[64:79], a[24:27], a[184:187], v[64:79]
    ds_read_b64_tr_b16 a[180:181], v12 offset:34816
    ds_read_b64_tr_b16 a[182:183], v12 offset:35328
    buffer_load_dwordx4 a[48:51], v2, s[8:11], s46 offen offset:0 sc1
    v_and_b32 v208, 31, v1
    v_mfma_f32_32x32x16_bf16 v[80:95], a[188:191], a[24:27], v[80:95]
    ds_read_b64_tr_b16 a[184:185], v13 offset:26624
    ds_read_b64_tr_b16 a[186:187], v13 offset:27136
    v_lshrrev_b32 v209, 5, v1
    v_bfe_u32 v210, v1, 2, 2
    v_and_b32 v211, 3, v1
    v_mfma_f32_32x32x16_bf16 v[96:111], a[160:163], a[24:27], v[96:111]
    ds_read_b64_tr_b16 a[188:189], v13 offset:34816
    ds_read_b64_tr_b16 a[190:191], v13 offset:35328
    buffer_load_dwordx4 a[52:55], v2, s[8:11], s46 offen offset:1024 sc1
    v_bfe_u32 v212, v1, 4, 1
    s_lshl_b32 s37, s3, 3
    v_mfma_f32_32x32x16_bf16 v[112:127], a[164:167], a[24:27], v[112:127]
    s_waitcnt vmcnt(11)
    s_barrier
    ds_read_b128 a[160:163], v14 offset:57344
    s_add_u32 s37, s37, 143360
    v_lshlrev_b32 v213, 5, v208
    v_mfma_f32_32x32x16_bf16 v[128:143], a[168:171], a[24:27], v[128:143]
    ds_read_b64_tr_b16 a[164:165], v12 offset:40960
    ds_read_b64_tr_b16 a[166:167], v12 offset:41472
    buffer_load_dwordx4 a[56:59], v2, s[8:11], s46 offen offset:2048 sc1
    v_lshlrev_b32 v214, 2, v209
    v_add3_u32 v18, v213, v214, s37
    s_waitcnt lgkmcnt(3)
    v_mfma_f32_32x32x16_bf16 v[64:79], a[28:31], a[172:175], v[64:79]
    ds_read_b64_tr_b16 a[168:169], v12 offset:49152
    ds_read_b64_tr_b16 a[170:171], v12 offset:49664
    v_add_u32 v19, 143360, v213
    s_mul_i32 s37, s3, 2560
    v_mfma_f32_32x32x16_bf16 v[80:95], a[176:179], a[28:31], v[80:95]
    ds_read_b64_tr_b16 a[172:173], v13 offset:40960
    ds_read_b64_tr_b16 a[174:175], v13 offset:41472
    buffer_load_dwordx4 a[60:63], v2, s[8:11], s46 offen offset:3072 sc1
    s_add_u32 s62, s62, 1
    s_cmp_eq_u32 s62, 10
    s_cselect_b32 s62, 0, s62
    v_mfma_f32_32x32x16_bf16 v[96:111], a[180:183], a[28:31], v[96:111]
    ds_read_b64_tr_b16 a[176:177], v13 offset:49152
    ds_read_b64_tr_b16 a[178:179], v13 offset:49664
    s_add_u32 m0, s36, 81920
    s_lshl_b32 s45, s62, 7
    s_add_u32 s45, s45, s34
    v_mfma_f32_32x32x16_bf16 v[112:127], a[184:187], a[28:31], v[112:127]
    ds_read_b128 a[180:183], v15 offset:57344
    buffer_load_dwordx4 v8, s[16:19], s45 offen offset:0  lds
    s_add_u32 m0, s35, 81920
    s_mul_i32 s45, s62, 196608
    s_add_u32 s45, s45, s32
    v_mfma_f32_32x32x16_bf16 v[128:143], a[188:191], a[28:31], v[128:143]
    ds_read_b64_tr_b16 a[184:185], v12 offset:43008
    ds_read_b64_tr_b16 a[186:187], v12 offset:43520
    s_add_u32 s37, s37, 151552
    v_mul_u32_u24 v213, 80, v208
    v_lshlrev_b32 v214, 5, v209
    s_waitcnt vmcnt(13) lgkmcnt(3)
    v_mfma_f32_32x32x16_bf16 v[64:79], a[32:35], a[160:163], v[64:79]
    ds_read_b64_tr_b16 a[188:189], v12 offset:51200
    ds_read_b64_tr_b16 a[190:191], v12 offset:51712
    buffer_load_dwordx4 v4, s[12:15], s45 offen offset:0  lds
    v_add3_u32 v20, v213, v214, s37
    v_mfma_f32_32x32x16_bf16 v[80:95], a[164:167], a[32:35], v[80:95]
    ds_read_b64_tr_b16 a[160:161], v13 offset:43008
    ds_read_b64_tr_b16 a[162:163], v13 offset:43520
    v_lshrrev_b32 v213, 4, v1
    v_lshlrev_b32 v213, 3, v213
    v_add_u32 v213, v213, v210
    v_mfma_f32_32x32x16_bf16 v[96:111], a[168:171], a[32:35], v[96:111]
    ds_read_b64_tr_b16 a[164:165], v13 offset:51200
    ds_read_b64_tr_b16 a[166:167], v13 offset:51712
    buffer_load_dwordx4 v5, s[12:15], s45 offen offset:1024  lds
    v_mul_u32_u24 v213, 80, v213
    v_lshlrev_b32 v214, 3, v211
    v_mfma_f32_32x32x16_bf16 v[112:127], a[172:175], a[32:35], v[112:127]
    ds_read_b128 a[168:171], v16 offset:57344
    v_add3_u32 v21, v213, v214, s37
    v_mul_u32_u24 v213, 81920, v212
    v_lshlrev_b32 v214, 8, v209
    v_add_u32 v213, v213, v214
    v_mfma_f32_32x32x16_bf16 v[128:143], a[176:179], a[32:35], v[128:143]
    ds_read_b64_tr_b16 a[172:173], v12 offset:45056
    ds_read_b64_tr_b16 a[174:175], v12 offset:45568
    buffer_load_dwordx4 v6, s[12:15], s45 offen offset:2048  lds
    v_and_b32 v214, 15, v1
    v_lshlrev_b32 v214, 4, v214
    s_waitcnt vmcnt(15) lgkmcnt(3)
    v_mfma_f32_32x32x16_bf16 v[64:79], a[36:39], a[180:183], v[64:79]
    ds_read_b64_tr_b16 a[176:177], v12 offset:53248
    ds_read_b64_tr_b16 a[178:179], v12 offset:53760
    v_add_u32 v22, v213, v214
    v_bfe_u32 v213, v208, 2, 1
    v_mfma_f32_32x32x16_bf16 v[80:95], a[184:187], a[36:39], v[80:95]
    ds_read_b64_tr_b16 a[180:181], v13 offset:45056
    ds_read_b64_tr_b16 a[182:183], v13 offset:45568
    buffer_load_dwordx4 v7, s[12:15], s45 offen offset:3072  lds
    s_add_u32 s101, s101, 1
    s_cmp_eq_u32 s101, 10
    s_cselect_b32 s101, 0, s101
    v_mfma_f32_32x32x16_bf16 v[96:111], a[188:191], a[36:39], v[96:111]
    ds_read_b64_tr_b16 a[184:185], v13 offset:53248
    ds_read_b64_tr_b16 a[186:187], v13 offset:53760
    s_lshl_b32 s46, s101, 12
    s_add_u32 s46, s46, s31
    v_lshlrev_b32 v213, 10, v213
    v_mfma_f32_32x32x16_bf16 v[112:127], a[160:163], a[36:39], v[112:127]
    ds_read_b128 a[188:191], v17 offset:57344
    buffer_load_dwordx4 a[64:67], v2, s[8:11], s46 offen offset:0 sc1
    v_lshlrev_b32 v214, 8, v209
    v_add_u32 v213, v213, v214
    v_lshrrev_b32 v214, 3, v208
    v_mfma_f32_32x32x16_bf16 v[128:143], a[164:167], a[36:39], v[128:143]
    ds_read_b64_tr_b16 a[160:161], v12 offset:47104
    ds_read_b64_tr_b16 a[162:163], v12 offset:47616
    v_lshlrev_b32 v214, 2, v214
    v_add_u32 v214, v214, v211
    v_lshlrev_b32 v214, 4, v214
    s_waitcnt vmcnt(16) lgkmcnt(3)
    v_mfma_f32_32x32x16_bf16 v[64:79], a[40:43], a[168:171], v[64:79]
    ds_read_b64_tr_b16 a[164:165], v12 offset:55296
    ds_read_b64_tr_b16 a[166:167], v12 offset:55808
    buffer_load_dwordx4 a[68:71], v2, s[8:11], s46 offen offset:1024 sc1
    v_add_u32 v23, v213, v214
    v_mfma_f32_32x32x16_bf16 v[80:95], a[172:175], a[40:43], v[80:95]
    ds_read_b64_tr_b16 a[168:169], v13 offset:47104
    ds_read_b64_tr_b16 a[170:171], v13 offset:47616
    s_lshl_b32 s37, s28, 1
    s_lshr_b32 s38, s3, 1
    s_add_u32 s37, s37, s38
    v_mfma_f32_32x32x16_bf16 v[96:111], a[176:179], a[40:43], v[96:111]
    ds_read_b64_tr_b16 a[172:173], v13 offset:55296
    ds_read_b64_tr_b16 a[174:175], v13 offset:55808
    buffer_load_dwordx4 a[72:75], v2, s[8:11], s46 offen offset:2048 sc1
    s_and_b32 s38, s3, 1
    s_lshl_b32 s38, s38, 11
    v_mfma_f32_32x32x16_bf16 v[112:127], a[180:183], a[40:43], v[112:127]
    s_waitcnt vmcnt(12)
    s_barrier
    v_add_u32 v14, 0xf000, v14
    ds_read_b128 a[176:179], v14 offset:16384
    s_mul_i32 s39, s37, 196608
    v_mfma_f32_32x32x16_bf16 v[128:143], a[184:187], a[40:43], v[128:143]
    ds_read_b64_tr_b16 a[180:181], v12 offset:61440
    ds_read_b64_tr_b16 a[182:183], v12 offset:61952
    buffer_load_dwordx4 a[76:79], v2, s[8:11], s46 offen offset:3072 sc1
    s_add_u32 s62, s62, 1
    s_cmp_eq_u32 s62, 10
    s_cselect_b32 s62, 0, s62
    s_waitcnt lgkmcnt(3)
    v_mfma_f32_32x32x16_bf16 v[64:79], a[44:47], a[188:191], v[64:79]
    v_add_u32 v12, 0xf000, v12
    ds_read_b64_tr_b16 a[184:185], v12 offset:8192
    ds_read_b64_tr_b16 a[186:187], v12 offset:8704
    s_add_u32 m0, s36, 102400
    v_mfma_f32_32x32x16_bf16 v[80:95], a[160:163], a[44:47], v[80:95]
    ds_read_b64_tr_b16 a[188:189], v13 offset:61440
    ds_read_b64_tr_b16 a[190:191], v13 offset:61952
    s_lshl_b32 s45, s62, 7
    s_add_u32 s45, s45, s34
    buffer_load_dwordx4 v8, s[16:19], s45 offen offset:0  lds
    v_mfma_f32_32x32x16_bf16 v[96:111], a[164:167], a[44:47], v[96:111]
    v_add_u32 v13, 0xf000, v13
    ds_read_b64_tr_b16 a[160:161], v13 offset:8192
    ds_read_b64_tr_b16 a[162:163], v13 offset:8704
    s_add_u32 m0, s35, 102400
    s_mul_i32 s45, s62, 196608
    v_mfma_f32_32x32x16_bf16 v[112:127], a[168:171], a[44:47], v[112:127]
    v_add_u32 v15, 0xf000, v15
    ds_read_b128 a[164:167], v15 offset:16384
    s_add_u32 s45, s45, s32
    buffer_load_dwordx4 v4, s[12:15], s45 offen offset:0  lds
    s_add_u32 s39, s39, s38
    v_mfma_f32_32x32x16_bf16 v[128:143], a[172:175], a[44:47], v[128:143]
    ds_read_b64_tr_b16 a[168:169], v12 offset:2048
    ds_read_b64_tr_b16 a[170:171], v12 offset:2560
    s_add_u32 s39, s39, 0x500000
    s_mul_i32 s40, s37, 163840
    s_add_u32 s40, s40, s38
    s_waitcnt vmcnt(14) lgkmcnt(3)
    v_mfma_f32_32x32x16_bf16 v[64:79], a[48:51], a[176:179], v[64:79]
    ds_read_b64_tr_b16 a[172:173], v12 offset:10240
    ds_read_b64_tr_b16 a[174:175], v12 offset:10752
    buffer_load_dwordx4 v5, s[12:15], s45 offen offset:1024  lds
    s_add_u32 s40, s40, 0xb00000
    v_mfma_f32_32x32x16_bf16 v[80:95], a[180:183], a[48:51], v[80:95]
    ds_read_b64_tr_b16 a[176:177], v13 offset:2048
    ds_read_b64_tr_b16 a[178:179], v13 offset:2560
    s_mul_i32 s37, s30, 24576
    s_add_u32 s39, s39, s37
    s_lshl_b32 s37, s29, 14
    v_mfma_f32_32x32x16_bf16 v[96:111], a[184:187], a[48:51], v[96:111]
    ds_read_b64_tr_b16 a[180:181], v13 offset:10240
    ds_read_b64_tr_b16 a[182:183], v13 offset:10752
    buffer_load_dwordx4 v6, s[12:15], s45 offen offset:2048  lds
    s_add_u32 s37, s37, 0x1000000
    s_add_u32 s20, s4, s37
    s_addc_u32 s21, s5, 0
    v_mfma_f32_32x32x16_bf16 v[112:127], a[188:191], a[48:51], v[112:127]
    v_add_u32 v16, 0xf000, v16
    ds_read_b128 a[184:187], v16 offset:16384
    s_mov_b32 s22, 0x4000
    s_mov_b32 s23, 0x20000
    s_sub_u32 s37, 15, s28
    v_mfma_f32_32x32x16_bf16 v[128:143], a[160:163], a[48:51], v[128:143]
    ds_read_b64_tr_b16 a[188:189], v12 offset:4096
    ds_read_b64_tr_b16 a[190:191], v12 offset:4608
    buffer_load_dwordx4 v7, s[12:15], s45 offen offset:3072  lds
    s_add_u32 s101, s101, 1
    s_cmp_eq_u32 s101, 10
    s_cselect_b32 s101, 0, s101
    s_waitcnt vmcnt(16) lgkmcnt(3)
    v_mfma_f32_32x32x16_bf16 v[64:79], a[52:55], a[164:167], v[64:79]
    ds_read_b64_tr_b16 a[160:161], v12 offset:12288
    ds_read_b64_tr_b16 a[162:163], v12 offset:12800
    s_lshl_b32 s46, s101, 12
    s_add_u32 s46, s46, s31
    v_mfma_f32_32x32x16_bf16 v[80:95], a[168:171], a[52:55], v[80:95]
    ds_read_b64_tr_b16 a[164:165], v13 offset:4096
    ds_read_b64_tr_b16 a[166:167], v13 offset:4608
    buffer_load_dwordx4 a[80:83], v2, s[8:11], s46 offen offset:0 sc1
    s_lshl_b32 s37, s37, 10
    v_lshlrev_b32 v213, 3, v208
    v_mfma_f32_32x32x16_bf16 v[96:111], a[172:175], a[52:55], v[96:111]
    ds_read_b64_tr_b16 a[168:169], v13 offset:12288
    ds_read_b64_tr_b16 a[170:171], v13 offset:12800
    v_add_u32 v213, s37, v213
    v_lshlrev_b32 v214, 10, v209
    v_add_u32 v28, v213, v214
    v_mfma_f32_32x32x16_bf16 v[112:127], a[176:179], a[52:55], v[112:127]
    v_add_u32 v17, 0xf000, v17
    ds_read_b128 a[172:175], v17 offset:16384
    buffer_load_dwordx4 a[84:87], v2, s[8:11], s46 offen offset:1024 sc1
    v_add_u32 v28, 1024, v28
    v_add_u32 v29, 4096, v28
    v_mfma_f32_32x32x16_bf16 v[128:143], a[180:183], a[52:55], v[128:143]
    ds_read_b64_tr_b16 a[176:177], v12 offset:6144
    ds_read_b64_tr_b16 a[178:179], v12 offset:6656
    v_add_u32 v30, 8192, v28
    v_add_u32 v31, 12288, v28
    v_lshlrev_b32 v214, 31, v209
    s_waitcnt vmcnt(17) lgkmcnt(3)
    v_mfma_f32_32x32x16_bf16 v[64:79], a[56:59], a[184:187], v[64:79]
    ds_read_b64_tr_b16 a[180:181], v12 offset:14336
    ds_read_b64_tr_b16 a[182:183], v12 offset:14848
    buffer_load_dwordx4 a[88:91], v2, s[8:11], s46 offen offset:2048 sc1
    v_or_b32 v24, v213, v214
    v_mfma_f32_32x32x16_bf16 v[80:95], a[188:191], a[56:59], v[80:95]
    ds_read_b64_tr_b16 a[184:185], v13 offset:6144
    ds_read_b64_tr_b16 a[186:187], v13 offset:6656
    s_cmp_eq_u32 s3, 0
    s_cselect_b32 s37, 0, 0x80000000
    v_or_b32 v24, s37, v24
    v_mfma_f32_32x32x16_bf16 v[96:111], a[160:163], a[56:59], v[96:111]
    ds_read_b64_tr_b16 a[188:189], v13 offset:14336
    ds_read_b64_tr_b16 a[190:191], v13 offset:14848
    buffer_load_dwordx4 a[92:95], v2, s[8:11], s46 offen offset:3072 sc1
    s_add_u32 s62, s62, 1
    s_cmp_eq_u32 s62, 10
    s_cselect_b32 s62, 0, s62
    v_mfma_f32_32x32x16_bf16 v[112:127], a[164:167], a[56:59], v[112:127]
    s_waitcnt vmcnt(13)
    s_barrier
    s_cmp_eq_u32 s3, 0
    s_cselect_b32 s7, 8, 0
    v_cmp_gt_u32 vcc, s7, v1
    v_lshlrev_b32 v248, 10, v1
    v_mov_b32 v249, 0x80000000
    v_cndmask_b32 v248, v249, v248, vcc
    v_mov_b32 v249, s43
    s_lshl_b32 s7, s2, 2
    s_add_u32 s7, s7, 0x11f0000
    buffer_store_dword v249, v248, s[8:11], s7 offen sc1
    ds_read_b128 a[160:163], v14 offset:36864
    s_add_u32 m0, s36, 122880
    s_lshl_b32 s45, s62, 7
    v_mfma_f32_32x32x16_bf16 v[128:143], a[168:171], a[56:59], v[128:143]
    ds_read_b64_tr_b16 a[164:165], v12 offset:20480
    ds_read_b64_tr_b16 a[166:167], v12 offset:20992
    s_add_u32 s45, s45, s34
    buffer_load_dwordx4 v8, s[16:19], s45 offen offset:0  lds
    s_add_u32 m0, s35, 122880
    s_waitcnt lgkmcnt(3)
    v_mfma_f32_32x32x16_bf16 v[64:79], a[60:63], a[172:175], v[64:79]
    ds_read_b64_tr_b16 a[168:169], v12 offset:28672
    ds_read_b64_tr_b16 a[170:171], v12 offset:29184
    s_mul_i32 s45, s62, 196608
    s_add_u32 s45, s45, s32
    v_mfma_f32_32x32x16_bf16 v[80:95], a[176:179], a[60:63], v[80:95]
    ds_read_b64_tr_b16 a[172:173], v13 offset:20480
    ds_read_b64_tr_b16 a[174:175], v13 offset:20992
    buffer_load_dwordx4 v4, s[12:15], s45 offen offset:0  lds
    s_add_u32 s37, s28, 1
    v_sub_u32 v25, s37, v209
    v_mfma_f32_32x32x16_bf16 v[96:111], a[180:183], a[60:63], v[96:111]
    ds_read_b64_tr_b16 a[176:177], v13 offset:28672
    ds_read_b64_tr_b16 a[178:179], v13 offset:29184
    v_lshrrev_b32 v25, 1, v25
    s_mov_b32 s42, 0xbfb8aa3b
    v_mov_b32 v54, 1.0
    v_mfma_f32_32x32x16_bf16 v[112:127], a[184:187], a[60:63], v[112:127]
    ds_read_b128 a[180:183], v15 offset:36864
    buffer_load_dwordx4 v5, s[12:15], s45 offen offset:1024  lds
    v_mov_b32 v55, 1.0
    v_mov_b32 v56, s42
    v_mov_b32 v57, s42
    v_mfma_f32_32x32x16_bf16 v[128:143], a[188:191], a[60:63], v[128:143]
    ds_read_b64_tr_b16 a[184:185], v12 offset:22528
    ds_read_b64_tr_b16 a[186:187], v12 offset:23040
    s_and_b32 s37, s2, 7
    s_lshr_b32 s38, s2, 3
    s_and_b32 s48, s37, 3
    s_waitcnt vmcnt(16) lgkmcnt(3)
    v_mfma_f32_32x32x16_bf16 v[64:79], a[64:67], a[160:163], v[64:79]
    ds_read_b64_tr_b16 a[188:189], v12 offset:30720
    ds_read_b64_tr_b16 a[190:191], v12 offset:31232
    buffer_load_dwordx4 v6, s[12:15], s45 offen offset:2048  lds
    s_lshl_b32 s48, s48, 3
    v_mfma_f32_32x32x16_bf16 v[80:95], a[164:167], a[64:67], v[80:95]
    ds_read_b64_tr_b16 a[160:161], v13 offset:22528
    ds_read_b64_tr_b16 a[162:163], v13 offset:23040
    s_and_b32 s49, s38, 7
    s_add_u32 s48, s48, s49
    s_lshr_b32 s49, s37, 2
    v_mfma_f32_32x32x16_bf16 v[96:111], a[168:171], a[64:67], v[96:111]
    ds_read_b64_tr_b16 a[164:165], v13 offset:30720
    ds_read_b64_tr_b16 a[166:167], v13 offset:31232
    buffer_load_dwordx4 v7, s[12:15], s45 offen offset:3072  lds
    s_add_u32 s101, s101, 1
    s_cmp_eq_u32 s101, 10
    s_cselect_b32 s101, 0, s101
    v_mfma_f32_32x32x16_bf16 v[112:127], a[172:175], a[64:67], v[112:127]
    ds_read_b128 a[168:171], v16 offset:36864
    s_lshl_b32 s46, s101, 12
    s_add_u32 s46, s46, s31
    s_lshl_b32 s49, s49, 2
    s_lshr_b32 s38, s38, 3
    v_mfma_f32_32x32x16_bf16 v[128:143], a[176:179], a[64:67], v[128:143]
    ds_read_b64_tr_b16 a[172:173], v12 offset:24576
    ds_read_b64_tr_b16 a[174:175], v12 offset:25088
    buffer_load_dwordx4 a[96:99], v2, s[8:11], s46 offen offset:0 sc1
    s_add_u32 s49, s49, s38
    v_add_u32 v3, 4096, v2
    s_waitcnt vmcnt(18) lgkmcnt(3)
    v_mfma_f32_32x32x16_bf16 v[64:79], a[68:71], a[180:183], v[64:79]
    ds_read_b64_tr_b16 a[176:177], v12 offset:32768
    ds_read_b64_tr_b16 a[178:179], v12 offset:33280
    s_mul_i32 s50, s49, 204800
    s_mul_i32 s37, s3, 51200
    v_mfma_f32_32x32x16_bf16 v[80:95], a[184:187], a[68:71], v[80:95]
    ds_read_b64_tr_b16 a[180:181], v13 offset:24576
    ds_read_b64_tr_b16 a[182:183], v13 offset:25088
    buffer_load_dwordx4 a[100:103], v2, s[8:11], s46 offen offset:1024 sc1
    s_add_u32 s50, s50, s37
    s_add_u32 s50, s50, 0x1040000
    v_mfma_f32_32x32x16_bf16 v[96:111], a[188:191], a[68:71], v[96:111]
    ds_read_b64_tr_b16 a[184:185], v13 offset:32768
    ds_read_b64_tr_b16 a[186:187], v13 offset:33280
    s_mul_i32 s51, s49, 245760
    s_mul_i32 s37, s3, 61440
    s_add_u32 s51, s51, s37
    v_mfma_f32_32x32x16_bf16 v[112:127], a[160:163], a[68:71], v[112:127]
    ds_read_b128 a[188:191], v17 offset:36864
    buffer_load_dwordx4 a[104:107], v2, s[8:11], s46 offen offset:2048 sc1
    s_add_u32 s51, s51, 0x300000
    s_mul_i32 s52, s48, 163840
    s_mul_i32 s37, s3, 40960
    v_mfma_f32_32x32x16_bf16 v[128:143], a[164:167], a[68:71], v[128:143]
    ds_read_b64_tr_b16 a[160:161], v12 offset:26624
    ds_read_b64_tr_b16 a[162:163], v12 offset:27136
    s_add_u32 s52, s52, s37
    s_add_u32 s52, s52, 0xb00000
    s_mul_i32 s53, s48, 196608
    s_waitcnt vmcnt(19) lgkmcnt(3)
    v_mfma_f32_32x32x16_bf16 v[64:79], a[72:75], a[168:171], v[64:79]
    ds_read_b64_tr_b16 a[164:165], v12 offset:34816
    ds_read_b64_tr_b16 a[166:167], v12 offset:35328
    buffer_load_dwordx4 a[108:111], v2, s[8:11], s46 offen offset:3072 sc1
    s_add_u32 s62, s62, 1
    v_mfma_f32_32x32x16_bf16 v[80:95], a[172:175], a[72:75], v[80:95]
    ds_read_b64_tr_b16 a[168:169], v13 offset:26624
    ds_read_b64_tr_b16 a[170:171], v13 offset:27136
    s_cmp_eq_u32 s62, 10
    s_cselect_b32 s62, 0, s62
    s_add_u32 m0, s36, 0
    v_mfma_f32_32x32x16_bf16 v[96:111], a[176:179], a[72:75], v[96:111]
    ds_read_b64_tr_b16 a[172:173], v13 offset:34816
    ds_read_b64_tr_b16 a[174:175], v13 offset:35328
    s_lshl_b32 s45, s62, 7
    s_add_u32 s45, s45, s34
    buffer_load_dwordx4 v8, s[16:19], s45 offen offset:0  lds
    v_mfma_f32_32x32x16_bf16 v[112:127], a[180:183], a[72:75], v[112:127]
    s_waitcnt vmcnt(15)
    s_barrier
    ds_read_b128 a[176:179], v14 offset:57344
    s_add_u32 m0, s35, 0
    s_mul_i32 s45, s62, 196608
    v_mfma_f32_32x32x16_bf16 v[128:143], a[184:187], a[72:75], v[128:143]
    ds_read_b64_tr_b16 a[180:181], v12 offset:40960
    ds_read_b64_tr_b16 a[182:183], v12 offset:41472
    s_add_u32 s45, s45, s32
    buffer_load_dwordx4 v4, s[12:15], s45 offen offset:0  lds
    s_mul_i32 s37, s3, 49152
    s_waitcnt lgkmcnt(3)
    v_mfma_f32_32x32x16_bf16 v[64:79], a[76:79], a[188:191], v[64:79]
    ds_read_b64_tr_b16 a[184:185], v12 offset:49152
    ds_read_b64_tr_b16 a[186:187], v12 offset:49664
    s_add_u32 s53, s53, s37
    s_add_u32 s53, s53, 0x500000
    v_mfma_f32_32x32x16_bf16 v[80:95], a[160:163], a[76:79], v[80:95]
    ds_read_b64_tr_b16 a[188:189], v13 offset:40960
    ds_read_b64_tr_b16 a[190:191], v13 offset:41472
    buffer_load_dwordx4 v5, s[12:15], s45 offen offset:1024  lds
    s_lshl_b32 s60, s48, 3
    s_add_u32 s60, s60, s49
    v_mfma_f32_32x32x16_bf16 v[96:111], a[164:167], a[76:79], v[96:111]
    ds_read_b64_tr_b16 a[160:161], v13 offset:49152
    ds_read_b64_tr_b16 a[162:163], v13 offset:49664
    s_lshl_b32 s60, s60, 8
    s_add_u32 s60, s60, 0x11d0000
    s_lshl_b32 s61, s28, 1
    v_mfma_f32_32x32x16_bf16 v[112:127], a[168:171], a[76:79], v[112:127]
    ds_read_b128 a[164:167], v15 offset:57344
    buffer_load_dwordx4 v6, s[12:15], s45 offen offset:2048  lds
    s_lshr_b32 s37, s3, 1
    s_add_u32 s61, s61, s37
    s_lshl_b32 s61, s61, 11
    v_mfma_f32_32x32x16_bf16 v[128:143], a[172:175], a[76:79], v[128:143]
    ds_read_b64_tr_b16 a[168:169], v12 offset:43008
    ds_read_b64_tr_b16 a[170:171], v12 offset:43520
    s_lshl_b32 s37, s29, 3
    s_add_u32 s61, s61, s37
    s_and_b32 s37, s3, 1
    s_waitcnt vmcnt(17) lgkmcnt(3)
    v_mfma_f32_32x32x16_bf16 v[64:79], a[80:83], a[176:179], v[64:79]
    ds_read_b64_tr_b16 a[172:173], v12 offset:51200
    ds_read_b64_tr_b16 a[174:175], v12 offset:51712
    buffer_load_dwordx4 v7, s[12:15], s45 offen offset:3072  lds
    s_add_u32 s101, s101, 1
    v_mfma_f32_32x32x16_bf16 v[80:95], a[180:183], a[80:83], v[80:95]
    ds_read_b64_tr_b16 a[176:177], v13 offset:43008
    ds_read_b64_tr_b16 a[178:179], v13 offset:43520
    s_cmp_eq_u32 s101, 10
    s_cselect_b32 s101, 0, s101
    s_lshl_b32 s46, s101, 12
    v_mfma_f32_32x32x16_bf16 v[96:111], a[184:187], a[80:83], v[96:111]
    ds_read_b64_tr_b16 a[180:181], v13 offset:51200
    ds_read_b64_tr_b16 a[182:183], v13 offset:51712
    s_add_u32 s46, s46, s31
    buffer_load_dwordx4 a[112:115], v2, s[8:11], s46 offen offset:0 sc1
    s_lshl_b32 s38, s37, 2
    v_mfma_f32_32x32x16_bf16 v[112:127], a[188:191], a[80:83], v[112:127]
    ds_read_b128 a[184:187], v16 offset:57344
    s_add_u32 s61, s61, s38
    s_add_u32 s61, s61, 0x11d0000
    v_lshrrev_b32 v61, 3, v1
    v_min_u32 v61, 1, v61
    v_mfma_f32_32x32x16_bf16 v[128:143], a[160:163], a[80:83], v[128:143]
    ds_read_b64_tr_b16 a[188:189], v12 offset:45056
    ds_read_b64_tr_b16 a[190:191], v12 offset:45568
    buffer_load_dwordx4 a[116:119], v2, s[8:11], s46 offen offset:1024 sc1
    v_lshlrev_b32 v61, 31, v61
    v_lshlrev_b32 v27, 8, v1
    s_waitcnt vmcnt(19) lgkmcnt(3)
    v_mfma_f32_32x32x16_bf16 v[64:79], a[84:87], a[164:167], v[64:79]
    ds_read_b64_tr_b16 a[160:161], v12 offset:53248
    ds_read_b64_tr_b16 a[162:163], v12 offset:53760
    v_or_b32 v27, v27, v61
    v_mfma_f32_32x32x16_bf16 v[80:95], a[168:171], a[84:87], v[80:95]
    ds_read_b64_tr_b16 a[164:165], v13 offset:45056
    ds_read_b64_tr_b16 a[166:167], v13 offset:45568
    buffer_load_dwordx4 a[120:123], v2, s[8:11], s46 offen offset:2048 sc1
    v_mfma_f32_32x32x16_bf16 v[96:111], a[172:175], a[84:87], v[96:111]
    ds_read_b64_tr_b16 a[168:169], v13 offset:53248
    ds_read_b64_tr_b16 a[170:171], v13 offset:53760
    v_mfma_f32_32x32x16_bf16 v[112:127], a[176:179], a[84:87], v[112:127]
    ds_read_b128 a[172:175], v17 offset:57344
    buffer_load_dwordx4 a[124:127], v2, s[8:11], s46 offen offset:3072 sc1
    s_add_u32 s62, s62, 1
    s_cmp_eq_u32 s62, 10
    s_cselect_b32 s62, 0, s62
    v_mfma_f32_32x32x16_bf16 v[128:143], a[180:183], a[84:87], v[128:143]
    ds_read_b64_tr_b16 a[176:177], v12 offset:47104
    ds_read_b64_tr_b16 a[178:179], v12 offset:47616
    s_add_u32 m0, s36, 20480
    s_lshl_b32 s45, s62, 7
    s_add_u32 s45, s45, s34
    s_waitcnt vmcnt(20) lgkmcnt(3)
    v_mfma_f32_32x32x16_bf16 v[64:79], a[88:91], a[184:187], v[64:79]
    ds_read_b64_tr_b16 a[180:181], v12 offset:55296
    ds_read_b64_tr_b16 a[182:183], v12 offset:55808
    buffer_load_dwordx4 v8, s[16:19], s45 offen offset:0  lds
    s_add_u32 m0, s35, 20480
    v_mfma_f32_32x32x16_bf16 v[80:95], a[188:191], a[88:91], v[80:95]
    ds_read_b64_tr_b16 a[184:185], v13 offset:47104
    ds_read_b64_tr_b16 a[186:187], v13 offset:47616
    s_mul_i32 s45, s62, 196608
    s_add_u32 s45, s45, s32
    v_mfma_f32_32x32x16_bf16 v[96:111], a[160:163], a[88:91], v[96:111]
    ds_read_b64_tr_b16 a[188:189], v13 offset:55296
    ds_read_b64_tr_b16 a[190:191], v13 offset:55808
    buffer_load_dwordx4 v4, s[12:15], s45 offen offset:0  lds
    v_mfma_f32_32x32x16_bf16 v[112:127], a[164:167], a[88:91], v[112:127]
    s_waitcnt vmcnt(15)
    s_barrier
    v_add_u32 v14, 0xf000, v14
    ds_read_b128 a[160:163], v14 offset:16384
    v_mfma_f32_32x32x16_bf16 v[128:143], a[168:171], a[88:91], v[128:143]
    ds_read_b64_tr_b16 a[164:165], v12 offset:61440
    ds_read_b64_tr_b16 a[166:167], v12 offset:61952
    buffer_load_dwordx4 v5, s[12:15], s45 offen offset:1024  lds
    s_waitcnt lgkmcnt(3)
    v_mfma_f32_32x32x16_bf16 v[64:79], a[92:95], a[172:175], v[64:79]
    v_add_u32 v12, 0xf000, v12
    ds_read_b64_tr_b16 a[168:169], v12 offset:8192
    ds_read_b64_tr_b16 a[170:171], v12 offset:8704
    v_mfma_f32_32x32x16_bf16 v[80:95], a[176:179], a[92:95], v[80:95]
    ds_read_b64_tr_b16 a[172:173], v13 offset:61440
    ds_read_b64_tr_b16 a[174:175], v13 offset:61952
    buffer_load_dwordx4 v6, s[12:15], s45 offen offset:2048  lds
    v_mfma_f32_32x32x16_bf16 v[96:111], a[180:183], a[92:95], v[96:111]
    v_add_u32 v13, 0xf000, v13
    ds_read_b64_tr_b16 a[176:177], v13 offset:8192
    ds_read_b64_tr_b16 a[178:179], v13 offset:8704
    v_mfma_f32_32x32x16_bf16 v[112:127], a[184:187], a[92:95], v[112:127]
    v_add_u32 v15, 0xf000, v15
    ds_read_b128 a[180:183], v15 offset:16384
    buffer_load_dwordx4 v7, s[12:15], s45 offen offset:3072  lds
    s_add_u32 s101, s101, 1
    s_cmp_eq_u32 s101, 10
    s_cselect_b32 s101, 0, s101
    v_mfma_f32_32x32x16_bf16 v[128:143], a[188:191], a[92:95], v[128:143]
    ds_read_b64_tr_b16 a[184:185], v12 offset:2048
    ds_read_b64_tr_b16 a[186:187], v12 offset:2560
    s_lshl_b32 s46, s101, 12
    s_add_u32 s46, s46, s31
    s_waitcnt vmcnt(17) lgkmcnt(3)
    v_mfma_f32_32x32x16_bf16 v[64:79], a[96:99], a[160:163], v[64:79]
    ds_read_b64_tr_b16 a[188:189], v12 offset:10240
    ds_read_b64_tr_b16 a[190:191], v12 offset:10752
    buffer_load_dwordx4 a[128:131], v2, s[8:11], s46 offen offset:0 sc1
    v_mfma_f32_32x32x16_bf16 v[80:95], a[164:167], a[96:99], v[80:95]
    ds_read_b64_tr_b16 a[160:161], v13 offset:2048
    ds_read_b64_tr_b16 a[162:163], v13 offset:2560
    v_mfma_f32_32x32x16_bf16 v[96:111], a[168:171], a[96:99], v[96:111]
    ds_read_b64_tr_b16 a[164:165], v13 offset:10240
    ds_read_b64_tr_b16 a[166:167], v13 offset:10752
    buffer_load_dwordx4 a[132:135], v2, s[8:11], s46 offen offset:1024 sc1
    v_mfma_f32_32x32x16_bf16 v[112:127], a[172:175], a[96:99], v[112:127]
    v_add_u32 v16, 0xf000, v16
    ds_read_b128 a[168:171], v16 offset:16384
    v_mfma_f32_32x32x16_bf16 v[128:143], a[176:179], a[96:99], v[128:143]
    ds_read_b64_tr_b16 a[172:173], v12 offset:4096
    ds_read_b64_tr_b16 a[174:175], v12 offset:4608
    buffer_load_dwordx4 a[136:139], v2, s[8:11], s46 offen offset:2048 sc1
    s_waitcnt vmcnt(19) lgkmcnt(3)
    v_mfma_f32_32x32x16_bf16 v[64:79], a[100:103], a[180:183], v[64:79]
    ds_read_b64_tr_b16 a[176:177], v12 offset:12288
    ds_read_b64_tr_b16 a[178:179], v12 offset:12800
    v_mfma_f32_32x32x16_bf16 v[80:95], a[184:187], a[100:103], v[80:95]
    ds_read_b64_tr_b16 a[180:181], v13 offset:4096
    ds_read_b64_tr_b16 a[182:183], v13 offset:4608
    buffer_load_dwordx4 a[140:143], v2, s[8:11], s46 offen offset:3072 sc1
    s_add_u32 s62, s62, 1
    s_cmp_eq_u32 s62, 10
    s_cselect_b32 s62, 0, s62
    v_mfma_f32_32x32x16_bf16 v[96:111], a[188:191], a[100:103], v[96:111]
    ds_read_b64_tr_b16 a[184:185], v13 offset:12288
    ds_read_b64_tr_b16 a[186:187], v13 offset:12800
    s_add_u32 m0, s36, 40960
    s_lshl_b32 s45, s62, 7
    s_add_u32 s45, s45, s34
    v_mfma_f32_32x32x16_bf16 v[112:127], a[160:163], a[100:103], v[112:127]
    v_add_u32 v17, 0xf000, v17
    ds_read_b128 a[188:191], v17 offset:16384
    buffer_load_dwordx4 v8, s[16:19], s45 offen offset:0  lds
    s_add_u32 m0, s35, 40960
    s_mul_i32 s45, s62, 196608
    v_mfma_f32_32x32x16_bf16 v[128:143], a[164:167], a[100:103], v[128:143]
    ds_read_b64_tr_b16 a[160:161], v12 offset:6144
    ds_read_b64_tr_b16 a[162:163], v12 offset:6656
    s_add_u32 s45, s45, s32
    s_waitcnt vmcnt(20) lgkmcnt(3)
    v_mfma_f32_32x32x16_bf16 v[64:79], a[104:107], a[168:171], v[64:79]
    ds_read_b64_tr_b16 a[164:165], v12 offset:14336
    ds_read_b64_tr_b16 a[166:167], v12 offset:14848
    buffer_load_dwordx4 v4, s[12:15], s45 offen offset:0  lds
    v_mfma_f32_32x32x16_bf16 v[80:95], a[172:175], a[104:107], v[80:95]
    ds_read_b64_tr_b16 a[168:169], v13 offset:6144
    ds_read_b64_tr_b16 a[170:171], v13 offset:6656
    v_mfma_f32_32x32x16_bf16 v[96:111], a[176:179], a[104:107], v[96:111]
    ds_read_b64_tr_b16 a[172:173], v13 offset:14336
    ds_read_b64_tr_b16 a[174:175], v13 offset:14848
    buffer_load_dwordx4 v5, s[12:15], s45 offen offset:1024  lds
    v_mfma_f32_32x32x16_bf16 v[112:127], a[180:183], a[104:107], v[112:127]
    s_waitcnt vmcnt(16)
    s_barrier
    v_add_u32 v14, 0xfffe2000, v14
    ds_read_b128 a[176:179], v14 offset:16384
    v_mfma_f32_32x32x16_bf16 v[128:143], a[184:187], a[104:107], v[128:143]
    v_add_u32 v12, 0xfffe2000, v12
    ds_read_b64_tr_b16 a[180:181], v12 offset:0
    ds_read_b64_tr_b16 a[182:183], v12 offset:512
    buffer_load_dwordx4 v6, s[12:15], s45 offen offset:2048  lds
    s_waitcnt lgkmcnt(3)
    v_mfma_f32_32x32x16_bf16 v[64:79], a[108:111], a[188:191], v[64:79]
    ds_read_b64_tr_b16 a[184:185], v12 offset:8192
    ds_read_b64_tr_b16 a[186:187], v12 offset:8704
    v_mfma_f32_32x32x16_bf16 v[80:95], a[160:163], a[108:111], v[80:95]
    v_add_u32 v13, 0xfffe2000, v13
    ds_read_b64_tr_b16 a[188:189], v13 offset:0
    ds_read_b64_tr_b16 a[190:191], v13 offset:512
    buffer_load_dwordx4 v7, s[12:15], s45 offen offset:3072  lds
    s_add_u32 s101, s101, 1
    v_mfma_f32_32x32x16_bf16 v[96:111], a[164:167], a[108:111], v[96:111]
    ds_read_b64_tr_b16 a[160:161], v13 offset:8192
    ds_read_b64_tr_b16 a[162:163], v13 offset:8704
    s_cmp_eq_u32 s101, 10
    s_cselect_b32 s101, 0, s101
    s_lshl_b32 s46, s101, 12
    v_mfma_f32_32x32x16_bf16 v[112:127], a[168:171], a[108:111], v[112:127]
    v_add_u32 v15, 0xfffe2000, v15
    ds_read_b128 a[164:167], v15 offset:16384
    s_add_u32 s46, s46, s31
    buffer_load_dwordx4 a[144:147], v2, s[8:11], s46 offen offset:0 sc1
    v_mfma_f32_32x32x16_bf16 v[128:143], a[172:175], a[108:111], v[128:143]
    ds_read_b64_tr_b16 a[168:169], v12 offset:2048
    ds_read_b64_tr_b16 a[170:171], v12 offset:2560
    s_waitcnt vmcnt(18) lgkmcnt(3)
    v_mfma_f32_32x32x16_bf16 v[64:79], a[112:115], a[176:179], v[64:79]
    ds_read_b64_tr_b16 a[172:173], v12 offset:10240
    ds_read_b64_tr_b16 a[174:175], v12 offset:10752
    buffer_load_dwordx4 a[148:151], v2, s[8:11], s46 offen offset:1024 sc1
    v_mfma_f32_32x32x16_bf16 v[80:95], a[180:183], a[112:115], v[80:95]
    ds_read_b64_tr_b16 a[176:177], v13 offset:2048
    ds_read_b64_tr_b16 a[178:179], v13 offset:2560
    v_mfma_f32_32x32x16_bf16 v[96:111], a[184:187], a[112:115], v[96:111]
    ds_read_b64_tr_b16 a[180:181], v13 offset:10240
    ds_read_b64_tr_b16 a[182:183], v13 offset:10752
    buffer_load_dwordx4 a[152:155], v2, s[8:11], s46 offen offset:2048 sc1
    v_mfma_f32_32x32x16_bf16 v[112:127], a[188:191], a[112:115], v[112:127]
    v_add_u32 v16, 0xfffe2000, v16
    ds_read_b128 a[184:187], v16 offset:16384
    v_mfma_f32_32x32x16_bf16 v[128:143], a[160:163], a[112:115], v[128:143]
    ds_read_b64_tr_b16 a[188:189], v12 offset:4096
    ds_read_b64_tr_b16 a[190:191], v12 offset:4608
    buffer_load_dwordx4 a[156:159], v2, s[8:11], s46 offen offset:3072 sc1
    s_add_u32 s62, s62, 1
    s_cmp_eq_u32 s62, 10
    s_cselect_b32 s62, 0, s62
    s_waitcnt vmcnt(20) lgkmcnt(3)
    v_mfma_f32_32x32x16_bf16 v[64:79], a[116:119], a[164:167], v[64:79]
    ds_read_b64_tr_b16 a[160:161], v12 offset:12288
    ds_read_b64_tr_b16 a[162:163], v12 offset:12800
    s_add_u32 m0, s35, 61440
    s_mul_i32 s45, s62, 196608
    v_mfma_f32_32x32x16_bf16 v[80:95], a[168:171], a[116:119], v[80:95]
    ds_read_b64_tr_b16 a[164:165], v13 offset:4096
    ds_read_b64_tr_b16 a[166:167], v13 offset:4608
    s_add_u32 s45, s45, s33
    buffer_load_dwordx4 v4, s[12:15], s45 offen offset:0  lds
    v_mfma_f32_32x32x16_bf16 v[96:111], a[172:175], a[116:119], v[96:111]
    ds_read_b64_tr_b16 a[168:169], v13 offset:12288
    ds_read_b64_tr_b16 a[170:171], v13 offset:12800
    v_mfma_f32_32x32x16_bf16 v[112:127], a[176:179], a[116:119], v[112:127]
    v_add_u32 v17, 0xfffe2000, v17
    ds_read_b128 a[172:175], v17 offset:16384
    buffer_load_dwordx4 v5, s[12:15], s45 offen offset:1024  lds
    v_mfma_f32_32x32x16_bf16 v[128:143], a[180:183], a[116:119], v[128:143]
    ds_read_b64_tr_b16 a[176:177], v12 offset:6144
    ds_read_b64_tr_b16 a[178:179], v12 offset:6656
    s_waitcnt vmcnt(21) lgkmcnt(3)
    v_mfma_f32_32x32x16_bf16 v[64:79], a[120:123], a[184:187], v[64:79]
    ds_read_b64_tr_b16 a[180:181], v12 offset:14336
    ds_read_b64_tr_b16 a[182:183], v12 offset:14848
    buffer_load_dwordx4 v6, s[12:15], s45 offen offset:2048  lds
    v_mfma_f32_32x32x16_bf16 v[80:95], a[188:191], a[120:123], v[80:95]
    ds_read_b64_tr_b16 a[184:185], v13 offset:6144
    ds_read_b64_tr_b16 a[186:187], v13 offset:6656
    v_mfma_f32_32x32x16_bf16 v[96:111], a[160:163], a[120:123], v[96:111]
    ds_read_b64_tr_b16 a[188:189], v13 offset:14336
    ds_read_b64_tr_b16 a[190:191], v13 offset:14848
    buffer_load_dwordx4 v7, s[12:15], s45 offen offset:3072  lds
    s_add_u32 s62, s62, 1
    s_cmp_eq_u32 s62, 10
    s_cselect_b32 s62, 0, s62
    v_mfma_f32_32x32x16_bf16 v[112:127], a[164:167], a[120:123], v[112:127]
    s_waitcnt vmcnt(17)
    s_barrier
    ds_read_b128 a[160:163], v14 offset:36864
    s_add_u32 m0, s35, 81920
    s_mul_i32 s45, s62, 196608
    v_mfma_f32_32x32x16_bf16 v[128:143], a[168:171], a[120:123], v[128:143]
    ds_read_b64_tr_b16 a[164:165], v12 offset:20480
    ds_read_b64_tr_b16 a[166:167], v12 offset:20992
    s_add_u32 s45, s45, s33
    buffer_load_dwordx4 v4, s[12:15], s45 offen offset:0  lds
    s_waitcnt lgkmcnt(3)
    v_mfma_f32_32x32x16_bf16 v[64:79], a[124:127], a[172:175], v[64:79]
    ds_read_b64_tr_b16 a[168:169], v12 offset:28672
    ds_read_b64_tr_b16 a[170:171], v12 offset:29184
    v_mfma_f32_32x32x16_bf16 v[80:95], a[176:179], a[124:127], v[80:95]
    ds_read_b64_tr_b16 a[172:173], v13 offset:20480
    ds_read_b64_tr_b16 a[174:175], v13 offset:20992
    buffer_load_dwordx4 v5, s[12:15], s45 offen offset:1024  lds
    v_mfma_f32_32x32x16_bf16 v[96:111], a[180:183], a[124:127], v[96:111]
    ds_read_b64_tr_b16 a[176:177], v13 offset:28672
    ds_read_b64_tr_b16 a[178:179], v13 offset:29184
    v_mfma_f32_32x32x16_bf16 v[112:127], a[184:187], a[124:127], v[112:127]
    ds_read_b128 a[180:183], v15 offset:36864
    buffer_load_dwordx4 v6, s[12:15], s45 offen offset:2048  lds
    v_mfma_f32_32x32x16_bf16 v[128:143], a[188:191], a[124:127], v[128:143]
    ds_read_b64_tr_b16 a[184:185], v12 offset:22528
    ds_read_b64_tr_b16 a[186:187], v12 offset:23040
    s_waitcnt vmcnt(19) lgkmcnt(3)
    v_mfma_f32_32x32x16_bf16 v[64:79], a[128:131], a[160:163], v[64:79]
    ds_read_b64_tr_b16 a[188:189], v12 offset:30720
    ds_read_b64_tr_b16 a[190:191], v12 offset:31232
    buffer_load_dwordx4 v7, s[12:15], s45 offen offset:3072  lds
    s_add_u32 s62, s62, 1
    v_mfma_f32_32x32x16_bf16 v[80:95], a[164:167], a[128:131], v[80:95]
    ds_read_b64_tr_b16 a[160:161], v13 offset:22528
    ds_read_b64_tr_b16 a[162:163], v13 offset:23040
    s_cmp_eq_u32 s62, 10
    s_cselect_b32 s62, 0, s62
    s_add_u32 m0, s35, 102400
    v_mfma_f32_32x32x16_bf16 v[96:111], a[168:171], a[128:131], v[96:111]
    ds_read_b64_tr_b16 a[164:165], v13 offset:30720
    ds_read_b64_tr_b16 a[166:167], v13 offset:31232
    s_mul_i32 s45, s62, 196608
    s_add_u32 s45, s45, s33
    buffer_load_dwordx4 v4, s[12:15], s45 offen offset:0  lds
    v_mfma_f32_32x32x16_bf16 v[112:127], a[172:175], a[128:131], v[112:127]
    ds_read_b128 a[168:171], v16 offset:36864
    v_mfma_f32_32x32x16_bf16 v[128:143], a[176:179], a[128:131], v[128:143]
    ds_read_b64_tr_b16 a[172:173], v12 offset:24576
    ds_read_b64_tr_b16 a[174:175], v12 offset:25088
    buffer_load_dwordx4 v5, s[12:15], s45 offen offset:1024  lds
    s_waitcnt vmcnt(21) lgkmcnt(3)
    v_mfma_f32_32x32x16_bf16 v[64:79], a[132:135], a[180:183], v[64:79]
    ds_read_b64_tr_b16 a[176:177], v12 offset:32768
    ds_read_b64_tr_b16 a[178:179], v12 offset:33280
    v_mfma_f32_32x32x16_bf16 v[80:95], a[184:187], a[132:135], v[80:95]
    ds_read_b64_tr_b16 a[180:181], v13 offset:24576
    ds_read_b64_tr_b16 a[182:183], v13 offset:25088
    buffer_load_dwordx4 v6, s[12:15], s45 offen offset:2048  lds
    v_mfma_f32_32x32x16_bf16 v[96:111], a[188:191], a[132:135], v[96:111]
    ds_read_b64_tr_b16 a[184:185], v13 offset:32768
    ds_read_b64_tr_b16 a[186:187], v13 offset:33280
    v_mfma_f32_32x32x16_bf16 v[112:127], a[160:163], a[132:135], v[112:127]
    ds_read_b128 a[188:191], v17 offset:36864
    buffer_load_dwordx4 v7, s[12:15], s45 offen offset:3072  lds
    s_add_u32 s62, s62, 1
    s_cmp_eq_u32 s62, 10
    s_cselect_b32 s62, 0, s62
    v_mfma_f32_32x32x16_bf16 v[128:143], a[164:167], a[132:135], v[128:143]
    ds_read_b64_tr_b16 a[160:161], v12 offset:26624
    ds_read_b64_tr_b16 a[162:163], v12 offset:27136
    s_add_u32 m0, s35, 122880
    s_mul_i32 s45, s62, 196608
    s_add_u32 s45, s45, s33
    s_and_b32 s6, s2, 7
    s_lshl_b32 s6, s6, 10
    s_add_u32 s6, s6, 0x11f0000
    buffer_load_dwordx4 v[248:251], v2, s[8:11], s6 offen sc1
    s_waitcnt vmcnt(23) lgkmcnt(3)
    v_mfma_f32_32x32x16_bf16 v[64:79], a[136:139], a[168:171], v[64:79]
    ds_read_b64_tr_b16 a[164:165], v12 offset:34816
    ds_read_b64_tr_b16 a[166:167], v12 offset:35328
    buffer_load_dwordx4 v4, s[12:15], s45 offen offset:0  lds
    s_mov_b32 s16, s64
    v_mfma_f32_32x32x16_bf16 v[80:95], a[172:175], a[136:139], v[80:95]
    ds_read_b64_tr_b16 a[168:169], v13 offset:26624
    ds_read_b64_tr_b16 a[170:171], v13 offset:27136
    s_mov_b32 s17, s65
    s_mov_b32 s24, s66
    s_mov_b32 s25, s67
    v_mfma_f32_32x32x16_bf16 v[96:111], a[176:179], a[136:139], v[96:111]
    ds_read_b64_tr_b16 a[172:173], v13 offset:34816
    ds_read_b64_tr_b16 a[174:175], v13 offset:35328
    buffer_load_dwordx4 v5, s[12:15], s45 offen offset:1024  lds
    s_mov_b32 s30, s68
    s_mov_b32 s31, s69
    v_mfma_f32_32x32x16_bf16 v[112:127], a[180:183], a[136:139], v[112:127]
    s_waitcnt vmcnt(19)
    s_barrier
    ds_read_b128 a[176:179], v14 offset:57344
    s_mov_b32 s18, 2621440
    s_mov_b32 s19, 0x20000
    v_mfma_f32_32x32x16_bf16 v[128:143], a[184:187], a[136:139], v[128:143]
    ds_read_b64_tr_b16 a[180:181], v12 offset:40960
    ds_read_b64_tr_b16 a[182:183], v12 offset:41472
    buffer_load_dwordx4 v6, s[12:15], s45 offen offset:2048  lds
    s_mov_b32 s26, 1280
    s_mov_b32 s27, 0x20000
    s_waitcnt lgkmcnt(3)
    v_mfma_f32_32x32x16_bf16 v[64:79], a[140:143], a[188:191], v[64:79]
    ds_read_b64_tr_b16 a[184:185], v12 offset:49152
    ds_read_b64_tr_b16 a[186:187], v12 offset:49664
    v_mfma_f32_32x32x16_bf16 v[80:95], a[160:163], a[140:143], v[80:95]
    ds_read_b64_tr_b16 a[188:189], v13 offset:40960
    ds_read_b64_tr_b16 a[190:191], v13 offset:41472
    buffer_load_dwordx4 v7, s[12:15], s45 offen offset:3072  lds
    s_add_u32 s62, s62, 1
    s_cmp_eq_u32 s62, 10
    s_cselect_b32 s62, 0, s62
    v_mfma_f32_32x32x16_bf16 v[96:111], a[164:167], a[140:143], v[96:111]
    ds_read_b64_tr_b16 a[160:161], v13 offset:49152
    ds_read_b64_tr_b16 a[162:163], v13 offset:49664
    s_add_u32 m0, s35, 0
    s_mul_i32 s45, s62, 196608
    s_add_u32 s45, s45, s33
    v_mfma_f32_32x32x16_bf16 v[112:127], a[168:171], a[140:143], v[112:127]
    ds_read_b128 a[164:167], v15 offset:57344
    buffer_load_dwordx4 v4, s[12:15], s45 offen offset:0  lds
    v_mfma_f32_32x32x16_bf16 v[128:143], a[172:175], a[140:143], v[128:143]
    ds_read_b64_tr_b16 a[168:169], v12 offset:43008
    ds_read_b64_tr_b16 a[170:171], v12 offset:43520
    s_waitcnt vmcnt(21) lgkmcnt(3)
    v_mfma_f32_32x32x16_bf16 v[64:79], a[144:147], a[176:179], v[64:79]
    ds_read_b64_tr_b16 a[172:173], v12 offset:51200
    ds_read_b64_tr_b16 a[174:175], v12 offset:51712
    buffer_load_dwordx4 v5, s[12:15], s45 offen offset:1024  lds
    v_mfma_f32_32x32x16_bf16 v[80:95], a[180:183], a[144:147], v[80:95]
    ds_read_b64_tr_b16 a[176:177], v13 offset:43008
    ds_read_b64_tr_b16 a[178:179], v13 offset:43520
    v_mfma_f32_32x32x16_bf16 v[96:111], a[184:187], a[144:147], v[96:111]
    ds_read_b64_tr_b16 a[180:181], v13 offset:51200
    ds_read_b64_tr_b16 a[182:183], v13 offset:51712
    buffer_load_dwordx4 v6, s[12:15], s45 offen offset:2048  lds
    v_mfma_f32_32x32x16_bf16 v[112:127], a[188:191], a[144:147], v[112:127]
    ds_read_b128 a[184:187], v16 offset:57344
    v_mfma_f32_32x32x16_bf16 v[128:143], a[160:163], a[144:147], v[128:143]
    ds_read_b64_tr_b16 a[188:189], v12 offset:45056
    ds_read_b64_tr_b16 a[190:191], v12 offset:45568
    buffer_load_dwordx4 v7, s[12:15], s45 offen offset:3072  lds
    s_waitcnt vmcnt(23) lgkmcnt(3)
    v_mfma_f32_32x32x16_bf16 v[64:79], a[148:151], a[164:167], v[64:79]
    ds_read_b64_tr_b16 a[160:161], v12 offset:53248
    ds_read_b64_tr_b16 a[162:163], v12 offset:53760
    v_mfma_f32_32x32x16_bf16 v[80:95], a[168:171], a[148:151], v[80:95]
    ds_read_b64_tr_b16 a[164:165], v13 offset:45056
    ds_read_b64_tr_b16 a[166:167], v13 offset:45568
    v_mfma_f32_32x32x16_bf16 v[96:111], a[172:175], a[148:151], v[96:111]
    ds_read_b64_tr_b16 a[168:169], v13 offset:53248
    ds_read_b64_tr_b16 a[170:171], v13 offset:53760
    v_mfma_f32_32x32x16_bf16 v[112:127], a[176:179], a[148:151], v[112:127]
    ds_read_b128 a[172:175], v17 offset:57344
    v_mfma_f32_32x32x16_bf16 v[128:143], a[180:183], a[148:151], v[128:143]
    ds_read_b64_tr_b16 a[176:177], v12 offset:47104
    ds_read_b64_tr_b16 a[178:179], v12 offset:47616
    s_waitcnt vmcnt(22) lgkmcnt(3)
    v_mfma_f32_32x32x16_bf16 v[64:79], a[152:155], a[184:187], v[64:79]
    ds_read_b64_tr_b16 a[180:181], v12 offset:55296
    ds_read_b64_tr_b16 a[182:183], v12 offset:55808
    s_waitcnt vmcnt(8)
    v_xor_b32 v248, s43, v248
    v_xor_b32 v249, s43, v249
    v_mfma_f32_32x32x16_bf16 v[80:95], a[188:191], a[152:155], v[80:95]
    ds_read_b64_tr_b16 a[184:185], v13 offset:47104
    ds_read_b64_tr_b16 a[186:187], v13 offset:47616
    v_xor_b32 v250, s43, v250
    v_xor_b32 v251, s43, v251
    v_or3_b32 v248, v248, v249, v250
    v_mfma_f32_32x32x16_bf16 v[96:111], a[160:163], a[152:155], v[96:111]
    ds_read_b64_tr_b16 a[188:189], v13 offset:55296
    ds_read_b64_tr_b16 a[190:191], v13 offset:55808
    v_or_b32 v248, v248, v251
    v_cmp_ne_u32 vcc, 0, v248
    s_cbranch_vccnz PFP_retry
PFP_back:
    v_mfma_f32_32x32x16_bf16 v[112:127], a[164:167], a[152:155], v[112:127]
    s_barrier
    ds_read_b64_tr_b16 a[160:161], v12 offset:61440
    ds_read_b64_tr_b16 a[162:163], v12 offset:61952
    s_add_u32 s62, s62, 1
    v_mfma_f32_32x32x16_bf16 v[128:143], a[168:171], a[152:155], v[128:143]
    v_add_u32 v12, 0xf000, v12
    ds_read_b64_tr_b16 a[164:165], v12 offset:8192
    ds_read_b64_tr_b16 a[166:167], v12 offset:8704
    s_cmp_eq_u32 s62, 10
    s_cselect_b32 s62, 0, s62
    s_waitcnt lgkmcnt(4)
    v_mfma_f32_32x32x16_bf16 v[64:79], a[156:159], a[172:175], v[64:79]
    ds_read_b64_tr_b16 a[168:169], v13 offset:61440
    ds_read_b64_tr_b16 a[170:171], v13 offset:61952
    s_add_u32 m0, s35, 20480
    s_mul_i32 s45, s62, 196608
    v_mfma_f32_32x32x16_bf16 v[80:95], a[176:179], a[156:159], v[80:95]
    v_add_u32 v13, 0xf000, v13
    ds_read_b64_tr_b16 a[172:173], v13 offset:8192
    ds_read_b64_tr_b16 a[174:175], v13 offset:8704
    s_add_u32 s45, s45, s33
    buffer_load_dwordx4 v4, s[12:15], s45 offen offset:0  lds
    v_mfma_f32_32x32x16_bf16 v[96:111], a[180:183], a[156:159], v[96:111]
    ds_read_b64_tr_b16 a[176:177], v12 offset:2048
    ds_read_b64_tr_b16 a[178:179], v12 offset:2560
    v_mfma_f32_32x32x16_bf16 v[112:127], a[184:187], a[156:159], v[112:127]
    ds_read_b64_tr_b16 a[180:181], v12 offset:10240
    ds_read_b64_tr_b16 a[182:183], v12 offset:10752
    buffer_load_dwordx4 v5, s[12:15], s45 offen offset:1024  lds
    v_mfma_f32_32x32x16_bf16 v[128:143], a[188:191], a[156:159], v[128:143]
    ds_read_b64_tr_b16 a[184:185], v13 offset:2048
    ds_read_b64_tr_b16 a[186:187], v13 offset:2560
    s_waitcnt lgkmcnt(6)
    v_mfma_f32_32x32x16_bf16 v[144:159], a[160:163], a[0:3], 0
    ds_read_b64_tr_b16 a[188:189], v13 offset:10240
    ds_read_b64_tr_b16 a[190:191], v13 offset:10752
    buffer_load_dwordx4 v6, s[12:15], s45 offen offset:2048  lds
    v_mfma_f32_32x32x16_bf16 v[160:175], a[164:167], a[0:3], 0
    ds_read_b64_tr_b16 a[160:161], v12 offset:4096
    ds_read_b64_tr_b16 a[162:163], v12 offset:4608
    v_fma_f32 v209, v32, v64, v65
    v_fmac_f32_dpp v209, v64, -v33 row_ror:8 row_mask:0xf bank_mask:0xf
    v_fma_f32 v208, v32, v209, v66
    s_nop 0
    v_fmac_f32_dpp v208, v209, -v33 row_ror:8 row_mask:0xf bank_mask:0xf
    v_mfma_f32_32x32x16_bf16 v[176:191], a[168:171], a[0:3], 0
    ds_read_b64_tr_b16 a[164:165], v12 offset:12288
    ds_read_b64_tr_b16 a[166:167], v12 offset:12800
    v_fma_f32 v209, v32, v208, v67
    v_fmac_f32_dpp v209, v208, -v33 row_ror:8 row_mask:0xf bank_mask:0xf
    v_fma_f32 v208, v32, v209, v68
    s_nop 0
    v_fmac_f32_dpp v208, v209, -v33 row_ror:8 row_mask:0xf bank_mask:0xf
    v_fma_f32 v209, v32, v208, v69
    s_nop 0
    v_fmac_f32_dpp v209, v208, -v33 row_ror:8 row_mask:0xf bank_mask:0xf
    v_fma_f32 v208, v32, v209, v70
    s_nop 0
    v_fmac_f32_dpp v208, v209, -v33 row_ror:8 row_mask:0xf bank_mask:0xf
    v_fma_f32 v209, v32, v208, v71
    s_nop 0
    v_fmac_f32_dpp v209, v208, -v33 row_ror:8 row_mask:0xf bank_mask:0xf
    buffer_load_dwordx4 v7, s[12:15], s45 offen offset:3072  lds
    v_mfma_f32_32x32x16_bf16 v[192:207], a[172:175], a[0:3], 0
    ds_read_b64_tr_b16 a[168:169], v13 offset:4096
    ds_read_b64_tr_b16 a[170:171], v13 offset:4608
    v_fma_f32 v208, v32, v209, v72
    v_fmac_f32_dpp v208, v209, -v33 row_ror:8 row_mask:0xf bank_mask:0xf
    v_fma_f32 v209, v32, v208, v73
    s_nop 0
    v_fmac_f32_dpp v209, v208, -v33 row_ror:8 row_mask:0xf bank_mask:0xf
    v_fma_f32 v208, v32, v209, v74
    s_nop 0
    v_fmac_f32_dpp v208, v209, -v33 row_ror:8 row_mask:0xf bank_mask:0xf
    v_fma_f32 v209, v32, v208, v75
    s_nop 0
    v_fmac_f32_dpp v209, v208, -v33 row_ror:8 row_mask:0xf bank_mask:0xf
    v_fma_f32 v208, v32, v209, v76
    s_nop 0
    v_fmac_f32_dpp v208, v209, -v33 row_ror:8 row_mask:0xf bank_mask:0xf
    s_waitcnt lgkmcnt(6)
    v_mfma_f32_32x32x16_bf16 v[144:159], a[176:179], a[4:7], v[144:159]
    ds_read_b64_tr_b16 a[172:173], v13 offset:12288
    ds_read_b64_tr_b16 a[174:175], v13 offset:12800
    v_fma_f32 v209, v32, v208, v77
    v_fmac_f32_dpp v209, v208, -v33 row_ror:8 row_mask:0xf bank_mask:0xf
    v_fma_f32 v208, v32, v209, v78
    s_nop 0
    v_fmac_f32_dpp v208, v209, -v33 row_ror:8 row_mask:0xf bank_mask:0xf
    v_fma_f32 v209, v32, v208, v79
    s_nop 0
    v_fmac_f32_dpp v209, v208, -v33 row_ror:8 row_mask:0xf bank_mask:0xf
    v_mul_f32 v208, v34, v209
    s_nop 0
    v_fmac_f32_dpp v208, v209, v35 row_ror:8 row_mask:0xf bank_mask:0xf
    ds_write_b32 v18, v208 offset:0
    v_mfma_f32_32x32x16_bf16 v[160:175], a[180:183], a[4:7], v[160:175]
    ds_read_b64_tr_b16 a[176:177], v12 offset:6144
    ds_read_b64_tr_b16 a[178:179], v12 offset:6656
    s_waitcnt lgkmcnt(2)
    s_barrier
    ds_read_b128 v[216:219], v19
    ds_read_b128 v[220:223], v19 offset:16
    s_waitcnt lgkmcnt(1)
    v_fma_f32 v210, v48, v216, v217
    v_fmac_f32_dpp v210, v216, v49 row_ror:8 row_mask:0xf bank_mask:0xf
    v_fma_f32 v208, v48, v210, v218
    s_nop 0
    v_fmac_f32_dpp v208, v210, v49 row_ror:8 row_mask:0xf bank_mask:0xf
    v_fma_f32 v210, v48, v208, v219
    s_nop 0
    v_fmac_f32_dpp v210, v208, v49 row_ror:8 row_mask:0xf bank_mask:0xf
    v_mfma_f32_32x32x16_bf16 v[176:191], a[184:187], a[4:7], v[176:191]
    ds_read_b64_tr_b16 a[180:181], v12 offset:14336
    ds_read_b64_tr_b16 a[182:183], v12 offset:14848
    s_waitcnt lgkmcnt(2)
    v_fma_f32 v208, v48, v210, v220
    v_fmac_f32_dpp v208, v210, v49 row_ror:8 row_mask:0xf bank_mask:0xf
    v_fma_f32 v210, v48, v208, v221
    s_nop 0
    v_fmac_f32_dpp v210, v208, v49 row_ror:8 row_mask:0xf bank_mask:0xf
    v_fma_f32 v208, v48, v210, v222
    s_nop 0
    v_fmac_f32_dpp v208, v210, v49 row_ror:8 row_mask:0xf bank_mask:0xf
    v_fma_f32 v210, v48, v208, v223
    s_nop 0
    v_fmac_f32_dpp v210, v208, v49 row_ror:8 row_mask:0xf bank_mask:0xf
    v_mov_b32 v211, s43
    buffer_store_dwordx2 v[210:211], v24, s[20:23], 0 offen sc1
    v_mfma_f32_32x32x16_bf16 v[192:207], a[188:191], a[4:7], v[192:207]
    ds_read_b64_tr_b16 a[184:185], v13 offset:6144
    ds_read_b64_tr_b16 a[186:187], v13 offset:6656
    v_mul_f32 v212, v34, v64
    v_fmac_f32_dpp v212, v64, v35 row_ror:8 row_mask:0xf bank_mask:0xf
    v_mul_f32 v64, v34, v65
    v_fmac_f32_dpp v64, v65, v35 row_ror:8 row_mask:0xf bank_mask:0xf
    v_mfma_f32_32x32x16_bf16 v[144:159], a[160:163], a[8:11], v[144:159]
    ds_read_b64_tr_b16 a[188:189], v13 offset:14336
    ds_read_b64_tr_b16 a[190:191], v13 offset:14848
    v_mul_f32 v65, v34, v66
    v_fmac_f32_dpp v65, v66, v35 row_ror:8 row_mask:0xf bank_mask:0xf
    v_mul_f32 v66, v34, v67
    s_add_u32 s54, s50, 0
    buffer_load_dwordx4 a[192:195], v2, s[8:11], s54 offen offset:0 sc1
    v_mfma_f32_32x32x16_bf16 v[160:175], a[164:167], a[8:11], v[160:175]
    s_barrier
    ds_read_b64_tr_b16 a[160:161], v12 offset:20480
    ds_read_b64_tr_b16 a[162:163], v12 offset:20992
    s_add_u32 s62, s62, 1
    s_cmp_eq_u32 s62, 10
    s_cselect_b32 s62, 0, s62
    v_mfma_f32_32x32x16_bf16 v[176:191], a[168:171], a[8:11], v[176:191]
    ds_read_b64_tr_b16 a[164:165], v12 offset:28672
    ds_read_b64_tr_b16 a[166:167], v12 offset:29184
    s_add_u32 m0, s35, 40960
    s_mul_i32 s45, s62, 196608
    s_add_u32 s45, s45, s33
    buffer_load_dwordx4 v4, s[12:15], s45 offen offset:0  lds
    v_mfma_f32_32x32x16_bf16 v[192:207], a[172:175], a[8:11], v[192:207]
    ds_read_b64_tr_b16 a[168:169], v13 offset:20480
    ds_read_b64_tr_b16 a[170:171], v13 offset:20992
    v_fmac_f32_dpp v66, v67, v35 row_ror:8 row_mask:0xf bank_mask:0xf
    v_mul_f32 v67, v34, v68
    v_fmac_f32_dpp v67, v68, v35 row_ror:8 row_mask:0xf bank_mask:0xf
    v_mul_f32 v68, v34, v69
    s_waitcnt lgkmcnt(6)
    v_mfma_f32_32x32x16_bf16 v[144:159], a[176:179], a[12:15], v[144:159]
    ds_read_b64_tr_b16 a[172:173], v13 offset:28672
    ds_read_b64_tr_b16 a[174:175], v13 offset:29184
    buffer_load_dwordx4 v5, s[12:15], s45 offen offset:1024  lds
    v_fmac_f32_dpp v68, v69, v35 row_ror:8 row_mask:0xf bank_mask:0xf
    v_mul_f32 v69, v34, v70
    v_mfma_f32_32x32x16_bf16 v[160:175], a[180:183], a[12:15], v[160:175]
    ds_read_b64_tr_b16 a[176:177], v12 offset:22528
    ds_read_b64_tr_b16 a[178:179], v12 offset:23040
    v_fmac_f32_dpp v69, v70, v35 row_ror:8 row_mask:0xf bank_mask:0xf
    v_mul_f32 v70, v34, v71
    v_fmac_f32_dpp v70, v71, v35 row_ror:8 row_mask:0xf bank_mask:0xf
    v_mul_f32 v71, v34, v72
    v_mfma_f32_32x32x16_bf16 v[176:191], a[184:187], a[12:15], v[176:191]
    ds_read_b64_tr_b16 a[180:181], v12 offset:30720
    ds_read_b64_tr_b16 a[182:183], v12 offset:31232
    buffer_load_dwordx4 v6, s[12:15], s45 offen offset:2048  lds
    v_fmac_f32_dpp v71, v72, v35 row_ror:8 row_mask:0xf bank_mask:0xf
    v_mul_f32 v72, v34, v73
    v_fmac_f32_dpp v72, v73, v35 row_ror:8 row_mask:0xf bank_mask:0xf
    v_mfma_f32_32x32x16_bf16 v[192:207], a[188:191], a[12:15], v[192:207]
    ds_read_b64_tr_b16 a[184:185], v13 offset:22528
    ds_read_b64_tr_b16 a[186:187], v13 offset:23040
    v_mul_f32 v73, v34, v74
    v_fmac_f32_dpp v73, v74, v35 row_ror:8 row_mask:0xf bank_mask:0xf
    v_mul_f32 v74, v34, v75
    v_fmac_f32_dpp v74, v75, v35 row_ror:8 row_mask:0xf bank_mask:0xf
    s_waitcnt lgkmcnt(6)
    v_mfma_f32_32x32x16_bf16 v[144:159], a[160:163], a[16:19], v[144:159]
    ds_read_b64_tr_b16 a[188:189], v13 offset:30720
    ds_read_b64_tr_b16 a[190:191], v13 offset:31232
    buffer_load_dwordx4 v7, s[12:15], s45 offen offset:3072  lds
    v_mul_f32 v75, v34, v76
    v_fmac_f32_dpp v75, v76, v35 row_ror:8 row_mask:0xf bank_mask:0xf
    v_mfma_f32_32x32x16_bf16 v[160:175], a[164:167], a[16:19], v[160:175]
    ds_read_b64_tr_b16 a[160:161], v12 offset:24576
    ds_read_b64_tr_b16 a[162:163], v12 offset:25088
    v_mul_f32 v76, v34, v77
    v_fmac_f32_dpp v76, v77, v35 row_ror:8 row_mask:0xf bank_mask:0xf
    v_mul_f32 v77, v34, v78
    v_fmac_f32_dpp v77, v78, v35 row_ror:8 row_mask:0xf bank_mask:0xf
    v_mfma_f32_32x32x16_bf16 v[176:191], a[168:171], a[16:19], v[176:191]
    ds_read_b64_tr_b16 a[164:165], v12 offset:32768
    ds_read_b64_tr_b16 a[166:167], v12 offset:33280
    v_mul_f32 v78, v34, v79
    v_fmac_f32_dpp v78, v79, v35 row_ror:8 row_mask:0xf bank_mask:0xf
    s_add_u32 s47, s39, 0
    v_mul_f32 v96, v80, v96
    buffer_load_dwordx4 a[196:199], v2, s[8:11], s54 offen offset:1024 sc1
    v_mfma_f32_32x32x16_bf16 v[192:207], a[172:175], a[16:19], v[192:207]
    ds_read_b64_tr_b16 a[168:169], v13 offset:24576
    ds_read_b64_tr_b16 a[170:171], v13 offset:25088
    v_mul_f32 v97, v81, v97
    v_mul_f32 v98, v82, v98
    v_mul_f32 v99, v83, v99
    v_mul_f32 v100, v84, v100
    s_waitcnt lgkmcnt(6)
    v_mfma_f32_32x32x16_bf16 v[144:159], a[176:179], a[20:23], v[144:159]
    ds_read_b64_tr_b16 a[172:173], v13 offset:32768
    ds_read_b64_tr_b16 a[174:175], v13 offset:33280
    v_mul_f32 v101, v85, v101
    v_mul_f32 v102, v86, v102
    v_mul_f32 v103, v87, v103
    buffer_load_dwordx4 a[200:203], v2, s[8:11], s54 offen offset:2048 sc1
    v_mfma_f32_32x32x16_bf16 v[160:175], a[180:183], a[20:23], v[160:175]
    ds_read_b64_tr_b16 a[176:177], v12 offset:26624
    ds_read_b64_tr_b16 a[178:179], v12 offset:27136
    v_mul_f32 v80, s42, v80
    v_mul_f32 v81, s42, v81
    v_mul_f32 v82, s42, v82
    v_mul_f32 v83, s42, v83
    v_mfma_f32_32x32x16_bf16 v[176:191], a[184:187], a[20:23], v[176:191]
    ds_read_b64_tr_b16 a[180:181], v12 offset:34816
    ds_read_b64_tr_b16 a[182:183], v12 offset:35328
    v_mul_f32 v84, s42, v84
    v_mul_f32 v85, s42, v85
    v_mul_f32 v86, s42, v86
    v_mul_f32 v87, s42, v87
    buffer_load_dwordx4 a[204:207], v2, s[8:11], s54 offen offset:3072 sc1
    v_mfma_f32_32x32x16_bf16 v[192:207], a[188:191], a[20:23], v[192:207]
    ds_read_b64_tr_b16 a[184:185], v13 offset:26624
    ds_read_b64_tr_b16 a[186:187], v13 offset:27136
    v_exp_f32 v80, v80
    v_exp_f32 v81, v81
    s_waitcnt lgkmcnt(6)
    v_mfma_f32_32x32x16_bf16 v[144:159], a[160:163], a[24:27], v[144:159]
    ds_read_b64_tr_b16 a[188:189], v13 offset:34816
    ds_read_b64_tr_b16 a[190:191], v13 offset:35328
    v_exp_f32 v82, v82
    buffer_load_dwordx4 a[208:211], v3, s[8:11], s54 offen offset:0 sc1
    v_mfma_f32_32x32x16_bf16 v[160:175], a[164:167], a[24:27], v[160:175]
    s_barrier
    ds_read_b64_tr_b16 a[160:161], v12 offset:40960
    ds_read_b64_tr_b16 a[162:163], v12 offset:41472
    s_add_u32 s62, s62, 1
    s_cmp_eq_u32 s62, 10
    s_cselect_b32 s62, 0, s62
    v_mfma_f32_32x32x16_bf16 v[176:191], a[168:171], a[24:27], v[176:191]
    ds_read_b64_tr_b16 a[164:165], v12 offset:49152
    ds_read_b64_tr_b16 a[166:167], v12 offset:49664
    s_add_u32 m0, s35, 61440
    s_mul_i32 s45, s62, 196608
    s_add_u32 s45, s45, s33
    buffer_load_dwordx4 v4, s[12:15], s45 offen offset:0  lds
    v_mfma_f32_32x32x16_bf16 v[192:207], a[172:175], a[24:27], v[192:207]
    ds_read_b64_tr_b16 a[168:169], v13 offset:40960
    ds_read_b64_tr_b16 a[170:171], v13 offset:41472
    v_exp_f32 v83, v83
    v_exp_f32 v84, v84
    s_waitcnt lgkmcnt(6)
    v_mfma_f32_32x32x16_bf16 v[144:159], a[176:179], a[28:31], v[144:159]
    ds_read_b64_tr_b16 a[172:173], v13 offset:49152
    ds_read_b64_tr_b16 a[174:175], v13 offset:49664
    buffer_load_dwordx4 v5, s[12:15], s45 offen offset:1024  lds
    v_exp_f32 v85, v85
    v_mfma_f32_32x32x16_bf16 v[160:175], a[180:183], a[28:31], v[160:175]
    ds_read_b64_tr_b16 a[176:177], v12 offset:43008
    ds_read_b64_tr_b16 a[178:179], v12 offset:43520
    v_exp_f32 v86, v86
    v_exp_f32 v87, v87
    v_mfma_f32_32x32x16_bf16 v[176:191], a[184:187], a[28:31], v[176:191]
    ds_read_b64_tr_b16 a[180:181], v12 offset:51200
    ds_read_b64_tr_b16 a[182:183], v12 offset:51712
    buffer_load_dwordx4 v6, s[12:15], s45 offen offset:2048  lds
    v_add_f32 v80, 1.0, v80
    v_add_f32 v81, 1.0, v81
    v_add_f32 v82, 1.0, v82
    v_mfma_f32_32x32x16_bf16 v[192:207], a[188:191], a[28:31], v[192:207]
    ds_read_b64_tr_b16 a[184:185], v13 offset:43008
    ds_read_b64_tr_b16 a[186:187], v13 offset:43520
    v_add_f32 v83, 1.0, v83
    v_add_f32 v84, 1.0, v84
    v_add_f32 v85, 1.0, v85
    v_add_f32 v86, 1.0, v86
    s_waitcnt lgkmcnt(6)
    v_mfma_f32_32x32x16_bf16 v[144:159], a[160:163], a[32:35], v[144:159]
    ds_read_b64_tr_b16 a[188:189], v13 offset:51200
    ds_read_b64_tr_b16 a[190:191], v13 offset:51712
    buffer_load_dwordx4 v7, s[12:15], s45 offen offset:3072  lds
    v_add_f32 v87, 1.0, v87
    v_mfma_f32_32x32x16_bf16 v[160:175], a[164:167], a[32:35], v[160:175]
    ds_read_b64_tr_b16 a[160:161], v12 offset:45056
    ds_read_b64_tr_b16 a[162:163], v12 offset:45568
    v_rcp_f32 v80, v80
    v_rcp_f32 v81, v81
    v_mfma_f32_32x32x16_bf16 v[176:191], a[168:171], a[32:35], v[176:191]
    ds_read_b64_tr_b16 a[164:165], v12 offset:53248
    ds_read_b64_tr_b16 a[166:167], v12 offset:53760
    v_rcp_f32 v82, v82
    v_rcp_f32 v83, v83
    s_add_u32 s54, s50, 5120
    buffer_load_dwordx4 a[212:215], v2, s[8:11], s54 offen offset:0 sc1
    v_mfma_f32_32x32x16_bf16 v[192:207], a[172:175], a[32:35], v[192:207]
    ds_read_b64_tr_b16 a[168:169], v13 offset:45056
    ds_read_b64_tr_b16 a[170:171], v13 offset:45568
    v_rcp_f32 v84, v84
    v_rcp_f32 v85, v85
    s_waitcnt lgkmcnt(6)
    v_mfma_f32_32x32x16_bf16 v[144:159], a[176:179], a[36:39], v[144:159]
    ds_read_b64_tr_b16 a[172:173], v13 offset:53248
    ds_read_b64_tr_b16 a[174:175], v13 offset:53760
    v_rcp_f32 v86, v86
    buffer_load_dwordx4 a[216:219], v2, s[8:11], s54 offen offset:1024 sc1
    v_mfma_f32_32x32x16_bf16 v[160:175], a[180:183], a[36:39], v[160:175]
    ds_read_b64_tr_b16 a[176:177], v12 offset:47104
    ds_read_b64_tr_b16 a[178:179], v12 offset:47616
    v_rcp_f32 v87, v87
    v_mul_f32 v96, v96, v80
    v_mul_f32 v97, v97, v81
    v_mfma_f32_32x32x16_bf16 v[176:191], a[184:187], a[36:39], v[176:191]
    ds_read_b64_tr_b16 a[180:181], v12 offset:55296
    ds_read_b64_tr_b16 a[182:183], v12 offset:55808
    v_mul_f32 v98, v98, v82
    v_mul_f32 v99, v99, v83
    v_mul_f32 v100, v100, v84
    v_mul_f32 v101, v101, v85
    buffer_load_dwordx4 a[220:223], v2, s[8:11], s54 offen offset:2048 sc1
    v_mfma_f32_32x32x16_bf16 v[192:207], a[188:191], a[36:39], v[192:207]
    ds_read_b64_tr_b16 a[184:185], v13 offset:47104
    ds_read_b64_tr_b16 a[186:187], v13 offset:47616
    v_mul_f32 v102, v102, v86
    v_mul_f32 v103, v103, v87
    v_cvt_pk_bf16_f32 v80, v96, v97
    v_cvt_pk_bf16_f32 v81, v98, v99
    s_waitcnt lgkmcnt(6)
    v_mfma_f32_32x32x16_bf16 v[144:159], a[160:163], a[40:43], v[144:159]
    ds_read_b64_tr_b16 a[188:189], v13 offset:55296
    ds_read_b64_tr_b16 a[190:191], v13 offset:55808
    v_cvt_pk_bf16_f32 v82, v100, v101
    v_cvt_pk_bf16_f32 v83, v102, v103
    buffer_store_dwordx4 v[80:83], v23, s[8:11], s47 offen offset:0 sc1
    v_mfma_f32_32x32x16_bf16 v[160:175], a[164:167], a[40:43], v[160:175]
    s_waitcnt vmcnt(26)
    s_barrier
    ds_read_b64_tr_b16 a[160:161], v12 offset:61440
    ds_read_b64_tr_b16 a[162:163], v12 offset:61952
    s_add_u32 s62, s62, 1
    s_cmp_eq_u32 s62, 10
    s_cselect_b32 s62, 0, s62
    v_mfma_f32_32x32x16_bf16 v[176:191], a[168:171], a[40:43], v[176:191]
    v_add_u32 v12, 0xf000, v12
    ds_read_b64_tr_b16 a[164:165], v12 offset:8192
    ds_read_b64_tr_b16 a[166:167], v12 offset:8704
    s_add_u32 m0, s35, 81920
    s_mul_i32 s45, s62, 196608
    s_add_u32 s45, s45, s33
    v_mfma_f32_32x32x16_bf16 v[192:207], a[172:175], a[40:43], v[192:207]
    ds_read_b64_tr_b16 a[168:169], v13 offset:61440
    ds_read_b64_tr_b16 a[170:171], v13 offset:61952
    buffer_load_dwordx4 v4, s[12:15], s45 offen offset:0  lds
    v_mul_f32 v104, v88, v104
    v_mul_f32 v105, v89, v105
    v_mul_f32 v106, v90, v106
    s_waitcnt lgkmcnt(6)
    v_mfma_f32_32x32x16_bf16 v[144:159], a[176:179], a[44:47], v[144:159]
    v_add_u32 v13, 0xf000, v13
    ds_read_b64_tr_b16 a[172:173], v13 offset:8192
    ds_read_b64_tr_b16 a[174:175], v13 offset:8704
    v_mul_f32 v107, v91, v107
    v_mul_f32 v108, v92, v108
    v_mfma_f32_32x32x16_bf16 v[160:175], a[180:183], a[44:47], v[160:175]
    ds_read_b64_tr_b16 a[176:177], v12 offset:2048
    ds_read_b64_tr_b16 a[178:179], v12 offset:2560
    buffer_load_dwordx4 v5, s[12:15], s45 offen offset:1024  lds
    v_mul_f32 v109, v93, v109
    v_mul_f32 v110, v94, v110
    v_mul_f32 v111, v95, v111
    v_mfma_f32_32x32x16_bf16 v[176:191], a[184:187], a[44:47], v[176:191]
    ds_read_b64_tr_b16 a[180:181], v12 offset:10240
    ds_read_b64_tr_b16 a[182:183], v12 offset:10752
    v_mul_f32 v88, s42, v88
    v_mul_f32 v89, s42, v89
    v_mul_f32 v90, s42, v90
    v_mul_f32 v91, s42, v91
    v_mfma_f32_32x32x16_bf16 v[192:207], a[188:191], a[44:47], v[192:207]
    ds_read_b64_tr_b16 a[184:185], v13 offset:2048
    ds_read_b64_tr_b16 a[186:187], v13 offset:2560
    buffer_load_dwordx4 v6, s[12:15], s45 offen offset:2048  lds
    v_mul_f32 v92, s42, v92
    v_mul_f32 v93, s42, v93
    v_mul_f32 v94, s42, v94
    s_waitcnt lgkmcnt(6)
    v_mfma_f32_32x32x16_bf16 v[144:159], a[160:163], a[48:51], v[144:159]
    ds_read_b64_tr_b16 a[188:189], v13 offset:10240
    ds_read_b64_tr_b16 a[190:191], v13 offset:10752
    buffer_load_dwordx2 v[224:225], v28, s[20:23], 0 offen offset:0 sc1
    buffer_load_dwordx2 v[226:227], v28, s[20:23], 0 offen offset:2048 sc1
    v_mul_f32 v95, s42, v95
    v_mfma_f32_32x32x16_bf16 v[160:175], a[164:167], a[48:51], v[160:175]
    ds_read_b64_tr_b16 a[160:161], v12 offset:4096
    ds_read_b64_tr_b16 a[162:163], v12 offset:4608
    buffer_load_dwordx2 v[228:229], v29, s[20:23], 0 offen offset:0 sc1
    buffer_load_dwordx2 v[230:231], v29, s[20:23], 0 offen offset:2048 sc1
    buffer_load_dwordx4 v7, s[12:15], s45 offen offset:3072  lds
    v_exp_f32 v88, v88
    v_mfma_f32_32x32x16_bf16 v[176:191], a[168:171], a[48:51], v[176:191]
    ds_read_b64_tr_b16 a[164:165], v12 offset:12288
    ds_read_b64_tr_b16 a[166:167], v12 offset:12800
    buffer_load_dwordx2 v[232:233], v30, s[20:23], 0 offen offset:0 sc1
    buffer_load_dwordx2 v[234:235], v30, s[20:23], 0 offen offset:2048 sc1
    v_exp_f32 v89, v89
    v_mfma_f32_32x32x16_bf16 v[192:207], a[172:175], a[48:51], v[192:207]
    ds_read_b64_tr_b16 a[168:169], v13 offset:4096
    ds_read_b64_tr_b16 a[170:171], v13 offset:4608
    buffer_load_dwordx2 v[236:237], v31, s[20:23], 0 offen offset:0 sc1
    buffer_load_dwordx2 v[238:239], v31, s[20:23], 0 offen offset:2048 sc1
    v_exp_f32 v90, v90
    buffer_load_dwordx4 a[224:227], v2, s[8:11], s54 offen offset:3072 sc1
    s_waitcnt lgkmcnt(6)
    v_mfma_f32_32x32x16_bf16 v[144:159], a[176:179], a[52:55], v[144:159]
    ds_read_b64_tr_b16 a[172:173], v13 offset:12288
    ds_read_b64_tr_b16 a[174:175], v13 offset:12800
    v_exp_f32 v91, v91
    v_mfma_f32_32x32x16_bf16 v[160:175], a[180:183], a[52:55], v[160:175]
    ds_read_b64_tr_b16 a[176:177], v12 offset:6144
    ds_read_b64_tr_b16 a[178:179], v12 offset:6656
    v_exp_f32 v92, v92
    v_exp_f32 v93, v93
    buffer_load_dwordx4 a[228:231], v3, s[8:11], s54 offen offset:0 sc1
    v_mfma_f32_32x32x16_bf16 v[176:191], a[184:187], a[52:55], v[176:191]
    ds_read_b64_tr_b16 a[180:181], v12 offset:14336
    ds_read_b64_tr_b16 a[182:183], v12 offset:14848
    v_exp_f32 v94, v94
    v_exp_f32 v95, v95
    v_mfma_f32_32x32x16_bf16 v[192:207], a[188:191], a[52:55], v[192:207]
    ds_read_b64_tr_b16 a[184:185], v13 offset:6144
    ds_read_b64_tr_b16 a[186:187], v13 offset:6656
    v_add_f32 v88, 1.0, v88
    v_add_f32 v89, 1.0, v89
    v_add_f32 v90, 1.0, v90
    v_add_f32 v91, 1.0, v91
    s_add_u32 s54, s50, 10240
    buffer_load_dwordx4 a[232:235], v2, s[8:11], s54 offen offset:0 sc1
    s_waitcnt lgkmcnt(6)
    v_mfma_f32_32x32x16_bf16 v[144:159], a[160:163], a[56:59], v[144:159]
    ds_read_b64_tr_b16 a[188:189], v13 offset:14336
    ds_read_b64_tr_b16 a[190:191], v13 offset:14848
    v_add_f32 v92, 1.0, v92
    v_add_f32 v93, 1.0, v93
    v_add_f32 v94, 1.0, v94
    v_mfma_f32_32x32x16_bf16 v[160:175], a[164:167], a[56:59], v[160:175]
    s_waitcnt vmcnt(37)
    s_barrier
    v_add_u32 v12, 0xfffe2000, v12
    ds_read_b64_tr_b16 a[160:161], v12 offset:0
    ds_read_b64_tr_b16 a[162:163], v12 offset:512
    s_add_u32 s62, s62, 1
    v_mfma_f32_32x32x16_bf16 v[176:191], a[168:171], a[56:59], v[176:191]
    ds_read_b64_tr_b16 a[164:165], v12 offset:8192
    ds_read_b64_tr_b16 a[166:167], v12 offset:8704
    s_cmp_eq_u32 s62, 10
    s_cselect_b32 s62, 0, s62
    s_add_u32 m0, s35, 102400
    s_mul_i32 s45, s62, 196608
    v_mfma_f32_32x32x16_bf16 v[192:207], a[172:175], a[56:59], v[192:207]
    v_add_u32 v13, 0xfffe2000, v13
    ds_read_b64_tr_b16 a[168:169], v13 offset:0
    ds_read_b64_tr_b16 a[170:171], v13 offset:512
    s_add_u32 s45, s45, s33
    buffer_load_dwordx4 v4, s[12:15], s45 offen offset:0  lds
    v_add_f32 v95, 1.0, v95
    s_waitcnt lgkmcnt(6)
    v_mfma_f32_32x32x16_bf16 v[144:159], a[176:179], a[60:63], v[144:159]
    ds_read_b64_tr_b16 a[172:173], v13 offset:8192
    ds_read_b64_tr_b16 a[174:175], v13 offset:8704
    v_rcp_f32 v88, v88
    v_mfma_f32_32x32x16_bf16 v[160:175], a[180:183], a[60:63], v[160:175]
    ds_read_b64_tr_b16 a[176:177], v12 offset:2048
    ds_read_b64_tr_b16 a[178:179], v12 offset:2560
    buffer_load_dwordx4 v5, s[12:15], s45 offen offset:1024  lds
    v_rcp_f32 v89, v89
    v_mfma_f32_32x32x16_bf16 v[176:191], a[184:187], a[60:63], v[176:191]
    ds_read_b64_tr_b16 a[180:181], v12 offset:10240
    ds_read_b64_tr_b16 a[182:183], v12 offset:10752
    v_rcp_f32 v90, v90
    v_rcp_f32 v91, v91
    v_mfma_f32_32x32x16_bf16 v[192:207], a[188:191], a[60:63], v[192:207]
    ds_read_b64_tr_b16 a[184:185], v13 offset:2048
    ds_read_b64_tr_b16 a[186:187], v13 offset:2560
    buffer_load_dwordx4 v6, s[12:15], s45 offen offset:2048  lds
    v_rcp_f32 v92, v92
    s_waitcnt lgkmcnt(6)
    v_mfma_f32_32x32x16_bf16 v[144:159], a[160:163], a[64:67], v[144:159]
    ds_read_b64_tr_b16 a[188:189], v13 offset:10240
    ds_read_b64_tr_b16 a[190:191], v13 offset:10752
    v_mov_b32 v26, 0
    s_waitcnt vmcnt(14)
    v_cmp_eq_u32 s[64:65], s43, v225
    s_waitcnt vmcnt(13)
    v_cmp_eq_u32 s[66:67], s43, v227
    v_rcp_f32 v93, v93
    v_mfma_f32_32x32x16_bf16 v[160:175], a[164:167], a[64:67], v[160:175]
    ds_read_b64_tr_b16 a[160:161], v12 offset:4096
    ds_read_b64_tr_b16 a[162:163], v12 offset:4608
    s_waitcnt vmcnt(12)
    v_cmp_eq_u32 s[68:69], s43, v229
    s_waitcnt vmcnt(11)
    v_cmp_eq_u32 s[70:71], s43, v231
    s_waitcnt vmcnt(9)
    v_cmp_eq_u32 s[72:73], s43, v233
    s_waitcnt vmcnt(8)
    v_cmp_eq_u32 s[74:75], s43, v235
    s_waitcnt vmcnt(7)
    v_cmp_eq_u32 s[76:77], s43, v237
    buffer_load_dwordx4 v7, s[12:15], s45 offen offset:3072  lds
    v_rcp_f32 v94, v94
    v_mfma_f32_32x32x16_bf16 v[176:191], a[168:171], a[64:67], v[176:191]
    ds_read_b64_tr_b16 a[164:165], v12 offset:12288
    ds_read_b64_tr_b16 a[166:167], v12 offset:12800
    s_waitcnt vmcnt(7)
    v_cmp_eq_u32 s[78:79], s43, v239
    v_addc_co_u32 v26, vcc, 0, v26, s[64:65]
    v_addc_co_u32 v26, vcc, 0, v26, s[66:67]
    v_addc_co_u32 v26, vcc, 0, v26, s[68:69]
    v_addc_co_u32 v26, vcc, 0, v26, s[70:71]
    v_mfma_f32_32x32x16_bf16 v[192:207], a[172:175], a[64:67], v[192:207]
    ds_read_b64_tr_b16 a[168:169], v13 offset:4096
    ds_read_b64_tr_b16 a[170:171], v13 offset:4608
    v_addc_co_u32 v26, vcc, 0, v26, s[72:73]
    v_addc_co_u32 v26, vcc, 0, v26, s[74:75]
    v_addc_co_u32 v26, vcc, 0, v26, s[76:77]
    v_addc_co_u32 v26, vcc, 0, v26, s[78:79]
    v_cmp_ne_u32 vcc, v26, v25
    buffer_load_dwordx4 a[236:239], v2, s[8:11], s54 offen offset:1024 sc1
    s_waitcnt lgkmcnt(6)
    v_mfma_f32_32x32x16_bf16 v[144:159], a[176:179], a[68:71], v[144:159]
    ds_read_b64_tr_b16 a[172:173], v13 offset:12288
    ds_read_b64_tr_b16 a[174:175], v13 offset:12800
    s_cbranch_vccnz K1P_retry
K1P_back:
    v_fma_f32 v208, v52, v238, v236
    v_fmac_f32_dpp v208, v238, v53 row_ror:8 row_mask:0xf bank_mask:0xf
    v_fma_f32 v209, v52, v208, v234
    v_mfma_f32_32x32x16_bf16 v[160:175], a[180:183], a[68:71], v[160:175]
    ds_read_b64_tr_b16 a[176:177], v12 offset:6144
    ds_read_b64_tr_b16 a[178:179], v12 offset:6656
    v_fmac_f32_dpp v209, v208, v53 row_ror:8 row_mask:0xf bank_mask:0xf
    v_fma_f32 v208, v52, v209, v232
    s_nop 0
    v_fmac_f32_dpp v208, v209, v53 row_ror:8 row_mask:0xf bank_mask:0xf
    v_fma_f32 v209, v52, v208, v230
    s_nop 0
    v_fmac_f32_dpp v209, v208, v53 row_ror:8 row_mask:0xf bank_mask:0xf
    buffer_load_dwordx4 a[240:243], v2, s[8:11], s54 offen offset:2048 sc1
    v_mfma_f32_32x32x16_bf16 v[176:191], a[184:187], a[68:71], v[176:191]
    ds_read_b64_tr_b16 a[180:181], v12 offset:14336
    ds_read_b64_tr_b16 a[182:183], v12 offset:14848
    v_fma_f32 v208, v52, v209, v228
    v_fmac_f32_dpp v208, v209, v53 row_ror:8 row_mask:0xf bank_mask:0xf
    v_fma_f32 v209, v52, v208, v226
    s_nop 0
    v_fmac_f32_dpp v209, v208, v53 row_ror:8 row_mask:0xf bank_mask:0xf
    v_fma_f32 v208, v52, v209, v224
    v_mfma_f32_32x32x16_bf16 v[192:207], a[188:191], a[68:71], v[192:207]
    ds_read_b64_tr_b16 a[184:185], v13 offset:6144
    ds_read_b64_tr_b16 a[186:187], v13 offset:6656
    v_fmac_f32_dpp v208, v209, v53 row_ror:8 row_mask:0xf bank_mask:0xf
    v_mov_b32 v210, v208
    s_nop 1
    v_permlane32_swap_b32 v208, v210
    v_fma_f32 v240, v50, v210, v208
    s_nop 0
    v_fmac_f32_dpp v240, v210, v51 row_ror:8 row_mask:0xf bank_mask:0xf
    buffer_load_dwordx4 a[244:247], v2, s[8:11], s54 offen offset:3072 sc1
    s_waitcnt lgkmcnt(6)
    v_mfma_f32_32x32x16_bf16 v[144:159], a[160:163], a[72:75], v[144:159]
    ds_read_b64_tr_b16 a[188:189], v13 offset:14336
    ds_read_b64_tr_b16 a[190:191], v13 offset:14848
    v_fma_f32 v241, v48, v240, v216
    v_fmac_f32_dpp v241, v240, v49 row_ror:8 row_mask:0xf bank_mask:0xf
    v_fma_f32 v242, v48, v241, v217
    s_nop 0
    v_fmac_f32_dpp v242, v241, v49 row_ror:8 row_mask:0xf bank_mask:0xf
    v_mfma_f32_32x32x16_bf16 v[160:175], a[164:167], a[72:75], v[160:175]
    s_barrier
    ds_read_b64_tr_b16 a[160:161], v12 offset:20480
    ds_read_b64_tr_b16 a[162:163], v12 offset:20992
    v_fma_f32 v243, v48, v242, v218
    v_fmac_f32_dpp v243, v242, v49 row_ror:8 row_mask:0xf bank_mask:0xf
    v_fma_f32 v244, v48, v243, v219
    buffer_load_dwordx4 a[248:251], v3, s[8:11], s54 offen offset:0 sc1
    v_mfma_f32_32x32x16_bf16 v[176:191], a[168:171], a[72:75], v[176:191]
    ds_read_b64_tr_b16 a[164:165], v12 offset:28672
    ds_read_b64_tr_b16 a[166:167], v12 offset:29184
    v_fmac_f32_dpp v244, v243, v49 row_ror:8 row_mask:0xf bank_mask:0xf
    v_fma_f32 v245, v48, v244, v220
    s_nop 0
    v_fmac_f32_dpp v245, v244, v49 row_ror:8 row_mask:0xf bank_mask:0xf
    v_fma_f32 v246, v48, v245, v221
    s_nop 0
    v_fmac_f32_dpp v246, v245, v49 row_ror:8 row_mask:0xf bank_mask:0xf
    v_mfma_f32_32x32x16_bf16 v[192:207], a[172:175], a[72:75], v[192:207]
    ds_read_b64_tr_b16 a[168:169], v13 offset:20480
    ds_read_b64_tr_b16 a[170:171], v13 offset:20992
    v_fma_f32 v247, v48, v246, v222
    v_fmac_f32_dpp v247, v246, v49 row_ror:8 row_mask:0xf bank_mask:0xf
    ds_write_b128 v19, v[240:243] offset:4096
    ds_write_b128 v19, v[244:247] offset:4112
    s_waitcnt lgkmcnt(0)
    s_add_u32 s54, s50, 15360
    buffer_load_dwordx4 a[252:255], v2, s[8:11], s54 offen offset:0 sc1
    v_mfma_f32_32x32x16_bf16 v[144:159], a[176:179], a[76:79], v[144:159]
    ds_read_b64_tr_b16 a[172:173], v13 offset:28672
    ds_read_b64_tr_b16 a[174:175], v13 offset:29184
    s_barrier
    ds_read_b32 v208, v18 offset:4096
    s_waitcnt lgkmcnt(0)
    v_fmac_f32 v212, v32, v208
    v_fmac_f32_dpp v212, v208, v33 row_ror:8 row_mask:0xf bank_mask:0xf
    v_mfma_f32_32x32x16_bf16 v[160:175], a[180:183], a[76:79], v[160:175]
    ds_read_b64_tr_b16 a[176:177], v12 offset:22528
    ds_read_b64_tr_b16 a[178:179], v12 offset:23040
    v_fmac_f32 v64, v32, v212
    v_fmac_f32_dpp v64, v212, v33 row_ror:8 row_mask:0xf bank_mask:0xf
    v_fmac_f32 v65, v32, v64
    s_nop 0
    v_fmac_f32_dpp v65, v64, v33 row_ror:8 row_mask:0xf bank_mask:0xf
    v_fmac_f32 v66, v32, v65
    s_nop 0
    v_fmac_f32_dpp v66, v65, v33 row_ror:8 row_mask:0xf bank_mask:0xf
    v_fmac_f32 v67, v32, v66
    s_nop 0
    v_fmac_f32_dpp v67, v66, v33 row_ror:8 row_mask:0xf bank_mask:0xf
    v_fmac_f32 v68, v32, v67
    s_nop 0
    v_fmac_f32_dpp v68, v67, v33 row_ror:8 row_mask:0xf bank_mask:0xf
    buffer_load_dwordx4 a[0:3], v2, s[8:11], s54 offen offset:1024 sc1
    v_mfma_f32_32x32x16_bf16 v[176:191], a[184:187], a[76:79], v[176:191]
    ds_read_b64_tr_b16 a[180:181], v12 offset:30720
    ds_read_b64_tr_b16 a[182:183], v12 offset:31232
    v_fmac_f32 v69, v32, v68
    v_fmac_f32_dpp v69, v68, v33 row_ror:8 row_mask:0xf bank_mask:0xf
    v_fmac_f32 v70, v32, v69
    s_nop 0
    v_fmac_f32_dpp v70, v69, v33 row_ror:8 row_mask:0xf bank_mask:0xf
    v_fmac_f32 v71, v32, v70
    s_nop 0
    v_fmac_f32_dpp v71, v70, v33 row_ror:8 row_mask:0xf bank_mask:0xf
    v_fmac_f32 v72, v32, v71
    s_nop 0
    v_fmac_f32_dpp v72, v71, v33 row_ror:8 row_mask:0xf bank_mask:0xf
    v_fmac_f32 v73, v32, v72
    s_nop 0
    v_fmac_f32_dpp v73, v72, v33 row_ror:8 row_mask:0xf bank_mask:0xf
    v_mfma_f32_32x32x16_bf16 v[192:207], a[188:191], a[76:79], v[192:207]
    ds_read_b64_tr_b16 a[184:185], v13 offset:22528
    ds_read_b64_tr_b16 a[186:187], v13 offset:23040
    v_fmac_f32 v74, v32, v73
    v_fmac_f32_dpp v74, v73, v33 row_ror:8 row_mask:0xf bank_mask:0xf
    v_fmac_f32 v75, v32, v74
    s_nop 0
    v_fmac_f32_dpp v75, v74, v33 row_ror:8 row_mask:0xf bank_mask:0xf
    v_fmac_f32 v76, v32, v75
    s_nop 0
    v_fmac_f32_dpp v76, v75, v33 row_ror:8 row_mask:0xf bank_mask:0xf
    v_fmac_f32 v77, v32, v76
    s_nop 0
    v_fmac_f32_dpp v77, v76, v33 row_ror:8 row_mask:0xf bank_mask:0xf
    v_fmac_f32 v78, v32, v77
    s_nop 0
    v_fmac_f32_dpp v78, v77, v33 row_ror:8 row_mask:0xf bank_mask:0xf
    buffer_load_dwordx4 a[4:7], v2, s[8:11], s54 offen offset:2048 sc1
    v_mfma_f32_32x32x16_bf16 v[144:159], a[160:163], a[80:83], v[144:159]
    ds_read_b64_tr_b16 a[188:189], v13 offset:30720
    ds_read_b64_tr_b16 a[190:191], v13 offset:31232
    v_cvt_pk_bf16_f32 v216, v212, v64
    v_cvt_pk_bf16_f32 v217, v65, v66
    v_cvt_pk_bf16_f32 v218, v67, v68
    v_cvt_pk_bf16_f32 v219, v69, v70
    v_cvt_pk_bf16_f32 v220, v71, v72
    v_cvt_pk_bf16_f32 v221, v73, v74
    v_cvt_pk_bf16_f32 v222, v75, v76
    v_cvt_pk_bf16_f32 v223, v77, v78
    ds_write_b128 v20, v[216:219]
    v_mfma_f32_32x32x16_bf16 v[160:175], a[164:167], a[80:83], v[160:175]
    ds_read_b64_tr_b16 a[160:161], v12 offset:24576
    ds_read_b64_tr_b16 a[162:163], v12 offset:25088
    ds_write_b128 v20, v[220:223] offset:16
    ds_read_b64_tr_b16 v[64:65], v21 offset:0
    ds_read_b64_tr_b16 v[66:67], v21 offset:320
    ds_read_b64_tr_b16 v[68:69], v21 offset:32
    ds_read_b64_tr_b16 v[70:71], v21 offset:352
    s_add_u32 s6, s41, 0
    s_lshr_b32 s7, s6, 1
    s_lshl_b32 s7, s7, 12
    s_and_b32 s6, s6, 1
    s_lshl_b32 s6, s6, 9
    buffer_load_dwordx4 a[8:11], v2, s[8:11], s54 offen offset:3072 sc1
    v_mfma_f32_32x32x16_bf16 v[176:191], a[168:171], a[80:83], v[176:191]
    ds_read_b64_tr_b16 a[164:165], v12 offset:32768
    ds_read_b64_tr_b16 a[166:167], v12 offset:33280
    s_add_u32 s6, s6, s7
    s_add_u32 s6, s6, s40
    v_rcp_f32 v95, v95
    v_mfma_f32_32x32x16_bf16 v[192:207], a[172:175], a[80:83], v[192:207]
    ds_read_b64_tr_b16 a[168:169], v13 offset:24576
    ds_read_b64_tr_b16 a[170:171], v13 offset:25088
    s_waitcnt lgkmcnt(6)
    buffer_store_dwordx4 v[64:67], v22, s[8:11], s6 offen offset:0 sc1
    v_mul_f32 v104, v104, v88
    v_mul_f32 v105, v105, v89
    v_mul_f32 v106, v106, v90
    v_mfma_f32_32x32x16_bf16 v[144:159], a[176:179], a[84:87], v[144:159]
    ds_read_b64_tr_b16 a[172:173], v13 offset:32768
    ds_read_b64_tr_b16 a[174:175], v13 offset:33280
    v_mul_f32 v107, v107, v91
    v_mul_f32 v108, v108, v92
    v_mul_f32 v109, v109, v93
    v_mfma_f32_32x32x16_bf16 v[160:175], a[180:183], a[84:87], v[160:175]
    ds_read_b64_tr_b16 a[176:177], v12 offset:26624
    ds_read_b64_tr_b16 a[178:179], v12 offset:27136
    s_waitcnt lgkmcnt(8)
    buffer_store_dwordx4 v[68:71], v22, s[8:11], s6 offen offset:1024 sc1
    v_mul_f32 v110, v110, v94
    v_mul_f32 v111, v111, v95
    v_cvt_pk_bf16_f32 v88, v104, v105
    v_mfma_f32_32x32x16_bf16 v[176:191], a[184:187], a[84:87], v[176:191]
    ds_read_b64_tr_b16 a[180:181], v12 offset:34816
    ds_read_b64_tr_b16 a[182:183], v12 offset:35328
    v_cvt_pk_bf16_f32 v89, v106, v107
    v_cvt_pk_bf16_f32 v90, v108, v109
    v_cvt_pk_bf16_f32 v91, v110, v111
    s_add_u32 s37, s3, 0
    v_mfma_f32_32x32x16_bf16 v[192:207], a[188:191], a[84:87], v[192:207]
    ds_read_b64_tr_b16 a[184:185], v13 offset:26624
    ds_read_b64_tr_b16 a[186:187], v13 offset:27136
    buffer_store_dwordx4 v[88:91], v23, s[8:11], s47 offen offset:512 sc1
    s_add_u32 s47, s39, 4096
    v_mul_f32 v128, v112, v128
    v_mul_f32 v129, v113, v129
    s_waitcnt lgkmcnt(6)
    v_mfma_f32_32x32x16_bf16 v[144:159], a[160:163], a[88:91], v[144:159]
    ds_read_b64_tr_b16 a[188:189], v13 offset:34816
    ds_read_b64_tr_b16 a[190:191], v13 offset:35328
    v_mul_f32 v130, v114, v130
    v_mul_f32 v131, v115, v131
    v_mul_f32 v132, v116, v132
    v_mfma_f32_32x32x16_bf16 v[160:175], a[164:167], a[88:91], v[160:175]
    s_barrier
    ds_read_b64_tr_b16 a[160:161], v12 offset:40960
    ds_read_b64_tr_b16 a[162:163], v12 offset:41472
    v_mul_f32 v133, v117, v133
    v_mul_f32 v134, v118, v134
    buffer_load_dwordx4 a[12:15], v3, s[8:11], s54 offen offset:0 sc1
    v_mfma_f32_32x32x16_bf16 v[176:191], a[168:171], a[88:91], v[176:191]
    ds_read_b64_tr_b16 a[164:165], v12 offset:49152
    ds_read_b64_tr_b16 a[166:167], v12 offset:49664
    v_mul_f32 v135, v119, v135
    v_mul_f32 v112, s42, v112
    v_mul_f32 v113, s42, v113
    v_mul_f32 v114, s42, v114
    v_mfma_f32_32x32x16_bf16 v[192:207], a[172:175], a[88:91], v[192:207]
    ds_read_b64_tr_b16 a[168:169], v13 offset:40960
    ds_read_b64_tr_b16 a[170:171], v13 offset:41472
    v_mul_f32 v115, s42, v115
    v_mul_f32 v116, s42, v116
    v_mul_f32 v117, s42, v117
    v_mul_f32 v118, s42, v118
    s_add_u32 s54, s50, 20480
    buffer_load_dwordx4 a[16:19], v2, s[8:11], s54 offen offset:0 sc1
    s_waitcnt lgkmcnt(6)
    v_mfma_f32_32x32x16_bf16 v[144:159], a[176:179], a[92:95], v[144:159]
    ds_read_b64_tr_b16 a[172:173], v13 offset:49152
    ds_read_b64_tr_b16 a[174:175], v13 offset:49664
    v_mul_f32 v119, s42, v119
    v_exp_f32 v112, v112
    v_mfma_f32_32x32x16_bf16 v[160:175], a[180:183], a[92:95], v[160:175]
    ds_read_b64_tr_b16 a[176:177], v12 offset:43008
    ds_read_b64_tr_b16 a[178:179], v12 offset:43520
    v_exp_f32 v113, v113
    v_exp_f32 v114, v114
    buffer_load_dwordx4 a[20:23], v2, s[8:11], s54 offen offset:1024 sc1
    v_mfma_f32_32x32x16_bf16 v[176:191], a[184:187], a[92:95], v[176:191]
    ds_read_b64_tr_b16 a[180:181], v12 offset:51200
    ds_read_b64_tr_b16 a[182:183], v12 offset:51712
    v_exp_f32 v115, v115
    v_exp_f32 v116, v116
    v_mfma_f32_32x32x16_bf16 v[192:207], a[188:191], a[92:95], v[192:207]
    ds_read_b64_tr_b16 a[184:185], v13 offset:43008
    ds_read_b64_tr_b16 a[186:187], v13 offset:43520
    v_exp_f32 v117, v117
    v_exp_f32 v118, v118
    buffer_load_dwordx4 a[24:27], v2, s[8:11], s54 offen offset:2048 sc1
    s_waitcnt lgkmcnt(6)
    v_mfma_f32_32x32x16_bf16 v[144:159], a[160:163], a[96:99], v[144:159]
    ds_read_b64_tr_b16 a[188:189], v13 offset:51200
    ds_read_b64_tr_b16 a[190:191], v13 offset:51712
    s_waitcnt vmcnt(5)
    v_mov_b32 v61, s43
    buffer_store_dword v61, v27, s[8:11], s61 offen offset:0 sc1
    v_mfma_f32_32x32x16_bf16 v[160:175], a[164:167], a[96:99], v[160:175]
    ds_read_b64_tr_b16 a[160:161], v12 offset:45056
    ds_read_b64_tr_b16 a[162:163], v12 offset:45568
    v_exp_f32 v119, v119
    v_add_f32 v112, 1.0, v112
    v_add_f32 v113, 1.0, v113
    buffer_load_dwordx4 a[28:31], v2, s[8:11], s54 offen offset:3072 sc1
    v_mfma_f32_32x32x16_bf16 v[176:191], a[168:171], a[96:99], v[176:191]
    ds_read_b64_tr_b16 a[164:165], v12 offset:53248
    ds_read_b64_tr_b16 a[166:167], v12 offset:53760
    v_add_f32 v114, 1.0, v114
    v_add_f32 v115, 1.0, v115
    v_add_f32 v116, 1.0, v116
    v_add_f32 v117, 1.0, v117
    v_mfma_f32_32x32x16_bf16 v[192:207], a[172:175], a[96:99], v[192:207]
    ds_read_b64_tr_b16 a[168:169], v13 offset:45056
    ds_read_b64_tr_b16 a[170:171], v13 offset:45568
    v_add_f32 v118, 1.0, v118
    v_add_f32 v119, 1.0, v119
    v_rcp_f32 v112, v112
    buffer_load_dwordx4 a[32:35], v3, s[8:11], s54 offen offset:0 sc1
    s_waitcnt lgkmcnt(6)
    v_mfma_f32_32x32x16_bf16 v[144:159], a[176:179], a[100:103], v[144:159]
    ds_read_b64_tr_b16 a[172:173], v13 offset:53248
    ds_read_b64_tr_b16 a[174:175], v13 offset:53760
    v_rcp_f32 v113, v113
    s_and_b32 s37, s37, 3
    v_mfma_f32_32x32x16_bf16 v[160:175], a[180:183], a[100:103], v[160:175]
    ds_read_b64_tr_b16 a[176:177], v12 offset:47104
    ds_read_b64_tr_b16 a[178:179], v12 offset:47616
    v_rcp_f32 v114, v114
    v_rcp_f32 v115, v115
    s_add_u32 s54, s50, 25600
    buffer_load_dwordx4 a[36:39], v2, s[8:11], s54 offen offset:0 sc1
    v_mfma_f32_32x32x16_bf16 v[176:191], a[184:187], a[100:103], v[176:191]
    ds_read_b64_tr_b16 a[180:181], v12 offset:55296
    ds_read_b64_tr_b16 a[182:183], v12 offset:55808
    v_rcp_f32 v116, v116
    v_rcp_f32 v117, v117
    v_mfma_f32_32x32x16_bf16 v[192:207], a[188:191], a[100:103], v[192:207]
    ds_read_b64_tr_b16 a[184:185], v13 offset:47104
    ds_read_b64_tr_b16 a[186:187], v13 offset:47616
    v_rcp_f32 v118, v118
    v_rcp_f32 v119, v119
    buffer_load_dwordx4 a[40:43], v2, s[8:11], s54 offen offset:1024 sc1
    s_waitcnt lgkmcnt(6)
    v_mfma_f32_32x32x16_bf16 v[144:159], a[160:163], a[104:107], v[144:159]
    ds_read_b64_tr_b16 a[188:189], v13 offset:55296
    ds_read_b64_tr_b16 a[190:191], v13 offset:55808
    v_mul_f32 v128, v128, v112
    v_mul_f32 v129, v129, v113
    v_mul_f32 v130, v130, v114
    v_mfma_f32_32x32x16_bf16 v[160:175], a[164:167], a[104:107], v[160:175]
    s_barrier
    ds_read_b64_tr_b16 a[160:161], v12 offset:61440
    ds_read_b64_tr_b16 a[162:163], v12 offset:61952
    v_mul_f32 v131, v131, v115
    v_mul_f32 v132, v132, v116
    buffer_load_dwordx4 a[44:47], v2, s[8:11], s54 offen offset:2048 sc1
    v_mfma_f32_32x32x16_bf16 v[176:191], a[168:171], a[104:107], v[176:191]
    v_add_u32 v12, 0xf000, v12
    ds_read_b64_tr_b16 a[164:165], v12 offset:8192
    ds_read_b64_tr_b16 a[166:167], v12 offset:8704
    v_mul_f32 v133, v133, v117
    v_mul_f32 v134, v134, v118
    v_mul_f32 v135, v135, v119
    v_mfma_f32_32x32x16_bf16 v[192:207], a[172:175], a[104:107], v[192:207]
    ds_read_b64_tr_b16 a[168:169], v13 offset:61440
    ds_read_b64_tr_b16 a[170:171], v13 offset:61952
    v_cvt_pk_bf16_f32 v112, v128, v129
    v_cvt_pk_bf16_f32 v113, v130, v131
    v_cvt_pk_bf16_f32 v114, v132, v133
    v_cvt_pk_bf16_f32 v115, v134, v135
    buffer_load_dwordx4 a[48:51], v2, s[8:11], s54 offen offset:3072 sc1
    s_waitcnt lgkmcnt(6)
    v_mfma_f32_32x32x16_bf16 v[144:159], a[176:179], a[108:111], v[144:159]
    v_add_u32 v13, 0xf000, v13
    ds_read_b64_tr_b16 a[172:173], v13 offset:8192
    ds_read_b64_tr_b16 a[174:175], v13 offset:8704
    s_lshl_b32 s37, s37, 10
    v_add_u32 v4, s37, v2
    v_mfma_f32_32x32x16_bf16 v[160:175], a[180:183], a[108:111], v[160:175]
    ds_read_b64_tr_b16 a[176:177], v12 offset:2048
    ds_read_b64_tr_b16 a[178:179], v12 offset:2560
    buffer_store_dwordx4 v[112:115], v23, s[8:11], s47 offen offset:0 sc1
    v_mul_f32 v136, v120, v136
    v_mul_f32 v137, v121, v137
    v_mul_f32 v138, v122, v138
    v_mfma_f32_32x32x16_bf16 v[176:191], a[184:187], a[108:111], v[176:191]
    ds_read_b64_tr_b16 a[180:181], v12 offset:10240
    ds_read_b64_tr_b16 a[182:183], v12 offset:10752
    v_mul_f32 v139, v123, v139
    v_mul_f32 v140, v124, v140
    v_mul_f32 v141, v125, v141
    v_mul_f32 v142, v126, v142
    v_mfma_f32_32x32x16_bf16 v[192:207], a[188:191], a[108:111], v[192:207]
    ds_read_b64_tr_b16 a[184:185], v13 offset:2048
    ds_read_b64_tr_b16 a[186:187], v13 offset:2560
    v_mul_f32 v143, v127, v143
    v_mul_f32 v120, s42, v120
    v_mul_f32 v121, s42, v121
    v_mul_f32 v122, s42, v122
    buffer_load_dwordx4 a[52:55], v3, s[8:11], s54 offen offset:0 sc1
    s_waitcnt lgkmcnt(6)
    v_mfma_f32_32x32x16_bf16 v[144:159], a[160:163], a[112:115], v[144:159]
    ds_read_b64_tr_b16 a[188:189], v13 offset:10240
    ds_read_b64_tr_b16 a[190:191], v13 offset:10752
    v_mul_f32 v123, s42, v123
    v_mul_f32 v124, s42, v124
    v_mul_f32 v125, s42, v125
    v_mfma_f32_32x32x16_bf16 v[160:175], a[164:167], a[112:115], v[160:175]
    ds_read_b64_tr_b16 a[160:161], v12 offset:4096
    ds_read_b64_tr_b16 a[162:163], v12 offset:4608
    v_mul_f32 v126, s42, v126
    v_mul_f32 v127, s42, v127
    v_exp_f32 v120, v120
    s_add_u32 s54, s50, 30720
    buffer_load_dwordx4 a[56:59], v2, s[8:11], s54 offen offset:0 sc1
    v_mfma_f32_32x32x16_bf16 v[176:191], a[168:171], a[112:115], v[176:191]
    ds_read_b64_tr_b16 a[164:165], v12 offset:12288
    ds_read_b64_tr_b16 a[166:167], v12 offset:12800
    v_exp_f32 v121, v121
    v_exp_f32 v122, v122
    v_mfma_f32_32x32x16_bf16 v[192:207], a[172:175], a[112:115], v[192:207]
    ds_read_b64_tr_b16 a[168:169], v13 offset:4096
    ds_read_b64_tr_b16 a[170:171], v13 offset:4608
    v_exp_f32 v123, v123
    v_exp_f32 v124, v124
    buffer_load_dwordx4 a[60:63], v2, s[8:11], s54 offen offset:1024 sc1
    s_waitcnt lgkmcnt(6)
    v_mfma_f32_32x32x16_bf16 v[144:159], a[176:179], a[116:119], v[144:159]
    ds_read_b64_tr_b16 a[172:173], v13 offset:12288
    ds_read_b64_tr_b16 a[174:175], v13 offset:12800
    v_exp_f32 v125, v125
    s_add_u32 s37, s3, 1
    v_mfma_f32_32x32x16_bf16 v[160:175], a[180:183], a[116:119], v[160:175]
    ds_read_b64_tr_b16 a[176:177], v12 offset:6144
    ds_read_b64_tr_b16 a[178:179], v12 offset:6656
    v_exp_f32 v126, v126
    v_exp_f32 v127, v127
    buffer_load_dwordx4 a[64:67], v2, s[8:11], s54 offen offset:2048 sc1
    v_mfma_f32_32x32x16_bf16 v[176:191], a[184:187], a[116:119], v[176:191]
    ds_read_b64_tr_b16 a[180:181], v12 offset:14336
    ds_read_b64_tr_b16 a[182:183], v12 offset:14848
    v_add_f32 v120, 1.0, v120
    v_add_f32 v121, 1.0, v121
    v_add_f32 v122, 1.0, v122
    v_add_f32 v123, 1.0, v123
    v_mfma_f32_32x32x16_bf16 v[192:207], a[188:191], a[116:119], v[192:207]
    ds_read_b64_tr_b16 a[184:185], v13 offset:6144
    ds_read_b64_tr_b16 a[186:187], v13 offset:6656
    v_add_f32 v124, 1.0, v124
    v_add_f32 v125, 1.0, v125
    v_add_f32 v126, 1.0, v126
    v_add_f32 v127, 1.0, v127
    buffer_load_dwordx4 a[68:71], v2, s[8:11], s54 offen offset:3072 sc1
    s_waitcnt lgkmcnt(6)
    v_mfma_f32_32x32x16_bf16 v[144:159], a[160:163], a[120:123], v[144:159]
    ds_read_b64_tr_b16 a[188:189], v13 offset:14336
    ds_read_b64_tr_b16 a[190:191], v13 offset:14848
    v_rcp_f32 v120, v120
    s_and_b32 s37, s37, 3
    v_mfma_f32_32x32x16_bf16 v[160:175], a[164:167], a[120:123], v[160:175]
    s_barrier
    ds_read_b64_tr_b16 a[160:161], v12 offset:20480
    ds_read_b64_tr_b16 a[162:163], v12 offset:20992
    v_rcp_f32 v121, v121
    buffer_load_dwordx4 a[72:75], v3, s[8:11], s54 offen offset:0 sc1
    v_mfma_f32_32x32x16_bf16 v[176:191], a[168:171], a[120:123], v[176:191]
    ds_read_b64_tr_b16 a[164:165], v12 offset:28672
    ds_read_b64_tr_b16 a[166:167], v12 offset:29184
    v_rcp_f32 v122, v122
    v_rcp_f32 v123, v123
    v_mfma_f32_32x32x16_bf16 v[192:207], a[172:175], a[120:123], v[192:207]
    ds_read_b64_tr_b16 a[168:169], v13 offset:20480
    ds_read_b64_tr_b16 a[170:171], v13 offset:20992
    v_rcp_f32 v124, v124
    v_rcp_f32 v125, v125
    s_add_u32 s54, s50, 35840
    buffer_load_dwordx4 a[76:79], v2, s[8:11], s54 offen offset:0 sc1
    s_waitcnt lgkmcnt(6)
    v_mfma_f32_32x32x16_bf16 v[144:159], a[176:179], a[124:127], v[144:159]
    ds_read_b64_tr_b16 a[172:173], v13 offset:28672
    ds_read_b64_tr_b16 a[174:175], v13 offset:29184
    v_rcp_f32 v126, v126
    s_lshl_b32 s37, s37, 10
    v_mfma_f32_32x32x16_bf16 v[160:175], a[180:183], a[124:127], v[160:175]
    ds_read_b64_tr_b16 a[176:177], v12 offset:22528
    ds_read_b64_tr_b16 a[178:179], v12 offset:23040
    v_rcp_f32 v127, v127
    v_mul_f32 v136, v136, v120
    v_mul_f32 v137, v137, v121
    buffer_load_dwordx4 a[80:83], v2, s[8:11], s54 offen offset:1024 sc1
    v_mfma_f32_32x32x16_bf16 v[176:191], a[184:187], a[124:127], v[176:191]
    ds_read_b64_tr_b16 a[180:181], v12 offset:30720
    ds_read_b64_tr_b16 a[182:183], v12 offset:31232
    v_mul_f32 v138, v138, v122
    v_mul_f32 v139, v139, v123
    v_mul_f32 v140, v140, v124
    v_mul_f32 v141, v141, v125
    v_mfma_f32_32x32x16_bf16 v[192:207], a[188:191], a[124:127], v[192:207]
    ds_read_b64_tr_b16 a[184:185], v13 offset:22528
    ds_read_b64_tr_b16 a[186:187], v13 offset:23040
    v_mul_f32 v142, v142, v126
    v_mul_f32 v143, v143, v127
    v_cvt_pk_bf16_f32 v120, v136, v137
    v_cvt_pk_bf16_f32 v121, v138, v139
    buffer_load_dwordx4 a[84:87], v2, s[8:11], s54 offen offset:2048 sc1
    s_waitcnt lgkmcnt(6)
    v_mfma_f32_32x32x16_bf16 v[144:159], a[160:163], a[128:131], v[144:159]
    ds_read_b64_tr_b16 a[188:189], v13 offset:30720
    ds_read_b64_tr_b16 a[190:191], v13 offset:31232
    v_cvt_pk_bf16_f32 v122, v140, v141
    v_cvt_pk_bf16_f32 v123, v142, v143
    v_add_u32 v5, s37, v2
    v_mfma_f32_32x32x16_bf16 v[160:175], a[164:167], a[128:131], v[160:175]
    ds_read_b64_tr_b16 a[160:161], v12 offset:24576
    ds_read_b64_tr_b16 a[162:163], v12 offset:25088
    buffer_store_dwordx4 v[120:123], v23, s[8:11], s47 offen offset:512 sc1
    s_add_u32 s37, s3, 2
    s_and_b32 s37, s37, 3
    s_lshl_b32 s37, s37, 10
    v_mfma_f32_32x32x16_bf16 v[176:191], a[168:171], a[128:131], v[176:191]
    ds_read_b64_tr_b16 a[164:165], v12 offset:32768
    ds_read_b64_tr_b16 a[166:167], v12 offset:33280
    v_add_u32 v6, s37, v2
    s_add_u32 s37, s3, 3
    s_and_b32 s37, s37, 3
    s_lshl_b32 s37, s37, 10
    v_mfma_f32_32x32x16_bf16 v[192:207], a[172:175], a[128:131], v[192:207]
    ds_read_b64_tr_b16 a[168:169], v13 offset:24576
    ds_read_b64_tr_b16 a[170:171], v13 offset:25088
    v_add_u32 v7, s37, v2
    s_mov_b32 s12, s30
    s_mov_b32 s13, s31
    s_mov_b32 s14, 0x500000
    buffer_load_dwordx4 a[88:91], v2, s[8:11], s54 offen offset:3072 sc1
    s_waitcnt lgkmcnt(6)
    v_mfma_f32_32x32x16_bf16 v[144:159], a[176:179], a[132:135], v[144:159]
    ds_read_b64_tr_b16 a[172:173], v13 offset:32768
    ds_read_b64_tr_b16 a[174:175], v13 offset:33280
    s_mov_b32 s15, 0x20000
    s_and_b32 s37, s3, 1
    s_lshl_b32 s37, s37, 6
    v_mfma_f32_32x32x16_bf16 v[160:175], a[180:183], a[132:135], v[160:175]
    ds_read_b64_tr_b16 a[176:177], v12 offset:26624
    ds_read_b64_tr_b16 a[178:179], v12 offset:27136
    s_add_u32 s37, s37, s60
    s_add_u32 s32, s4, s37
    s_addc_u32 s33, s5, 0
    s_lshl_b32 s37, s3, 5
    buffer_load_dwordx4 a[92:95], v3, s[8:11], s54 offen offset:0 sc1
    v_mfma_f32_32x32x16_bf16 v[176:191], a[184:187], a[132:135], v[176:191]
    ds_read_b64_tr_b16 a[180:181], v12 offset:34816
    ds_read_b64_tr_b16 a[182:183], v12 offset:35328
    s_add_u32 s37, s37, s60
    s_add_u32 s37, s37, 128
    s_add_u32 s34, s4, s37
    s_addc_u32 s35, s5, 0
    v_mfma_f32_32x32x16_bf16 v[192:207], a[188:191], a[132:135], v[192:207]
    ds_read_b64_tr_b16 a[184:185], v13 offset:26624
    ds_read_b64_tr_b16 a[186:187], v13 offset:27136
    s_mov_b32 s28, s43
    s_mov_b32 s29, s43
    v_and_b32 v62, 15, v1
    v_mul_u32_u24 v20, 640, v62
    s_add_u32 s54, s50, 40960
    buffer_load_dwordx4 a[96:99], v2, s[8:11], s54 offen offset:0 sc1
    s_waitcnt lgkmcnt(6)
    v_mfma_f32_32x32x16_bf16 v[144:159], a[160:163], a[136:139], v[144:159]
    ds_read_b64_tr_b16 a[188:189], v13 offset:34816
    ds_read_b64_tr_b16 a[190:191], v13 offset:35328
    v_lshrrev_b32 v63, 4, v1
    v_lshlrev_b32 v11, 2, v63
    s_lshl_b32 s37, s48, 2
    v_mfma_f32_32x32x16_bf16 v[160:175], a[164:167], a[136:139], v[160:175]
    s_barrier
    ds_read_b64_tr_b16 a[160:161], v12 offset:40960
    ds_read_b64_tr_b16 a[162:163], v12 offset:41472
    s_add_u32 s37, s37, s3
    s_mul_i32 s56, s37, 10240
    buffer_load_dwordx4 a[100:103], v2, s[8:11], s54 offen offset:1024 sc1
    v_mfma_f32_32x32x16_bf16 v[176:191], a[168:171], a[136:139], v[176:191]
    ds_read_b64_tr_b16 a[164:165], v12 offset:49152
    ds_read_b64_tr_b16 a[166:167], v12 offset:49664
    s_mul_i32 s37, s49, 80
    s_add_u32 s56, s56, s37
    v_add3_u32 v20, v20, v11, s56
    v_lshlrev_b32 v20, 2, v20
    v_mfma_f32_32x32x16_bf16 v[192:207], a[172:175], a[136:139], v[192:207]
    ds_read_b64_tr_b16 a[168:169], v13 offset:40960
    ds_read_b64_tr_b16 a[170:171], v13 offset:41472
    s_lshl_b32 s56, s56, 1
    s_mul_i32 s58, s3, 5120
    s_add_u32 s58, s58, 122880
    v_mul_u32_u24 v18, 160, v62
    buffer_load_dwordx4 a[104:107], v2, s[8:11], s54 offen offset:2048 sc1
    s_waitcnt lgkmcnt(6)
    v_mfma_f32_32x32x16_bf16 v[144:159], a[176:179], a[140:143], v[144:159]
    ds_read_b64_tr_b16 a[172:173], v13 offset:49152
    ds_read_b64_tr_b16 a[174:175], v13 offset:49664
    v_lshlrev_b32 v11, 3, v63
    v_add_u32 v21, 143360, v11
    v_add3_u32 v18, v18, v11, s58
    v_mfma_f32_32x32x16_bf16 v[160:175], a[180:183], a[140:143], v[160:175]
    ds_read_b64_tr_b16 a[176:177], v12 offset:43008
    ds_read_b64_tr_b16 a[178:179], v12 offset:43520
    v_lshlrev_b32 v19, 4, v62
    v_lshrrev_b32 v11, 1, v63
    v_lshlrev_b32 v11, 8, v11
    v_and_b32 v26, 1, v63
    buffer_load_dwordx4 a[108:111], v2, s[8:11], s54 offen offset:3072 sc1
    v_mfma_f32_32x32x16_bf16 v[176:191], a[184:187], a[140:143], v[176:191]
    ds_read_b64_tr_b16 a[180:181], v12 offset:51200
    ds_read_b64_tr_b16 a[182:183], v12 offset:51712
    v_lshlrev_b32 v26, 3, v26
    v_add3_u32 v19, v19, v11, v26
    v_add_u32 v19, s58, v19
    v_add_u32 v11, 0, v1
    v_mfma_f32_32x32x16_bf16 v[192:207], a[188:191], a[140:143], v[192:207]
    ds_read_b64_tr_b16 a[184:185], v13 offset:43008
    ds_read_b64_tr_b16 a[186:187], v13 offset:43520
    v_mul_u32_u24 v26, 205, v11
    v_lshrrev_b32 v26, 11, v26
    v_mul_u32_u24 v26, 1120, v26
    v_lshlrev_b32 v11, 4, v11
    buffer_load_dwordx4 a[112:115], v3, s[8:11], s54 offen offset:0 sc1
    s_waitcnt lgkmcnt(6)
    v_mfma_f32_32x32x16_bf16 v[144:159], a[160:163], a[144:147], v[144:159]
    ds_read_b64_tr_b16 a[188:189], v13 offset:51200
    ds_read_b64_tr_b16 a[190:191], v13 offset:51712
    v_add_u32 v8, v11, v26
    v_add_u32 v11, 64, v1
    v_mul_u32_u24 v26, 205, v11
    v_mfma_f32_32x32x16_bf16 v[160:175], a[164:167], a[144:147], v[160:175]
    ds_read_b64_tr_b16 a[160:161], v12 offset:45056
    ds_read_b64_tr_b16 a[162:163], v12 offset:45568
    v_lshrrev_b32 v26, 11, v26
    v_mul_u32_u24 v26, 1120, v26
    v_lshlrev_b32 v11, 4, v11
    v_add_u32 v9, v11, v26
    s_add_u32 s54, s50, 46080
    buffer_load_dwordx4 a[116:119], v2, s[8:11], s54 offen offset:0 sc1
    v_mfma_f32_32x32x16_bf16 v[176:191], a[168:171], a[144:147], v[176:191]
    ds_read_b64_tr_b16 a[164:165], v12 offset:53248
    ds_read_b64_tr_b16 a[166:167], v12 offset:53760
    v_subrev_u32 v9, 1024, v9
    v_add_u32 v11, 128, v1
    v_mul_u32_u24 v26, 205, v11
    v_lshrrev_b32 v26, 11, v26
    v_mfma_f32_32x32x16_bf16 v[192:207], a[172:175], a[144:147], v[192:207]
    ds_read_b64_tr_b16 a[168:169], v13 offset:45056
    ds_read_b64_tr_b16 a[170:171], v13 offset:45568
    v_mul_u32_u24 v26, 1120, v26
    v_lshlrev_b32 v11, 4, v11
    v_add_u32 v10, v11, v26
    v_subrev_u32 v10, 2048, v10
    buffer_load_dwordx4 a[120:123], v2, s[8:11], s54 offen offset:1024 sc1
    s_waitcnt lgkmcnt(6)
    v_mfma_f32_32x32x16_bf16 v[144:159], a[176:179], a[148:151], v[144:159]
    ds_read_b64_tr_b16 a[172:173], v13 offset:53248
    ds_read_b64_tr_b16 a[174:175], v13 offset:53760
    v_and_b32 v11, 15, v1
    v_lshrrev_b32 v26, 2, v11
    v_lshlrev_b32 v26, 3, v26
    v_mfma_f32_32x32x16_bf16 v[160:175], a[180:183], a[148:151], v[160:175]
    ds_read_b64_tr_b16 a[176:177], v12 offset:47104
    ds_read_b64_tr_b16 a[178:179], v12 offset:47616
    v_and_b32 v11, 3, v11
    v_add_u32 v26, v26, v11
    s_and_b32 s37, s3, 1
    s_lshl_b32 s37, s37, 2
    buffer_load_dwordx4 a[124:127], v2, s[8:11], s54 offen offset:2048 sc1
    v_mfma_f32_32x32x16_bf16 v[176:191], a[184:187], a[148:151], v[176:191]
    ds_read_b64_tr_b16 a[180:181], v12 offset:55296
    ds_read_b64_tr_b16 a[182:183], v12 offset:55808
    v_add_u32 v26, s37, v26
    v_lshlrev_b32 v26, 4, v26
    v_lshrrev_b32 v11, 4, v1
    v_lshlrev_b32 v11, 9, v11
    v_mfma_f32_32x32x16_bf16 v[192:207], a[188:191], a[148:151], v[192:207]
    ds_read_b64_tr_b16 a[184:185], v13 offset:47104
    ds_read_b64_tr_b16 a[186:187], v13 offset:47616
    v_add_u32 v11, v11, v26
    s_lshl_b32 s57, s48, 1
    s_lshr_b32 s37, s3, 1
    s_add_u32 s57, s57, s37
    buffer_load_dwordx4 a[128:131], v2, s[8:11], s54 offen offset:3072 sc1
    s_waitcnt lgkmcnt(6)
    v_mfma_f32_32x32x16_bf16 v[144:159], a[160:163], a[152:155], v[144:159]
    ds_read_b64_tr_b16 a[188:189], v13 offset:55296
    ds_read_b64_tr_b16 a[190:191], v13 offset:55808
    s_mul_i32 s57, s57, 40960
    s_mul_i32 s37, s49, 5120
    s_add_u32 s57, s57, s37
    v_mfma_f32_32x32x16_bf16 v[160:175], a[164:167], a[152:155], v[160:175]
    s_mul_i32 s59, s49, 160
    s_add_u32 s37, s3, 1
    s_and_b32 s37, s37, 3
    s_mul_i32 s37, s37, 15360
    s_add_u32 s37, s37, 0
    v_add_u32 v14, s37, v2
    buffer_load_dwordx4 a[132:135], v3, s[8:11], s54 offen offset:0 sc1
    v_mfma_f32_32x32x16_bf16 v[176:191], a[168:171], a[152:155], v[176:191]
    s_add_u32 s37, s3, 2
    s_and_b32 s37, s37, 3
    s_mul_i32 s37, s37, 15360
    s_add_u32 s37, s37, 5120
    v_add_u32 v15, s37, v2
    s_add_u32 s37, s3, 3
    v_mfma_f32_32x32x16_bf16 v[192:207], a[172:175], a[152:155], v[192:207]
    s_and_b32 s37, s37, 3
    s_mul_i32 s37, s37, 15360
    s_add_u32 s37, s37, 10240
    v_add_u32 v16, s37, v2
    s_mul_i32 s37, s3, 15360
    v_add_u32 v17, s37, v2
    s_add_u32 s54, s51, 0
    buffer_load_dwordx4 a[136:139], v2, s[8:11], s54 offen offset:0 sc1
    s_waitcnt lgkmcnt(0)
    v_mfma_f32_32x32x16_bf16 v[144:159], a[176:179], a[156:159], v[144:159]
    v_add_u32 v244, 61440, v14
    v_add_u32 v245, 61440, v15
    v_add_u32 v246, 61440, v16
    v_add_u32 v247, 61440, v17
    v_mov_b32 v250, 1.0
    v_mfma_f32_32x32x16_bf16 v[160:175], a[180:183], a[156:159], v[160:175]
    v_mov_b32 v251, 1.0
    v_mov_b32 v252, s42
    v_mov_b32 v253, s42
    s_mov_b32 m0, s58
    s_nop 0
    buffer_load_dwordx4 v8, s[16:19], s56 offen offset:0 lds
    s_mov_b32 m0, s58
    s_nop 0
    buffer_load_dwordx4 v9, s[16:19], s56 offen offset:1024 lds
    v_mfma_f32_32x32x16_bf16 v[176:191], a[184:187], a[156:159], v[176:191]
    v_mfma_f32_32x32x16_bf16 v[192:207], a[188:191], a[156:159], v[192:207]
    s_mov_b32 m0, s58
    s_mov_b32 exec_hi, 0
    buffer_load_dwordx4 v10, s[16:19], s56 offen offset:2048 lds
    s_mov_b64 exec, -1
    s_add_u32 m0, s58, 2560
    s_nop 0
    buffer_load_dwordx4 v11, s[8:11], s57 offen offset:0 sc1 lds
    s_add_u32 s57, s57, 1024
    s_add_u32 m0, s58, 2560
    s_nop 0
    buffer_load_dwordx4 v11, s[8:11], s57 offen offset:1024 sc1 lds
    s_add_u32 s57, s57, 1024
    s_add_u32 m0, s58, 2560
    s_mov_b32 exec_hi, 0
    buffer_load_dwordx4 v11, s[8:11], s57 offen offset:2048 sc1 lds
    s_mov_b64 exec, -1
    s_mov_b32 m0, 143360
    s_mov_b64 exec, 0x3ff
    buffer_load_dwordx4 v2, s[24:27], s59 offen lds
    s_mov_b64 exec, -1
    s_load_dwordx16 s[64:79], s[32:33], 0 glc
    s_add_u32 s47, s39, 8192
    v_pk_mul_f32 v[160:161], v[144:145], v[160:161]
    v_pk_mul_f32 v[162:163], v[146:147], v[162:163]
    v_pk_mul_f32 v[164:165], v[148:149], v[164:165]
    v_pk_mul_f32 v[166:167], v[150:151], v[166:167]
    v_pk_mul_f32 v[144:145], v[144:145], v[56:57]
    v_pk_mul_f32 v[146:147], v[146:147], v[56:57]
    v_pk_mul_f32 v[148:149], v[148:149], v[56:57]
    v_pk_mul_f32 v[150:151], v[150:151], v[56:57]
    v_exp_f32 v144, v144
    v_exp_f32 v145, v145
    v_exp_f32 v146, v146
    v_exp_f32 v147, v147
    buffer_load_dwordx4 a[140:143], v2, s[8:11], s54 offen offset:1024 sc1
    v_exp_f32 v148, v148
    v_exp_f32 v149, v149
    v_exp_f32 v150, v150
    v_exp_f32 v151, v151
    buffer_load_dwordx4 a[144:147], v2, s[8:11], s54 offen offset:2048 sc1
    v_pk_add_f32 v[144:145], v[144:145], v[54:55]
    v_pk_add_f32 v[146:147], v[146:147], v[54:55]
    v_pk_add_f32 v[148:149], v[148:149], v[54:55]
    v_pk_add_f32 v[150:151], v[150:151], v[54:55]
    v_rcp_f32 v144, v144
    v_rcp_f32 v145, v145
    v_rcp_f32 v146, v146
    v_rcp_f32 v147, v147
    buffer_load_dwordx4 a[148:151], v2, s[8:11], s54 offen offset:3072 sc1
    v_rcp_f32 v148, v148
    v_rcp_f32 v149, v149
    v_rcp_f32 v150, v150
    v_rcp_f32 v151, v151
    buffer_load_dwordx4 a[152:155], v3, s[8:11], s54 offen offset:0 sc1
    v_pk_mul_f32 v[160:161], v[160:161], v[144:145]
    v_pk_mul_f32 v[162:163], v[162:163], v[146:147]
    v_pk_mul_f32 v[164:165], v[164:165], v[148:149]
    v_pk_mul_f32 v[166:167], v[166:167], v[150:151]
    v_cvt_pk_bf16_f32 v144, v160, v161
    v_cvt_pk_bf16_f32 v145, v162, v163
    v_cvt_pk_bf16_f32 v146, v164, v165
    v_cvt_pk_bf16_f32 v147, v166, v167
    buffer_store_dwordx4 v[144:147], v23, s[8:11], s47 offen offset:0 sc1
    v_pk_mul_f32 v[168:169], v[152:153], v[168:169]
    v_pk_mul_f32 v[170:171], v[154:155], v[170:171]
    v_pk_mul_f32 v[172:173], v[156:157], v[172:173]
    v_pk_mul_f32 v[174:175], v[158:159], v[174:175]
    v_pk_mul_f32 v[152:153], v[152:153], v[56:57]
    v_pk_mul_f32 v[154:155], v[154:155], v[56:57]
    v_pk_mul_f32 v[156:157], v[156:157], v[56:57]
    v_pk_mul_f32 v[158:159], v[158:159], v[56:57]
    v_exp_f32 v152, v152
    v_exp_f32 v153, v153
    v_exp_f32 v154, v154
    v_exp_f32 v155, v155
    v_exp_f32 v156, v156
    v_exp_f32 v157, v157
    v_exp_f32 v158, v158
    v_exp_f32 v159, v159
    v_pk_add_f32 v[152:153], v[152:153], v[54:55]
    v_pk_add_f32 v[154:155], v[154:155], v[54:55]
    v_pk_add_f32 v[156:157], v[156:157], v[54:55]
    v_pk_add_f32 v[158:159], v[158:159], v[54:55]
    v_rcp_f32 v152, v152
    v_rcp_f32 v153, v153
    v_rcp_f32 v154, v154
    v_rcp_f32 v155, v155
    v_rcp_f32 v156, v156
    v_rcp_f32 v157, v157
    v_rcp_f32 v158, v158
    v_rcp_f32 v159, v159
    v_pk_mul_f32 v[168:169], v[168:169], v[152:153]
    v_pk_mul_f32 v[170:171], v[170:171], v[154:155]
    v_pk_mul_f32 v[172:173], v[172:173], v[156:157]
    v_pk_mul_f32 v[174:175], v[174:175], v[158:159]
    v_cvt_pk_bf16_f32 v152, v168, v169
    v_cvt_pk_bf16_f32 v153, v170, v171
    v_cvt_pk_bf16_f32 v154, v172, v173
    v_cvt_pk_bf16_f32 v155, v174, v175
    buffer_store_dwordx4 v[152:155], v23, s[8:11], s47 offen offset:512 sc1
    s_waitcnt lgkmcnt(0)
    s_cmp_lg_u64 s[64:65], s[28:29]
    s_cbranch_scc1 FP0_retry
    s_cmp_lg_u64 s[66:67], s[28:29]
    s_cbranch_scc1 FP0_retry
    s_cmp_lg_u64 s[68:69], s[28:29]
    s_cbranch_scc1 FP0_retry
    s_cmp_lg_u64 s[70:71], s[28:29]
    s_cbranch_scc1 FP0_retry
    s_cmp_lg_u64 s[72:73], s[28:29]
    s_cbranch_scc1 FP0_retry
    s_cmp_lg_u64 s[74:75], s[28:29]
    s_cbranch_scc1 FP0_retry
    s_cmp_lg_u64 s[76:77], s[28:29]
    s_cbranch_scc1 FP0_retry
    s_cmp_lg_u64 s[78:79], s[28:29]
    s_cbranch_scc1 FP0_retry
FP0_back:
    s_add_u32 s55, s52, 0
    buffer_load_dwordx4 v[208:211], v4, s[8:11], s55 offen sc1
    buffer_load_dwordx4 v[212:215], v5, s[8:11], s55 offen sc1
    buffer_load_dwordx4 v[216:219], v6, s[8:11], s55 offen sc1
    buffer_load_dwordx4 v[220:223], v7, s[8:11], s55 offen sc1
    s_add_u32 s55, s52, 4096
    buffer_load_dwordx4 v[144:147], v4, s[8:11], s55 offen sc1
    buffer_load_dwordx4 v[148:151], v5, s[8:11], s55 offen sc1
    buffer_load_dwordx4 v[152:155], v6, s[8:11], s55 offen sc1
    buffer_load_dwordx4 v[156:159], v7, s[8:11], s55 offen sc1
    s_add_u32 s55, s52, 8192
    buffer_load_dwordx4 v[160:163], v4, s[8:11], s55 offen sc1
    buffer_load_dwordx4 v[164:167], v5, s[8:11], s55 offen sc1
    buffer_load_dwordx4 v[168:171], v6, s[8:11], s55 offen sc1
    buffer_load_dwordx4 v[172:175], v7, s[8:11], s55 offen sc1
    s_add_u32 s47, s39, 12288
    v_pk_mul_f32 v[192:193], v[176:177], v[192:193]
    v_pk_mul_f32 v[194:195], v[178:179], v[194:195]
    v_pk_mul_f32 v[196:197], v[180:181], v[196:197]
    v_pk_mul_f32 v[198:199], v[182:183], v[198:199]
    v_pk_mul_f32 v[176:177], v[176:177], v[56:57]
    v_pk_mul_f32 v[178:179], v[178:179], v[56:57]
    v_pk_mul_f32 v[180:181], v[180:181], v[56:57]
    v_pk_mul_f32 v[182:183], v[182:183], v[56:57]
    v_exp_f32 v176, v176
    v_exp_f32 v177, v177
    v_exp_f32 v178, v178
    v_exp_f32 v179, v179
    s_add_u32 s54, s51, 5120
    buffer_load_dwordx4 a[156:159], v2, s[8:11], s54 offen offset:0 sc1
    v_exp_f32 v180, v180
    v_exp_f32 v181, v181
    v_exp_f32 v182, v182
    v_exp_f32 v183, v183
    buffer_load_dwordx4 a[160:163], v2, s[8:11], s54 offen offset:1024 sc1
    v_pk_add_f32 v[176:177], v[176:177], v[54:55]
    v_pk_add_f32 v[178:179], v[178:179], v[54:55]
    v_pk_add_f32 v[180:181], v[180:181], v[54:55]
    v_pk_add_f32 v[182:183], v[182:183], v[54:55]
    v_rcp_f32 v176, v176
    v_rcp_f32 v177, v177
    v_rcp_f32 v178, v178
    v_rcp_f32 v179, v179
    buffer_load_dwordx4 a[164:167], v2, s[8:11], s54 offen offset:2048 sc1
    v_rcp_f32 v180, v180
    v_rcp_f32 v181, v181
    v_rcp_f32 v182, v182
    v_rcp_f32 v183, v183
    buffer_load_dwordx4 a[168:171], v2, s[8:11], s54 offen offset:3072 sc1
    v_pk_mul_f32 v[192:193], v[192:193], v[176:177]
    v_pk_mul_f32 v[194:195], v[194:195], v[178:179]
    v_pk_mul_f32 v[196:197], v[196:197], v[180:181]
    v_pk_mul_f32 v[198:199], v[198:199], v[182:183]
    v_cvt_pk_bf16_f32 v176, v192, v193
    v_cvt_pk_bf16_f32 v177, v194, v195
    v_cvt_pk_bf16_f32 v178, v196, v197
    v_cvt_pk_bf16_f32 v179, v198, v199
    buffer_store_dwordx4 v[176:179], v23, s[8:11], s47 offen offset:0 sc1
    v_pk_mul_f32 v[200:201], v[184:185], v[200:201]
    v_pk_mul_f32 v[202:203], v[186:187], v[202:203]
    v_pk_mul_f32 v[204:205], v[188:189], v[204:205]
    v_pk_mul_f32 v[206:207], v[190:191], v[206:207]
    v_pk_mul_f32 v[184:185], v[184:185], v[56:57]
    v_pk_mul_f32 v[186:187], v[186:187], v[56:57]
    v_pk_mul_f32 v[188:189], v[188:189], v[56:57]
    v_pk_mul_f32 v[190:191], v[190:191], v[56:57]
    v_exp_f32 v184, v184
    v_exp_f32 v185, v185
    v_exp_f32 v186, v186
    v_exp_f32 v187, v187
    v_exp_f32 v188, v188
    v_exp_f32 v189, v189
    v_exp_f32 v190, v190
    v_exp_f32 v191, v191
    v_pk_add_f32 v[184:185], v[184:185], v[54:55]
    v_pk_add_f32 v[186:187], v[186:187], v[54:55]
    v_pk_add_f32 v[188:189], v[188:189], v[54:55]
    v_pk_add_f32 v[190:191], v[190:191], v[54:55]
    v_rcp_f32 v184, v184
    v_rcp_f32 v185, v185
    v_rcp_f32 v186, v186
    v_rcp_f32 v187, v187
    v_rcp_f32 v188, v188
    v_rcp_f32 v189, v189
    v_rcp_f32 v190, v190
    v_rcp_f32 v191, v191
    v_pk_mul_f32 v[200:201], v[200:201], v[184:185]
    v_pk_mul_f32 v[202:203], v[202:203], v[186:187]
    v_pk_mul_f32 v[204:205], v[204:205], v[188:189]
    v_pk_mul_f32 v[206:207], v[206:207], v[190:191]
    v_cvt_pk_bf16_f32 v184, v200, v201
    v_cvt_pk_bf16_f32 v185, v202, v203
    v_cvt_pk_bf16_f32 v186, v204, v205
    v_cvt_pk_bf16_f32 v187, v206, v207
    buffer_store_dwordx4 v[184:187], v23, s[8:11], s47 offen offset:512 sc1
    s_waitcnt vmcnt(17)
    v_mfma_f32_16x16x32_bf16 v[64:67], a[192:195], v[208:211], 0
    s_add_u32 s55, s52, 12288
    buffer_load_dwordx4 v[176:179], v4, s[8:11], s55 offen sc1
    v_mfma_f32_16x16x32_bf16 v[68:71], a[196:199], v[208:211], 0
    buffer_load_dwordx4 v[180:183], v5, s[8:11], s55 offen sc1
    v_mfma_f32_16x16x32_bf16 v[72:75], a[200:203], v[208:211], 0
    buffer_load_dwordx4 v[184:187], v6, s[8:11], s55 offen sc1
    v_mfma_f32_16x16x32_bf16 v[76:79], a[204:207], v[208:211], 0
    buffer_load_dwordx4 v[188:191], v7, s[8:11], s55 offen sc1
    v_mfma_f32_16x16x32_bf16 v[80:83], a[208:211], v[208:211], 0
    s_waitcnt vmcnt(20)
    v_mfma_f32_16x16x32_bf16 v[84:87], a[192:195], v[212:215], 0
    v_mfma_f32_16x16x32_bf16 v[88:91], a[196:199], v[212:215], 0
    v_mfma_f32_16x16x32_bf16 v[92:95], a[200:203], v[212:215], 0
    s_add_u32 s55, s52, 16384
    buffer_load_dwordx4 v[192:195], v4, s[8:11], s55 offen sc1
    v_mfma_f32_16x16x32_bf16 v[96:99], a[204:207], v[212:215], 0
    v_mfma_f32_16x16x32_bf16 v[100:103], a[208:211], v[212:215], 0
    s_waitcnt vmcnt(20)
    v_mfma_f32_16x16x32_bf16 v[104:107], a[192:195], v[216:219], 0
    v_mfma_f32_16x16x32_bf16 v[108:111], a[196:199], v[216:219], 0
    buffer_load_dwordx4 v[196:199], v5, s[8:11], s55 offen sc1
    v_mfma_f32_16x16x32_bf16 v[112:115], a[200:203], v[216:219], 0
    v_mfma_f32_16x16x32_bf16 v[116:119], a[204:207], v[216:219], 0
    v_mfma_f32_16x16x32_bf16 v[120:123], a[208:211], v[216:219], 0
    s_waitcnt vmcnt(20)
    v_mfma_f32_16x16x32_bf16 v[124:127], a[192:195], v[220:223], 0
    buffer_load_dwordx4 v[200:203], v6, s[8:11], s55 offen sc1
    v_mfma_f32_16x16x32_bf16 v[128:131], a[196:199], v[220:223], 0
    v_mfma_f32_16x16x32_bf16 v[132:135], a[200:203], v[220:223], 0
    v_mfma_f32_16x16x32_bf16 v[136:139], a[204:207], v[220:223], 0
    v_mfma_f32_16x16x32_bf16 v[140:143], a[208:211], v[220:223], 0
    buffer_load_dwordx4 v[204:207], v7, s[8:11], s55 offen sc1
    s_waitcnt vmcnt(21)
    v_mfma_f32_16x16x32_bf16 v[64:67], a[212:215], v[144:147], v[64:67]
    s_waitcnt vmcnt(8)
    v_mov_b32 v61, s43
    v_mfma_f32_16x16x32_bf16 v[68:71], a[216:219], v[144:147], v[68:71]
    buffer_store_dword v61, v27, s[8:11], s61 offen offset:128 sc1
    v_mfma_f32_16x16x32_bf16 v[72:75], a[220:223], v[144:147], v[72:75]
    ds_read_b64 v[28:29], v18 offset:0
    ds_read_b64 v[38:39], v19 offset:2560
    v_mfma_f32_16x16x32_bf16 v[76:79], a[224:227], v[144:147], v[76:79]
    ds_read_b64 v[48:49], v21 offset:0
    ds_read_b64 v[30:31], v18 offset:32
    v_mfma_f32_16x16x32_bf16 v[80:83], a[228:231], v[144:147], v[80:83]
    ds_read_b64 v[40:41], v19 offset:3072
    v_mfma_f32_16x16x32_bf16 v[84:87], a[212:215], v[148:151], v[84:87]
    s_add_u32 s55, s52, 20480
    buffer_load_dwordx4 v[208:211], v4, s[8:11], s55 offen sc1
    v_mfma_f32_16x16x32_bf16 v[88:91], a[216:219], v[148:151], v[88:91]
    ds_read_b64 v[50:51], v21 offset:32
    ds_read_b64 v[32:33], v18 offset:64
    v_mfma_f32_16x16x32_bf16 v[92:95], a[220:223], v[148:151], v[92:95]
    ds_read_b64 v[42:43], v19 offset:3584
    ds_read_b64 v[52:53], v21 offset:64
    v_mfma_f32_16x16x32_bf16 v[96:99], a[224:227], v[148:151], v[96:99]
    ds_read_b64 v[34:35], v18 offset:96
    ds_read_b64 v[44:45], v19 offset:4096
    v_mfma_f32_16x16x32_bf16 v[100:103], a[228:231], v[148:151], v[100:103]
    buffer_load_dwordx4 v[212:215], v5, s[8:11], s55 offen sc1
    v_mfma_f32_16x16x32_bf16 v[104:107], a[212:215], v[152:155], v[104:107]
    ds_read_b64 v[54:55], v21 offset:96
    ds_read_b64 v[36:37], v18 offset:128
    v_mfma_f32_16x16x32_bf16 v[108:111], a[216:219], v[152:155], v[108:111]
    ds_read_b64 v[46:47], v19 offset:4608
    ds_read_b64 v[56:57], v21 offset:128
    v_mfma_f32_16x16x32_bf16 v[112:115], a[220:223], v[152:155], v[112:115]
    v_mfma_f32_16x16x32_bf16 v[116:119], a[224:227], v[152:155], v[116:119]
    buffer_load_dwordx4 v[216:219], v6, s[8:11], s55 offen sc1
    v_mfma_f32_16x16x32_bf16 v[120:123], a[228:231], v[152:155], v[120:123]
    v_mfma_f32_16x16x32_bf16 v[124:127], a[212:215], v[156:159], v[124:127]
    v_mfma_f32_16x16x32_bf16 v[128:131], a[216:219], v[156:159], v[128:131]
    v_mfma_f32_16x16x32_bf16 v[132:135], a[220:223], v[156:159], v[132:135]
    buffer_load_dwordx4 v[220:223], v7, s[8:11], s55 offen sc1
    v_mfma_f32_16x16x32_bf16 v[136:139], a[224:227], v[156:159], v[136:139]
    v_mfma_f32_16x16x32_bf16 v[140:143], a[228:231], v[156:159], v[140:143]
    v_mfma_f32_16x16x32_bf16 v[64:67], a[232:235], v[160:163], v[64:67]
    v_mfma_f32_16x16x32_bf16 v[68:71], a[236:239], v[160:163], v[68:71]
    s_add_u32 s55, s52, 24576
    buffer_load_dwordx4 v[144:147], v4, s[8:11], s55 offen sc1
    v_mfma_f32_16x16x32_bf16 v[72:75], a[240:243], v[160:163], v[72:75]
    v_mfma_f32_16x16x32_bf16 v[76:79], a[244:247], v[160:163], v[76:79]
    v_mfma_f32_16x16x32_bf16 v[80:83], a[248:251], v[160:163], v[80:83]
    v_mfma_f32_16x16x32_bf16 v[84:87], a[232:235], v[164:167], v[84:87]
    buffer_load_dwordx4 v[148:151], v5, s[8:11], s55 offen sc1
    v_mfma_f32_16x16x32_bf16 v[88:91], a[236:239], v[164:167], v[88:91]
    v_mfma_f32_16x16x32_bf16 v[92:95], a[240:243], v[164:167], v[92:95]
    v_mfma_f32_16x16x32_bf16 v[96:99], a[244:247], v[164:167], v[96:99]
    v_mfma_f32_16x16x32_bf16 v[100:103], a[248:251], v[164:167], v[100:103]
    buffer_load_dwordx4 v[152:155], v6, s[8:11], s55 offen sc1
    v_mfma_f32_16x16x32_bf16 v[104:107], a[232:235], v[168:171], v[104:107]
    v_mfma_f32_16x16x32_bf16 v[108:111], a[236:239], v[168:171], v[108:111]
    v_mfma_f32_16x16x32_bf16 v[112:115], a[240:243], v[168:171], v[112:115]
    v_mfma_f32_16x16x32_bf16 v[116:119], a[244:247], v[168:171], v[116:119]
    buffer_load_dwordx4 v[156:159], v7, s[8:11], s55 offen sc1
    v_mfma_f32_16x16x32_bf16 v[120:123], a[248:251], v[168:171], v[120:123]
    v_mfma_f32_16x16x32_bf16 v[124:127], a[232:235], v[172:175], v[124:127]
    v_mfma_f32_16x16x32_bf16 v[128:131], a[236:239], v[172:175], v[128:131]
    v_mfma_f32_16x16x32_bf16 v[132:135], a[240:243], v[172:175], v[132:135]
    s_add_u32 s55, s52, 28672
    buffer_load_dwordx4 v[160:163], v4, s[8:11], s55 offen sc1
    v_mfma_f32_16x16x32_bf16 v[136:139], a[244:247], v[172:175], v[136:139]
    v_mfma_f32_16x16x32_bf16 v[140:143], a[248:251], v[172:175], v[140:143]
    s_waitcnt vmcnt(17)
    v_mfma_f32_16x16x32_bf16 v[64:67], a[252:255], v[176:179], v[64:67]
    v_mfma_f32_16x16x32_bf16 v[68:71], a[0:3], v[176:179], v[68:71]
    buffer_load_dwordx4 v[164:167], v5, s[8:11], s55 offen sc1
    v_mfma_f32_16x16x32_bf16 v[72:75], a[4:7], v[176:179], v[72:75]
    v_mfma_f32_16x16x32_bf16 v[76:79], a[8:11], v[176:179], v[76:79]
    v_mfma_f32_16x16x32_bf16 v[80:83], a[12:15], v[176:179], v[80:83]
    s_waitcnt vmcnt(17)
    v_mfma_f32_16x16x32_bf16 v[84:87], a[252:255], v[180:183], v[84:87]
    buffer_load_dwordx4 v[168:171], v6, s[8:11], s55 offen sc1
    v_mfma_f32_16x16x32_bf16 v[88:91], a[0:3], v[180:183], v[88:91]
    v_mfma_f32_16x16x32_bf16 v[92:95], a[4:7], v[180:183], v[92:95]
    v_mfma_f32_16x16x32_bf16 v[96:99], a[8:11], v[180:183], v[96:99]
    v_mfma_f32_16x16x32_bf16 v[100:103], a[12:15], v[180:183], v[100:103]
    buffer_load_dwordx4 v[172:175], v7, s[8:11], s55 offen sc1
    s_waitcnt vmcnt(18)
    v_mfma_f32_16x16x32_bf16 v[104:107], a[252:255], v[184:187], v[104:107]
    v_mfma_f32_16x16x32_bf16 v[108:111], a[0:3], v[184:187], v[108:111]
    v_mfma_f32_16x16x32_bf16 v[112:115], a[4:7], v[184:187], v[112:115]
    v_mfma_f32_16x16x32_bf16 v[116:119], a[8:11], v[184:187], v[116:119]
    s_add_u32 s55, s52, 32768
    buffer_load_dwordx4 v[176:179], v4, s[8:11], s55 offen sc1
    v_mfma_f32_16x16x32_bf16 v[120:123], a[12:15], v[184:187], v[120:123]
    s_waitcnt vmcnt(18)
    v_mfma_f32_16x16x32_bf16 v[124:127], a[252:255], v[188:191], v[124:127]
    v_mfma_f32_16x16x32_bf16 v[128:131], a[0:3], v[188:191], v[128:131]
    v_mfma_f32_16x16x32_bf16 v[132:135], a[4:7], v[188:191], v[132:135]
    buffer_load_dwordx4 v[180:183], v5, s[8:11], s55 offen sc1
    v_mfma_f32_16x16x32_bf16 v[136:139], a[8:11], v[188:191], v[136:139]
    v_mfma_f32_16x16x32_bf16 v[140:143], a[12:15], v[188:191], v[140:143]
    s_load_dwordx8 s[64:71], s[34:35], 0 glc
    s_waitcnt vmcnt(18)
    v_mfma_f32_16x16x32_bf16 v[64:67], a[16:19], v[192:195], v[64:67]
    v_mfma_f32_16x16x32_bf16 v[68:71], a[20:23], v[192:195], v[68:71]
    buffer_load_dwordx4 v[184:187], v6, s[8:11], s55 offen sc1
    v_mfma_f32_16x16x32_bf16 v[72:75], a[24:27], v[192:195], v[72:75]
    v_mfma_f32_16x16x32_bf16 v[76:79], a[28:31], v[192:195], v[76:79]
    v_mfma_f32_16x16x32_bf16 v[80:83], a[32:35], v[192:195], v[80:83]
    s_waitcnt vmcnt(18)
    v_mfma_f32_16x16x32_bf16 v[84:87], a[16:19], v[196:199], v[84:87]
    buffer_load_dwordx4 v[188:191], v7, s[8:11], s55 offen sc1
    v_mfma_f32_16x16x32_bf16 v[88:91], a[20:23], v[196:199], v[88:91]
    v_mfma_f32_16x16x32_bf16 v[92:95], a[24:27], v[196:199], v[92:95]
    v_mfma_f32_16x16x32_bf16 v[96:99], a[28:31], v[196:199], v[96:99]
    v_mfma_f32_16x16x32_bf16 v[100:103], a[32:35], v[196:199], v[100:103]
    s_add_u32 s55, s52, 36864
    buffer_load_dwordx4 v[192:195], v4, s[8:11], s55 offen sc1
    s_waitcnt vmcnt(19)
    v_mfma_f32_16x16x32_bf16 v[104:107], a[16:19], v[200:203], v[104:107]
    v_mfma_f32_16x16x32_bf16 v[108:111], a[20:23], v[200:203], v[108:111]
    v_mfma_f32_16x16x32_bf16 v[112:115], a[24:27], v[200:203], v[112:115]
    v_mfma_f32_16x16x32_bf16 v[116:119], a[28:31], v[200:203], v[116:119]
    buffer_load_dwordx4 v[196:199], v5, s[8:11], s55 offen sc1
    v_mfma_f32_16x16x32_bf16 v[120:123], a[32:35], v[200:203], v[120:123]
    s_waitcnt vmcnt(19)
    v_mfma_f32_16x16x32_bf16 v[124:127], a[16:19], v[204:207], v[124:127]
    v_mfma_f32_16x16x32_bf16 v[128:131], a[20:23], v[204:207], v[128:131]
    v_mfma_f32_16x16x32_bf16 v[132:135], a[24:27], v[204:207], v[132:135]
    buffer_load_dwordx4 v[200:203], v6, s[8:11], s55 offen sc1
    v_mfma_f32_16x16x32_bf16 v[136:139], a[28:31], v[204:207], v[136:139]
    v_mfma_f32_16x16x32_bf16 v[140:143], a[32:35], v[204:207], v[140:143]
    s_waitcnt vmcnt(18)
    v_mfma_f32_16x16x32_bf16 v[64:67], a[36:39], v[208:211], v[64:67]
    v_mfma_f32_16x16x32_bf16 v[68:71], a[40:43], v[208:211], v[68:71]
    buffer_load_dwordx4 v[204:207], v7, s[8:11], s55 offen sc1
    v_mfma_f32_16x16x32_bf16 v[72:75], a[44:47], v[208:211], v[72:75]
    v_mfma_f32_16x16x32_bf16 v[76:79], a[48:51], v[208:211], v[76:79]
    v_mfma_f32_16x16x32_bf16 v[80:83], a[52:55], v[208:211], v[80:83]
    s_waitcnt vmcnt(18)
    v_mfma_f32_16x16x32_bf16 v[84:87], a[36:39], v[212:215], v[84:87]
    buffer_load_dwordx4 a[172:175], v3, s[8:11], s54 offen offset:0 sc1
    v_mfma_f32_16x16x32_bf16 v[88:91], a[40:43], v[212:215], v[88:91]
    v_mfma_f32_16x16x32_bf16 v[92:95], a[44:47], v[212:215], v[92:95]
    v_mfma_f32_16x16x32_bf16 v[96:99], a[48:51], v[212:215], v[96:99]
    v_mfma_f32_16x16x32_bf16 v[100:103], a[52:55], v[212:215], v[100:103]
    s_add_u32 s54, s51, 10240
    buffer_load_dwordx4 a[176:179], v2, s[8:11], s54 offen offset:0 sc1
    s_waitcnt vmcnt(19)
    v_mfma_f32_16x16x32_bf16 v[104:107], a[36:39], v[216:219], v[104:107]
    v_mfma_f32_16x16x32_bf16 v[108:111], a[40:43], v[216:219], v[108:111]
    v_mfma_f32_16x16x32_bf16 v[112:115], a[44:47], v[216:219], v[112:115]
    v_mfma_f32_16x16x32_bf16 v[116:119], a[48:51], v[216:219], v[116:119]
    buffer_load_dwordx4 a[180:183], v2, s[8:11], s54 offen offset:1024 sc1
    v_mfma_f32_16x16x32_bf16 v[120:123], a[52:55], v[216:219], v[120:123]
    s_waitcnt vmcnt(19)
    v_mfma_f32_16x16x32_bf16 v[124:127], a[36:39], v[220:223], v[124:127]
    v_mfma_f32_16x16x32_bf16 v[128:131], a[40:43], v[220:223], v[128:131]
    v_mfma_f32_16x16x32_bf16 v[132:135], a[44:47], v[220:223], v[132:135]
    buffer_load_dwordx4 a[184:187], v2, s[8:11], s54 offen offset:2048 sc1
    v_mfma_f32_16x16x32_bf16 v[136:139], a[48:51], v[220:223], v[136:139]
    v_mfma_f32_16x16x32_bf16 v[140:143], a[52:55], v[220:223], v[140:143]
    s_waitcnt lgkmcnt(0)
    s_cmp_lg_u64 s[64:65], s[28:29]
    s_cbranch_scc1 FP1_retry
    s_cmp_lg_u64 s[66:67], s[28:29]
    s_cbranch_scc1 FP1_retry
    s_cmp_lg_u64 s[68:69], s[28:29]
    s_cbranch_scc1 FP1_retry
    s_cmp_lg_u64 s[70:71], s[28:29]
    s_cbranch_scc1 FP1_retry
FP1_back:
    s_waitcnt vmcnt(19)
    v_mfma_f32_16x16x32_bf16 v[64:67], a[56:59], v[144:147], v[64:67]
    v_mfma_f32_16x16x32_bf16 v[68:71], a[60:63], v[144:147], v[68:71]
    s_add_u32 s55, s53, 0
    buffer_load_dwordx4 a[188:191], v4, s[8:11], s55 offen sc1
    v_mfma_f32_16x16x32_bf16 v[72:75], a[64:67], v[144:147], v[72:75]
    v_mfma_f32_16x16x32_bf16 v[76:79], a[68:71], v[144:147], v[76:79]
    v_mfma_f32_16x16x32_bf16 v[80:83], a[72:75], v[144:147], v[80:83]
    s_waitcnt vmcnt(19)
    v_mfma_f32_16x16x32_bf16 v[84:87], a[56:59], v[148:151], v[84:87]
    buffer_load_dwordx4 a[192:195], v5, s[8:11], s55 offen sc1
    v_mfma_f32_16x16x32_bf16 v[88:91], a[60:63], v[148:151], v[88:91]
    v_mfma_f32_16x16x32_bf16 v[92:95], a[64:67], v[148:151], v[92:95]
    v_mfma_f32_16x16x32_bf16 v[96:99], a[68:71], v[148:151], v[96:99]
    v_mfma_f32_16x16x32_bf16 v[100:103], a[72:75], v[148:151], v[100:103]
    buffer_load_dwordx4 a[196:199], v6, s[8:11], s55 offen sc1
    s_waitcnt vmcnt(20)
    v_mfma_f32_16x16x32_bf16 v[104:107], a[56:59], v[152:155], v[104:107]
    v_mfma_f32_16x16x32_bf16 v[108:111], a[60:63], v[152:155], v[108:111]
    v_mfma_f32_16x16x32_bf16 v[112:115], a[64:67], v[152:155], v[112:115]
    v_mfma_f32_16x16x32_bf16 v[116:119], a[68:71], v[152:155], v[116:119]
    buffer_load_dwordx4 a[200:203], v7, s[8:11], s55 offen sc1
    v_mfma_f32_16x16x32_bf16 v[120:123], a[72:75], v[152:155], v[120:123]
    s_waitcnt vmcnt(20)
    v_mfma_f32_16x16x32_bf16 v[124:127], a[56:59], v[156:159], v[124:127]
    v_mfma_f32_16x16x32_bf16 v[128:131], a[60:63], v[156:159], v[128:131]
    v_mfma_f32_16x16x32_bf16 v[132:135], a[64:67], v[156:159], v[132:135]
    s_add_u32 s55, s53, 4096
    buffer_load_dwordx4 a[204:207], v4, s[8:11], s55 offen sc1
    v_mfma_f32_16x16x32_bf16 v[136:139], a[68:71], v[156:159], v[136:139]
    v_mfma_f32_16x16x32_bf16 v[140:143], a[72:75], v[156:159], v[140:143]
    s_waitcnt vmcnt(20)
    v_mfma_f32_16x16x32_bf16 v[64:67], a[76:79], v[160:163], v[64:67]
    v_mfma_f32_16x16x32_bf16 v[68:71], a[80:83], v[160:163], v[68:71]
    buffer_load_dwordx4 a[208:211], v5, s[8:11], s55 offen sc1
    v_mfma_f32_16x16x32_bf16 v[72:75], a[84:87], v[160:163], v[72:75]
    v_mfma_f32_16x16x32_bf16 v[76:79], a[88:91], v[160:163], v[76:79]
    v_mfma_f32_16x16x32_bf16 v[80:83], a[92:95], v[160:163], v[80:83]
    s_waitcnt vmcnt(20)
    v_mfma_f32_16x16x32_bf16 v[84:87], a[76:79], v[164:167], v[84:87]
    buffer_load_dwordx4 a[212:215], v6, s[8:11], s55 offen sc1
    v_mfma_f32_16x16x32_bf16 v[88:91], a[80:83], v[164:167], v[88:91]
    v_mfma_f32_16x16x32_bf16 v[92:95], a[84:87], v[164:167], v[92:95]
    v_mfma_f32_16x16x32_bf16 v[96:99], a[88:91], v[164:167], v[96:99]
    v_mfma_f32_16x16x32_bf16 v[100:103], a[92:95], v[164:167], v[100:103]
    buffer_load_dwordx4 a[216:219], v7, s[8:11], s55 offen sc1
    s_waitcnt vmcnt(21)
    v_mfma_f32_16x16x32_bf16 v[104:107], a[76:79], v[168:171], v[104:107]
    v_mfma_f32_16x16x32_bf16 v[108:111], a[80:83], v[168:171], v[108:111]
    v_mfma_f32_16x16x32_bf16 v[112:115], a[84:87], v[168:171], v[112:115]
    v_mfma_f32_16x16x32_bf16 v[116:119], a[88:91], v[168:171], v[116:119]
    buffer_load_dwordx4 a[220:223], v2, s[8:11], s54 offen offset:3072 sc1
    v_mfma_f32_16x16x32_bf16 v[120:123], a[92:95], v[168:171], v[120:123]
    s_waitcnt vmcnt(21)
    v_mfma_f32_16x16x32_bf16 v[124:127], a[76:79], v[172:175], v[124:127]
    v_mfma_f32_16x16x32_bf16 v[128:131], a[80:83], v[172:175], v[128:131]
    v_mfma_f32_16x16x32_bf16 v[132:135], a[84:87], v[172:175], v[132:135]
    buffer_load_dwordx4 a[224:227], v3, s[8:11], s54 offen offset:0 sc1
    v_mfma_f32_16x16x32_bf16 v[136:139], a[88:91], v[172:175], v[136:139]
    v_mfma_f32_16x16x32_bf16 v[140:143], a[92:95], v[172:175], v[140:143]
    s_waitcnt vmcnt(21)
    v_mfma_f32_16x16x32_bf16 v[64:67], a[96:99], v[176:179], v[64:67]
    v_mfma_f32_16x16x32_bf16 v[68:71], a[100:103], v[176:179], v[68:71]
    s_add_u32 s55, s53, 8192
    buffer_load_dwordx4 a[228:231], v4, s[8:11], s55 offen sc1
    v_mfma_f32_16x16x32_bf16 v[72:75], a[104:107], v[176:179], v[72:75]
    v_mfma_f32_16x16x32_bf16 v[76:79], a[108:111], v[176:179], v[76:79]
    v_mfma_f32_16x16x32_bf16 v[80:83], a[112:115], v[176:179], v[80:83]
    s_waitcnt vmcnt(21)
    v_mfma_f32_16x16x32_bf16 v[84:87], a[96:99], v[180:183], v[84:87]
    buffer_load_dwordx4 a[232:235], v5, s[8:11], s55 offen sc1
    v_mfma_f32_16x16x32_bf16 v[88:91], a[100:103], v[180:183], v[88:91]
    v_mfma_f32_16x16x32_bf16 v[92:95], a[104:107], v[180:183], v[92:95]
    v_mfma_f32_16x16x32_bf16 v[96:99], a[108:111], v[180:183], v[96:99]
    v_mfma_f32_16x16x32_bf16 v[100:103], a[112:115], v[180:183], v[100:103]
    buffer_load_dwordx4 a[236:239], v6, s[8:11], s55 offen sc1
    s_waitcnt vmcnt(22)
    v_mfma_f32_16x16x32_bf16 v[104:107], a[96:99], v[184:187], v[104:107]
    v_mfma_f32_16x16x32_bf16 v[108:111], a[100:103], v[184:187], v[108:111]
    v_mfma_f32_16x16x32_bf16 v[112:115], a[104:107], v[184:187], v[112:115]
    v_mfma_f32_16x16x32_bf16 v[116:119], a[108:111], v[184:187], v[116:119]
    buffer_load_dwordx4 a[240:243], v7, s[8:11], s55 offen sc1
    v_mfma_f32_16x16x32_bf16 v[120:123], a[112:115], v[184:187], v[120:123]
    s_waitcnt vmcnt(22)
    v_mfma_f32_16x16x32_bf16 v[124:127], a[96:99], v[188:191], v[124:127]
    v_mfma_f32_16x16x32_bf16 v[128:131], a[100:103], v[188:191], v[128:131]
    v_mfma_f32_16x16x32_bf16 v[132:135], a[104:107], v[188:191], v[132:135]
    s_add_u32 s54, s51, 15360
    buffer_load_dwordx4 a[244:247], v2, s[8:11], s54 offen offset:0 sc1
    v_mfma_f32_16x16x32_bf16 v[136:139], a[108:111], v[188:191], v[136:139]
    v_mfma_f32_16x16x32_bf16 v[140:143], a[112:115], v[188:191], v[140:143]
    s_waitcnt vmcnt(22)
    v_mfma_f32_16x16x32_bf16 v[64:67], a[116:119], v[192:195], v[64:67]
    v_mfma_f32_16x16x32_bf16 v[68:71], a[120:123], v[192:195], v[68:71]
    buffer_load_dwordx4 a[248:251], v2, s[8:11], s54 offen offset:1024 sc1
    v_mfma_f32_16x16x32_bf16 v[72:75], a[124:127], v[192:195], v[72:75]
    v_mfma_f32_16x16x32_bf16 v[76:79], a[128:131], v[192:195], v[76:79]
    v_mfma_f32_16x16x32_bf16 v[80:83], a[132:135], v[192:195], v[80:83]
    s_waitcnt vmcnt(22)
    v_mfma_f32_16x16x32_bf16 v[84:87], a[116:119], v[196:199], v[84:87]
    buffer_load_dwordx4 a[252:255], v2, s[8:11], s54 offen offset:2048 sc1
    v_mfma_f32_16x16x32_bf16 v[88:91], a[120:123], v[196:199], v[88:91]
    v_mfma_f32_16x16x32_bf16 v[92:95], a[124:127], v[196:199], v[92:95]
    v_mfma_f32_16x16x32_bf16 v[96:99], a[128:131], v[196:199], v[96:99]
    v_mfma_f32_16x16x32_bf16 v[100:103], a[132:135], v[196:199], v[100:103]
    buffer_load_dwordx4 a[0:3], v2, s[8:11], s54 offen offset:3072 sc1
    s_waitcnt vmcnt(23)
    v_mfma_f32_16x16x32_bf16 v[104:107], a[116:119], v[200:203], v[104:107]
    v_mfma_f32_16x16x32_bf16 v[108:111], a[120:123], v[200:203], v[108:111]
    v_mfma_f32_16x16x32_bf16 v[112:115], a[124:127], v[200:203], v[112:115]
    v_mfma_f32_16x16x32_bf16 v[116:119], a[128:131], v[200:203], v[116:119]
    buffer_load_dwordx4 a[4:7], v3, s[8:11], s54 offen offset:0 sc1
    v_mfma_f32_16x16x32_bf16 v[120:123], a[132:135], v[200:203], v[120:123]
    s_waitcnt vmcnt(23)
    v_mfma_f32_16x16x32_bf16 v[124:127], a[116:119], v[204:207], v[124:127]
    v_mfma_f32_16x16x32_bf16 v[128:131], a[120:123], v[204:207], v[128:131]
    v_mfma_f32_16x16x32_bf16 v[132:135], a[124:127], v[204:207], v[132:135]
    s_add_u32 s55, s53, 12288
    buffer_load_dwordx4 a[8:11], v4, s[8:11], s55 offen sc1
    v_mfma_f32_16x16x32_bf16 v[136:139], a[128:131], v[204:207], v[136:139]
    v_mfma_f32_16x16x32_bf16 v[140:143], a[132:135], v[204:207], v[140:143]
    s_waitcnt vmcnt(19)
    v_mfma_f32_16x16x32_bf16 v[144:147], a[136:139], a[188:191], 0
    buffer_load_dwordx4 a[12:15], v5, s[8:11], s55 offen sc1
    v_lshlrev_b32 v224, 16, v28
    v_lshlrev_b32 v62, 16, v38
    v_mfma_f32_16x16x32_bf16 v[148:151], a[140:143], a[188:191], 0
    buffer_load_dwordx4 a[16:19], v6, s[8:11], s55 offen sc1
    v_lshlrev_b32 v63, 16, v48
    v_fmac_f32 v64, v62, v63
    v_mfma_f32_16x16x32_bf16 v[152:155], a[144:147], a[188:191], 0
    buffer_load_dwordx4 a[20:23], v7, s[8:11], s55 offen sc1
    v_and_b32 v225, 0xffff0000, v28
    v_and_b32 v62, 0xffff0000, v38
    v_mfma_f32_16x16x32_bf16 v[156:159], a[148:151], a[188:191], 0
    v_and_b32 v63, 0xffff0000, v48
    v_fmac_f32 v65, v62, v63
    v_lshlrev_b32 v226, 16, v29
    v_mfma_f32_16x16x32_bf16 v[160:163], a[152:155], a[188:191], 0
    v_lshlrev_b32 v62, 16, v39
    v_lshlrev_b32 v63, 16, v49
    s_waitcnt vmcnt(21)
    v_mfma_f32_16x16x32_bf16 v[164:167], a[136:139], a[192:195], 0
    v_fmac_f32 v66, v62, v63
    v_and_b32 v227, 0xffff0000, v29
    v_and_b32 v62, 0xffff0000, v39
    v_mfma_f32_16x16x32_bf16 v[168:171], a[140:143], a[192:195], 0
    s_add_u32 s54, s51, 20480
    buffer_load_dwordx4 a[24:27], v2, s[8:11], s54 offen offset:0 sc1
    v_and_b32 v63, 0xffff0000, v49
    v_mfma_f32_16x16x32_bf16 v[172:175], a[144:147], a[192:195], 0
    v_fmac_f32 v67, v62, v63
    v_lshlrev_b32 v228, 16, v30
    v_lshlrev_b32 v62, 16, v40
    v_mfma_f32_16x16x32_bf16 v[176:179], a[148:151], a[192:195], 0
    v_lshlrev_b32 v63, 16, v50
    v_fmac_f32 v68, v62, v63
    v_and_b32 v229, 0xffff0000, v30
    v_mfma_f32_16x16x32_bf16 v[180:183], a[152:155], a[192:195], 0
    v_and_b32 v62, 0xffff0000, v40
    v_and_b32 v63, 0xffff0000, v50
    s_waitcnt vmcnt(21)
    v_mfma_f32_16x16x32_bf16 v[184:187], a[136:139], a[196:199], 0
    buffer_load_dwordx4 a[28:31], v2, s[8:11], s54 offen offset:1024 sc1
    v_fmac_f32 v69, v62, v63
    v_lshlrev_b32 v230, 16, v31
    v_mfma_f32_16x16x32_bf16 v[188:191], a[140:143], a[196:199], 0
    v_lshlrev_b32 v62, 16, v41
    v_lshlrev_b32 v63, 16, v51
    v_fmac_f32 v70, v62, v63
    v_mfma_f32_16x16x32_bf16 v[192:195], a[144:147], a[196:199], 0
    v_and_b32 v231, 0xffff0000, v31
    v_and_b32 v62, 0xffff0000, v41
    v_and_b32 v63, 0xffff0000, v51
    v_mfma_f32_16x16x32_bf16 v[196:199], a[148:151], a[196:199], 0
    v_fmac_f32 v71, v62, v63
    v_lshlrev_b32 v232, 16, v32
    v_lshlrev_b32 v62, 16, v42
    v_mfma_f32_16x16x32_bf16 v[200:203], a[152:155], a[196:199], 0
    buffer_load_dwordx4 a[32:35], v2, s[8:11], s54 offen offset:2048 sc1
    v_lshlrev_b32 v63, 16, v52
    s_waitcnt vmcnt(22)
    v_mfma_f32_16x16x32_bf16 v[204:207], a[136:139], a[200:203], 0
    v_fmac_f32 v72, v62, v63
    v_and_b32 v233, 0xffff0000, v32
    v_and_b32 v62, 0xffff0000, v42
    v_mfma_f32_16x16x32_bf16 v[208:211], a[140:143], a[200:203], 0
    v_and_b32 v63, 0xffff0000, v52
    v_fmac_f32 v73, v62, v63
    v_lshlrev_b32 v234, 16, v33
    v_mfma_f32_16x16x32_bf16 v[212:215], a[144:147], a[200:203], 0
    v_lshlrev_b32 v62, 16, v43
    v_lshlrev_b32 v63, 16, v53
    v_fmac_f32 v74, v62, v63
    v_mfma_f32_16x16x32_bf16 v[216:219], a[148:151], a[200:203], 0
    buffer_load_dwordx4 a[36:39], v2, s[8:11], s54 offen offset:3072 sc1
    v_and_b32 v235, 0xffff0000, v33
    v_and_b32 v62, 0xffff0000, v43
    v_mfma_f32_16x16x32_bf16 v[220:223], a[152:155], a[200:203], 0
    v_and_b32 v63, 0xffff0000, v53
    v_fmac_f32 v75, v62, v63
    s_waitcnt vmcnt(22)
    v_mfma_f32_16x16x32_bf16 v[144:147], a[156:159], a[204:207], v[144:147]
    buffer_load_dwordx4 a[40:43], v3, s[8:11], s54 offen offset:0 sc1
    v_lshlrev_b32 v236, 16, v34
    v_lshlrev_b32 v62, 16, v44
    v_mfma_f32_16x16x32_bf16 v[148:151], a[160:163], a[204:207], v[148:151]
    s_add_u32 s55, s53, 16384
    buffer_load_dwordx4 a[44:47], v4, s[8:11], s55 offen sc1
    v_lshlrev_b32 v63, 16, v54
    v_mfma_f32_16x16x32_bf16 v[152:155], a[164:167], a[204:207], v[152:155]
    buffer_load_dwordx4 a[48:51], v5, s[8:11], s55 offen sc1
    v_fmac_f32 v76, v62, v63
    v_and_b32 v237, 0xffff0000, v34
    v_mfma_f32_16x16x32_bf16 v[156:159], a[168:171], a[204:207], v[156:159]
    buffer_load_dwordx4 a[52:55], v6, s[8:11], s55 offen sc1
    v_and_b32 v62, 0xffff0000, v44
    v_and_b32 v63, 0xffff0000, v54
    v_mfma_f32_16x16x32_bf16 v[160:163], a[172:175], a[204:207], v[160:163]
    buffer_load_dwordx4 a[56:59], v7, s[8:11], s55 offen sc1
    v_fmac_f32 v77, v62, v63
    s_waitcnt vmcnt(26)
    v_mfma_f32_16x16x32_bf16 v[164:167], a[156:159], a[208:211], v[164:167]
    v_lshlrev_b32 v238, 16, v35
    v_lshlrev_b32 v62, 16, v45
    v_lshlrev_b32 v63, 16, v55
    v_mfma_f32_16x16x32_bf16 v[168:171], a[160:163], a[208:211], v[168:171]
    v_fmac_f32 v78, v62, v63
    v_and_b32 v239, 0xffff0000, v35
    v_and_b32 v62, 0xffff0000, v45
    v_mfma_f32_16x16x32_bf16 v[172:175], a[164:167], a[208:211], v[172:175]
    v_and_b32 v63, 0xffff0000, v55
    v_fmac_f32 v79, v62, v63
    v_lshlrev_b32 v240, 16, v36
    v_mfma_f32_16x16x32_bf16 v[176:179], a[168:171], a[208:211], v[176:179]
    s_add_u32 s54, s51, 25600
    buffer_load_dwordx4 a[60:63], v2, s[8:11], s54 offen offset:0 sc1
    v_lshlrev_b32 v62, 16, v46
    v_mfma_f32_16x16x32_bf16 v[180:183], a[172:175], a[208:211], v[180:183]
    v_lshlrev_b32 v63, 16, v56
    v_fmac_f32 v80, v62, v63
    s_waitcnt vmcnt(26)
    v_mfma_f32_16x16x32_bf16 v[184:187], a[156:159], a[212:215], v[184:187]
    v_and_b32 v241, 0xffff0000, v36
    v_and_b32 v62, 0xffff0000, v46
    v_and_b32 v63, 0xffff0000, v56
    v_mfma_f32_16x16x32_bf16 v[188:191], a[160:163], a[212:215], v[188:191]
    v_fmac_f32 v81, v62, v63
    v_lshlrev_b32 v242, 16, v37
    v_lshlrev_b32 v62, 16, v47
    v_mfma_f32_16x16x32_bf16 v[192:195], a[164:167], a[212:215], v[192:195]
    buffer_load_dwordx4 a[64:67], v2, s[8:11], s54 offen offset:1024 sc1
    v_lshlrev_b32 v63, 16, v57
    v_fmac_f32 v82, v62, v63
    v_mfma_f32_16x16x32_bf16 v[196:199], a[168:171], a[212:215], v[196:199]
    v_and_b32 v243, 0xffff0000, v37
    v_and_b32 v62, 0xffff0000, v47
    v_and_b32 v63, 0xffff0000, v57
    v_mfma_f32_16x16x32_bf16 v[200:203], a[172:175], a[212:215], v[200:203]
    v_fmac_f32 v83, v62, v63
    ds_write_b128 v14, v[84:87] offset:0
    s_waitcnt vmcnt(26)
    v_mfma_f32_16x16x32_bf16 v[204:207], a[156:159], a[216:219], v[204:207]
    ds_write_b128 v14, v[88:91] offset:1024
    ds_write_b128 v14, v[92:95] offset:2048
    ds_write_b128 v14, v[96:99] offset:3072
    v_mfma_f32_16x16x32_bf16 v[208:211], a[160:163], a[216:219], v[208:211]
    buffer_load_dwordx4 a[68:71], v2, s[8:11], s54 offen offset:2048 sc1
    ds_write_b128 v14, v[100:103] offset:4096
    ds_write_b128 v15, v[104:107] offset:0
    v_mfma_f32_16x16x32_bf16 v[212:215], a[164:167], a[216:219], v[212:215]
    ds_write_b128 v15, v[108:111] offset:1024
    ds_write_b128 v15, v[112:115] offset:2048
    ds_write_b128 v15, v[116:119] offset:3072
    v_mfma_f32_16x16x32_bf16 v[216:219], a[168:171], a[216:219], v[216:219]
    ds_write_b128 v15, v[120:123] offset:4096
    ds_write_b128 v16, v[124:127] offset:0
    ds_write_b128 v16, v[128:131] offset:1024
    v_mfma_f32_16x16x32_bf16 v[220:223], a[172:175], a[216:219], v[220:223]
    ds_write_b128 v16, v[132:135] offset:2048
    ds_write_b128 v16, v[136:139] offset:3072
    s_waitcnt vmcnt(24)
    v_mfma_f32_16x16x32_bf16 v[144:147], a[176:179], a[228:231], v[144:147]
    buffer_load_dwordx4 a[72:75], v2, s[8:11], s54 offen offset:3072 sc1
    ds_write_b128 v16, v[140:143] offset:4096
    v_mfma_f32_16x16x32_bf16 v[148:151], a[180:183], a[228:231], v[148:151]
    buffer_load_dwordx4 a[76:79], v3, s[8:11], s54 offen offset:0 sc1
    v_mfma_f32_16x16x32_bf16 v[152:155], a[184:187], a[228:231], v[152:155]
    s_add_u32 s55, s53, 20480
    buffer_load_dwordx4 a[80:83], v4, s[8:11], s55 offen sc1
    v_mfma_f32_16x16x32_bf16 v[156:159], a[220:223], a[228:231], v[156:159]
    buffer_load_dwordx4 a[84:87], v5, s[8:11], s55 offen sc1
    v_mfma_f32_16x16x32_bf16 v[160:163], a[224:227], a[228:231], v[160:163]
    buffer_load_dwordx4 a[88:91], v6, s[8:11], s55 offen sc1
    s_waitcnt vmcnt(28)
    v_mfma_f32_16x16x32_bf16 v[164:167], a[176:179], a[232:235], v[164:167]
    buffer_load_dwordx4 a[92:95], v7, s[8:11], s55 offen sc1
    v_mfma_f32_16x16x32_bf16 v[168:171], a[180:183], a[232:235], v[168:171]
    v_mfma_f32_16x16x32_bf16 v[172:175], a[184:187], a[232:235], v[172:175]
    v_mfma_f32_16x16x32_bf16 v[176:179], a[220:223], a[232:235], v[176:179]
    v_mfma_f32_16x16x32_bf16 v[180:183], a[224:227], a[232:235], v[180:183]
    s_add_u32 s54, s51, 30720
    buffer_load_dwordx4 a[96:99], v2, s[8:11], s54 offen offset:0 sc1
    s_waitcnt vmcnt(29)
    v_mfma_f32_16x16x32_bf16 v[184:187], a[176:179], a[236:239], v[184:187]
    v_mfma_f32_16x16x32_bf16 v[188:191], a[180:183], a[236:239], v[188:191]
    v_mfma_f32_16x16x32_bf16 v[192:195], a[184:187], a[236:239], v[192:195]
    v_mfma_f32_16x16x32_bf16 v[196:199], a[220:223], a[236:239], v[196:199]
    buffer_load_dwordx4 a[100:103], v2, s[8:11], s54 offen offset:1024 sc1
    v_mfma_f32_16x16x32_bf16 v[200:203], a[224:227], a[236:239], v[200:203]
    s_waitcnt vmcnt(29)
    v_mfma_f32_16x16x32_bf16 v[204:207], a[176:179], a[240:243], v[204:207]
    v_mfma_f32_16x16x32_bf16 v[208:211], a[180:183], a[240:243], v[208:211]
    v_mfma_f32_16x16x32_bf16 v[212:215], a[184:187], a[240:243], v[212:215]
    buffer_load_dwordx4 a[104:107], v2, s[8:11], s54 offen offset:2048 sc1
    v_mfma_f32_16x16x32_bf16 v[216:219], a[220:223], a[240:243], v[216:219]
    v_mfma_f32_16x16x32_bf16 v[220:223], a[224:227], a[240:243], v[220:223]
    s_waitcnt vmcnt(24)
    v_mfma_f32_16x16x32_bf16 v[144:147], a[244:247], a[8:11], v[144:147]
    buffer_load_dwordx4 a[108:111], v2, s[8:11], s54 offen offset:3072 sc1
    v_mfma_f32_16x16x32_bf16 v[148:151], a[248:251], a[8:11], v[148:151]
    buffer_load_dwordx4 a[112:115], v3, s[8:11], s54 offen offset:0 sc1
    v_mfma_f32_16x16x32_bf16 v[152:155], a[252:255], a[8:11], v[152:155]
    s_add_u32 s55, s53, 24576
    buffer_load_dwordx4 a[116:119], v4, s[8:11], s55 offen sc1
    v_mfma_f32_16x16x32_bf16 v[156:159], a[0:3], a[8:11], v[156:159]
    buffer_load_dwordx4 a[120:123], v5, s[8:11], s55 offen sc1
    v_mfma_f32_16x16x32_bf16 v[160:163], a[4:7], a[8:11], v[160:163]
    buffer_load_dwordx4 a[124:127], v6, s[8:11], s55 offen sc1
    s_waitcnt vmcnt(28)
    v_mfma_f32_16x16x32_bf16 v[164:167], a[244:247], a[12:15], v[164:167]
    buffer_load_dwordx4 a[128:131], v7, s[8:11], s55 offen sc1
    v_mfma_f32_16x16x32_bf16 v[168:171], a[248:251], a[12:15], v[168:171]
    v_mfma_f32_16x16x32_bf16 v[172:175], a[252:255], a[12:15], v[172:175]
    v_mfma_f32_16x16x32_bf16 v[176:179], a[0:3], a[12:15], v[176:179]
    v_mfma_f32_16x16x32_bf16 v[180:183], a[4:7], a[12:15], v[180:183]
    s_add_u32 s54, s51, 35840
    buffer_load_dwordx4 a[132:135], v2, s[8:11], s54 offen offset:0 sc1
    s_waitcnt vmcnt(29)
    v_mfma_f32_16x16x32_bf16 v[184:187], a[244:247], a[16:19], v[184:187]
    v_mfma_f32_16x16x32_bf16 v[188:191], a[248:251], a[16:19], v[188:191]
    v_mfma_f32_16x16x32_bf16 v[192:195], a[252:255], a[16:19], v[192:195]
    v_mfma_f32_16x16x32_bf16 v[196:199], a[0:3], a[16:19], v[196:199]
    buffer_load_dwordx4 a[188:191], v2, s[8:11], s54 offen offset:1024 sc1
    v_mfma_f32_16x16x32_bf16 v[200:203], a[4:7], a[16:19], v[200:203]
    s_waitcnt vmcnt(29)
    v_mfma_f32_16x16x32_bf16 v[204:207], a[244:247], a[20:23], v[204:207]
    v_mfma_f32_16x16x32_bf16 v[208:211], a[248:251], a[20:23], v[208:211]
    v_mfma_f32_16x16x32_bf16 v[212:215], a[252:255], a[20:23], v[212:215]
    buffer_load_dwordx4 a[192:195], v2, s[8:11], s54 offen offset:2048 sc1
    v_mfma_f32_16x16x32_bf16 v[216:219], a[0:3], a[20:23], v[216:219]
    v_mfma_f32_16x16x32_bf16 v[220:223], a[4:7], a[20:23], v[220:223]
    s_waitcnt vmcnt(24)
    v_mfma_f32_16x16x32_bf16 v[144:147], a[24:27], a[44:47], v[144:147]
    buffer_load_dwordx4 a[196:199], v2, s[8:11], s54 offen offset:3072 sc1
    v_mfma_f32_16x16x32_bf16 v[148:151], a[28:31], a[44:47], v[148:151]
    buffer_load_dwordx4 a[136:139], v3, s[8:11], s54 offen offset:0 sc1
    v_mfma_f32_16x16x32_bf16 v[152:155], a[32:35], a[44:47], v[152:155]
    s_add_u32 s55, s53, 28672
    buffer_load_dwordx4 a[140:143], v4, s[8:11], s55 offen sc1
    v_mfma_f32_16x16x32_bf16 v[156:159], a[36:39], a[44:47], v[156:159]
    buffer_load_dwordx4 a[144:147], v5, s[8:11], s55 offen sc1
    v_mfma_f32_16x16x32_bf16 v[160:163], a[40:43], a[44:47], v[160:163]
    buffer_load_dwordx4 a[148:151], v6, s[8:11], s55 offen sc1
    s_waitcnt vmcnt(28)
    v_mfma_f32_16x16x32_bf16 v[164:167], a[24:27], a[48:51], v[164:167]
    buffer_load_dwordx4 a[152:155], v7, s[8:11], s55 offen sc1
    v_mfma_f32_16x16x32_bf16 v[168:171], a[28:31], a[48:51], v[168:171]
    v_mfma_f32_16x16x32_bf16 v[172:175], a[32:35], a[48:51], v[172:175]
    v_mfma_f32_16x16x32_bf16 v[176:179], a[36:39], a[48:51], v[176:179]
    v_mfma_f32_16x16x32_bf16 v[180:183], a[40:43], a[48:51], v[180:183]
    s_add_u32 s54, s51, 40960
    buffer_load_dwordx4 a[200:203], v2, s[8:11], s54 offen offset:0 sc1
    s_waitcnt vmcnt(29)
    v_mfma_f32_16x16x32_bf16 v[184:187], a[24:27], a[52:55], v[184:187]
    v_mfma_f32_16x16x32_bf16 v[188:191], a[28:31], a[52:55], v[188:191]
    v_mfma_f32_16x16x32_bf16 v[192:195], a[32:35], a[52:55], v[192:195]
    v_mfma_f32_16x16x32_bf16 v[196:199], a[36:39], a[52:55], v[196:199]
    buffer_load_dwordx4 a[204:207], v2, s[8:11], s54 offen offset:1024 sc1
    v_mfma_f32_16x16x32_bf16 v[200:203], a[40:43], a[52:55], v[200:203]
    s_waitcnt vmcnt(29)
    v_mfma_f32_16x16x32_bf16 v[204:207], a[24:27], a[56:59], v[204:207]
    v_mfma_f32_16x16x32_bf16 v[208:211], a[28:31], a[56:59], v[208:211]
    v_mfma_f32_16x16x32_bf16 v[212:215], a[32:35], a[56:59], v[212:215]
    buffer_load_dwordx4 a[208:211], v2, s[8:11], s54 offen offset:2048 sc1
    v_mfma_f32_16x16x32_bf16 v[216:219], a[36:39], a[56:59], v[216:219]
    v_mfma_f32_16x16x32_bf16 v[220:223], a[40:43], a[56:59], v[220:223]
    s_waitcnt vmcnt(24)
    v_mfma_f32_16x16x32_bf16 v[144:147], a[60:63], a[80:83], v[144:147]
    buffer_load_dwordx4 a[212:215], v2, s[8:11], s54 offen offset:3072 sc1
    v_mfma_f32_16x16x32_bf16 v[148:151], a[64:67], a[80:83], v[148:151]
    buffer_load_dwordx4 a[156:159], v3, s[8:11], s54 offen offset:0 sc1
    v_mfma_f32_16x16x32_bf16 v[152:155], a[68:71], a[80:83], v[152:155]
    s_add_u32 s55, s53, 32768
    buffer_load_dwordx4 a[160:163], v4, s[8:11], s55 offen sc1
    v_mfma_f32_16x16x32_bf16 v[156:159], a[72:75], a[80:83], v[156:159]
    buffer_load_dwordx4 a[164:167], v5, s[8:11], s55 offen sc1
    v_mfma_f32_16x16x32_bf16 v[160:163], a[76:79], a[80:83], v[160:163]
    buffer_load_dwordx4 a[168:171], v6, s[8:11], s55 offen sc1
    s_waitcnt vmcnt(28)
    v_mfma_f32_16x16x32_bf16 v[164:167], a[60:63], a[84:87], v[164:167]
    buffer_load_dwordx4 a[172:175], v7, s[8:11], s55 offen sc1
    v_mfma_f32_16x16x32_bf16 v[168:171], a[64:67], a[84:87], v[168:171]
    v_mfma_f32_16x16x32_bf16 v[172:175], a[68:71], a[84:87], v[172:175]
    v_mfma_f32_16x16x32_bf16 v[176:179], a[72:75], a[84:87], v[176:179]
    v_mfma_f32_16x16x32_bf16 v[180:183], a[76:79], a[84:87], v[180:183]
    s_add_u32 s54, s51, 46080
    buffer_load_dwordx4 a[216:219], v2, s[8:11], s54 offen offset:0 sc1
    s_waitcnt vmcnt(29)
    v_mfma_f32_16x16x32_bf16 v[184:187], a[60:63], a[88:91], v[184:187]
    v_mfma_f32_16x16x32_bf16 v[188:191], a[64:67], a[88:91], v[188:191]
    v_mfma_f32_16x16x32_bf16 v[192:195], a[68:71], a[88:91], v[192:195]
    v_mfma_f32_16x16x32_bf16 v[196:199], a[72:75], a[88:91], v[196:199]
    buffer_load_dwordx4 a[228:231], v2, s[8:11], s54 offen offset:1024 sc1
    v_mfma_f32_16x16x32_bf16 v[200:203], a[76:79], a[88:91], v[200:203]
    s_waitcnt vmcnt(29)
    v_mfma_f32_16x16x32_bf16 v[204:207], a[60:63], a[92:95], v[204:207]
    v_mfma_f32_16x16x32_bf16 v[208:211], a[64:67], a[92:95], v[208:211]
    v_mfma_f32_16x16x32_bf16 v[212:215], a[68:71], a[92:95], v[212:215]
    buffer_load_dwordx4 a[232:235], v2, s[8:11], s54 offen offset:2048 sc1
    v_mfma_f32_16x16x32_bf16 v[216:219], a[72:75], a[92:95], v[216:219]
    v_mfma_f32_16x16x32_bf16 v[220:223], a[76:79], a[92:95], v[220:223]
    s_waitcnt lgkmcnt(0)
    s_barrier
    s_waitcnt vmcnt(24)
    v_mfma_f32_16x16x32_bf16 v[144:147], a[96:99], a[116:119], v[144:147]
    buffer_load_dwordx4 a[236:239], v2, s[8:11], s54 offen offset:3072 sc1
    ds_read_b128 v[84:87], v17 offset:0
    ds_read_b128 v[88:91], v17 offset:1024
    v_mfma_f32_16x16x32_bf16 v[148:151], a[100:103], a[116:119], v[148:151]
    buffer_load_dwordx4 a[176:179], v3, s[8:11], s54 offen offset:0 sc1
    ds_read_b128 v[92:95], v17 offset:2048
    ds_read_b128 v[96:99], v17 offset:3072
    v_mfma_f32_16x16x32_bf16 v[152:155], a[104:107], a[116:119], v[152:155]
    s_add_u32 s55, s53, 36864
    buffer_load_dwordx4 a[180:183], v4, s[8:11], s55 offen sc1
    ds_read_b128 v[100:103], v17 offset:4096
    v_mfma_f32_16x16x32_bf16 v[156:159], a[108:111], a[116:119], v[156:159]
    buffer_load_dwordx4 a[184:187], v5, s[8:11], s55 offen sc1
    ds_read_b128 v[104:107], v17 offset:5120
    ds_read_b128 v[108:111], v17 offset:6144
    v_mfma_f32_16x16x32_bf16 v[160:163], a[112:115], a[116:119], v[160:163]
    buffer_load_dwordx4 a[220:223], v6, s[8:11], s55 offen sc1
    ds_read_b128 v[112:115], v17 offset:7168
    s_waitcnt vmcnt(28)
    v_mfma_f32_16x16x32_bf16 v[164:167], a[96:99], a[120:123], v[164:167]
    buffer_load_dwordx4 a[224:227], v7, s[8:11], s55 offen sc1
    ds_read_b128 v[116:119], v17 offset:8192
    ds_read_b128 v[120:123], v17 offset:9216
    v_mfma_f32_16x16x32_bf16 v[168:171], a[100:103], a[120:123], v[168:171]
    ds_read_b128 v[124:127], v17 offset:10240
    ds_read_b128 v[128:131], v17 offset:11264
    ds_read_b128 v[132:135], v17 offset:12288
    v_mfma_f32_16x16x32_bf16 v[172:175], a[104:107], a[120:123], v[172:175]
    ds_read_b128 v[136:139], v17 offset:13312
    ds_read_b128 v[140:143], v17 offset:14336
    s_waitcnt lgkmcnt(14)
    v_add_f32 v64, v64, v84
    v_mfma_f32_16x16x32_bf16 v[176:179], a[108:111], a[120:123], v[176:179]
    v_add_f32 v65, v65, v85
    v_add_f32 v66, v66, v86
    v_add_f32 v67, v67, v87
    v_mfma_f32_16x16x32_bf16 v[180:183], a[112:115], a[120:123], v[180:183]
    s_add_u32 s54, s51, 51200
    buffer_load_dwordx4 a[240:243], v2, s[8:11], s54 offen offset:0 sc1
    s_waitcnt vmcnt(29)
    v_mfma_f32_16x16x32_bf16 v[184:187], a[96:99], a[124:127], v[184:187]
    s_waitcnt lgkmcnt(13)
    v_add_f32 v68, v68, v88
    v_add_f32 v69, v69, v89
    v_add_f32 v70, v70, v90
    v_mfma_f32_16x16x32_bf16 v[188:191], a[100:103], a[124:127], v[188:191]
    v_add_f32 v71, v71, v91
    s_waitcnt lgkmcnt(12)
    v_add_f32 v72, v72, v92
    v_add_f32 v73, v73, v93
    v_mfma_f32_16x16x32_bf16 v[192:195], a[104:107], a[124:127], v[192:195]
    v_add_f32 v74, v74, v94
    v_add_f32 v75, v75, v95
    s_waitcnt lgkmcnt(11)
    v_add_f32 v76, v76, v96
    v_mfma_f32_16x16x32_bf16 v[196:199], a[108:111], a[124:127], v[196:199]
    buffer_load_dwordx4 a[8:11], v2, s[8:11], s54 offen offset:1024 sc1
    v_add_f32 v77, v77, v97
    v_add_f32 v78, v78, v98
    v_mfma_f32_16x16x32_bf16 v[200:203], a[112:115], a[124:127], v[200:203]
    v_add_f32 v79, v79, v99
    s_waitcnt lgkmcnt(10)
    v_add_f32 v80, v80, v100
    s_waitcnt vmcnt(29)
    v_mfma_f32_16x16x32_bf16 v[204:207], a[96:99], a[128:131], v[204:207]
    v_add_f32 v81, v81, v101
    v_add_f32 v82, v82, v102
    v_add_f32 v83, v83, v103
    v_mfma_f32_16x16x32_bf16 v[208:211], a[100:103], a[128:131], v[208:211]
    s_waitcnt lgkmcnt(9)
    v_add_f32 v64, v64, v104
    v_add_f32 v65, v65, v105
    v_add_f32 v66, v66, v106
    v_mfma_f32_16x16x32_bf16 v[212:215], a[104:107], a[128:131], v[212:215]
    buffer_load_dwordx4 a[12:15], v2, s[8:11], s54 offen offset:2048 sc1
    v_add_f32 v67, v67, v107
    s_waitcnt lgkmcnt(8)
    v_add_f32 v68, v68, v108
    v_mfma_f32_16x16x32_bf16 v[216:219], a[108:111], a[128:131], v[216:219]
    v_add_f32 v69, v69, v109
    v_add_f32 v70, v70, v110
    v_add_f32 v71, v71, v111
    v_mfma_f32_16x16x32_bf16 v[220:223], a[112:115], a[128:131], v[220:223]
    s_waitcnt lgkmcnt(7)
    v_add_f32 v72, v72, v112
    v_add_f32 v73, v73, v113
    s_waitcnt vmcnt(24)
    v_mfma_f32_16x16x32_bf16 v[144:147], a[132:135], a[140:143], v[144:147]
    buffer_load_dwordx4 a[16:19], v2, s[8:11], s54 offen offset:3072 sc1
    v_add_f32 v74, v74, v114
    v_add_f32 v75, v75, v115
    v_mfma_f32_16x16x32_bf16 v[148:151], a[188:191], a[140:143], v[148:151]
    buffer_load_dwordx4 a[244:247], v3, s[8:11], s54 offen offset:0 sc1
    s_waitcnt lgkmcnt(6)
    v_add_f32 v76, v76, v116
    v_add_f32 v77, v77, v117
    v_mfma_f32_16x16x32_bf16 v[152:155], a[192:195], a[140:143], v[152:155]
    s_add_u32 s54, s51, 56320
    buffer_load_dwordx4 a[248:251], v2, s[8:11], s54 offen offset:0 sc1
    v_add_f32 v78, v78, v118
    v_mfma_f32_16x16x32_bf16 v[156:159], a[196:199], a[140:143], v[156:159]
    buffer_load_dwordx4 a[252:255], v2, s[8:11], s54 offen offset:1024 sc1
    v_add_f32 v79, v79, v119
    s_waitcnt lgkmcnt(5)
    v_add_f32 v80, v80, v120
    v_mfma_f32_16x16x32_bf16 v[160:163], a[136:139], a[140:143], v[160:163]
    buffer_load_dwordx4 a[0:3], v2, s[8:11], s54 offen offset:2048 sc1
    v_add_f32 v81, v81, v121
    s_waitcnt vmcnt(28)
    v_mfma_f32_16x16x32_bf16 v[164:167], a[132:135], a[144:147], v[164:167]
    buffer_load_dwordx4 a[4:7], v2, s[8:11], s54 offen offset:3072 sc1
    v_add_f32 v82, v82, v122
    v_add_f32 v83, v83, v123
    v_mfma_f32_16x16x32_bf16 v[168:171], a[188:191], a[144:147], v[168:171]
    buffer_load_dwordx4 a[20:23], v3, s[8:11], s54 offen offset:0 sc1
    s_waitcnt lgkmcnt(4)
    v_add_f32 v64, v64, v124
    v_add_f32 v65, v65, v125
    v_mfma_f32_16x16x32_bf16 v[172:175], a[192:195], a[144:147], v[172:175]
    s_add_u32 s55, s53, 40960
    buffer_load_dwordx4 a[44:47], v5, s[8:11], s55 offen sc1
    v_add_f32 v66, v66, v126
    v_mfma_f32_16x16x32_bf16 v[176:179], a[196:199], a[144:147], v[176:179]
    s_add_u32 s55, s53, 45056
    buffer_load_dwordx4 a[48:51], v5, s[8:11], s55 offen sc1
    v_add_f32 v67, v67, v127
    v_mfma_f32_16x16x32_bf16 v[180:183], a[136:139], a[144:147], v[180:183]
    s_add_u32 s55, s53, 40960
    buffer_load_dwordx4 a[52:55], v6, s[8:11], s55 offen sc1
    s_waitcnt vmcnt(32)
    v_mfma_f32_16x16x32_bf16 v[184:187], a[132:135], a[148:151], v[184:187]
    s_add_u32 s55, s53, 45056
    buffer_load_dwordx4 a[24:27], v6, s[8:11], s55 offen sc1
    s_waitcnt lgkmcnt(3)
    v_add_f32 v68, v68, v128
    v_mfma_f32_16x16x32_bf16 v[188:191], a[188:191], a[148:151], v[188:191]
    v_add_f32 v69, v69, v129
    v_add_f32 v70, v70, v130
    v_add_f32 v71, v71, v131
    v_mfma_f32_16x16x32_bf16 v[192:195], a[192:195], a[148:151], v[192:195]
    s_waitcnt lgkmcnt(2)
    v_add_f32 v72, v72, v132
    v_add_f32 v73, v73, v133
    v_add_f32 v74, v74, v134
    v_mfma_f32_16x16x32_bf16 v[196:199], a[196:199], a[148:151], v[196:199]
    v_add_f32 v75, v75, v135
    s_waitcnt lgkmcnt(1)
    v_add_f32 v76, v76, v136
    v_add_f32 v77, v77, v137
    v_mfma_f32_16x16x32_bf16 v[200:203], a[136:139], a[148:151], v[200:203]
    s_add_u32 s55, s53, 40960
    buffer_load_dwordx4 a[28:31], v7, s[8:11], s55 offen sc1
    s_waitcnt vmcnt(33)
    v_mfma_f32_16x16x32_bf16 v[204:207], a[132:135], a[152:155], v[204:207]
    v_add_f32 v78, v78, v138
    v_add_f32 v79, v79, v139
    s_waitcnt lgkmcnt(0)
    v_add_f32 v80, v80, v140
    v_mfma_f32_16x16x32_bf16 v[208:211], a[188:191], a[152:155], v[208:211]
    v_add_f32 v81, v81, v141
    v_add_f32 v82, v82, v142
    v_add_f32 v83, v83, v143
    v_mfma_f32_16x16x32_bf16 v[212:215], a[192:195], a[152:155], v[212:215]
    v_mfma_f32_16x16x32_bf16 v[216:219], a[196:199], a[152:155], v[216:219]
    s_add_u32 s55, s53, 45056
    buffer_load_dwordx4 a[32:35], v7, s[8:11], s55 offen sc1
    v_mfma_f32_16x16x32_bf16 v[220:223], a[136:139], a[152:155], v[220:223]
    s_waitcnt vmcnt(28)
    v_mfma_f32_16x16x32_bf16 v[144:147], a[200:203], a[160:163], v[144:147]
    s_add_u32 s55, s53, 40960
    buffer_load_dwordx4 a[36:39], v4, s[8:11], s55 offen sc1
    v_mfma_f32_16x16x32_bf16 v[148:151], a[204:207], a[160:163], v[148:151]
    s_add_u32 s55, s53, 45056
    buffer_load_dwordx4 a[40:43], v4, s[8:11], s55 offen sc1
    v_mfma_f32_16x16x32_bf16 v[152:155], a[208:211], a[160:163], v[152:155]
    v_mfma_f32_16x16x32_bf16 v[156:159], a[212:215], a[160:163], v[156:159]
    v_mfma_f32_16x16x32_bf16 v[160:163], a[156:159], a[160:163], v[160:163]
    s_waitcnt vmcnt(29)
    v_mfma_f32_16x16x32_bf16 v[164:167], a[200:203], a[164:167], v[164:167]
    v_mfma_f32_16x16x32_bf16 v[168:171], a[204:207], a[164:167], v[168:171]
    v_mfma_f32_16x16x32_bf16 v[172:175], a[208:211], a[164:167], v[172:175]
    v_mfma_f32_16x16x32_bf16 v[176:179], a[212:215], a[164:167], v[176:179]
    v_mfma_f32_16x16x32_bf16 v[180:183], a[156:159], a[164:167], v[180:183]
    s_waitcnt vmcnt(28)
    v_mfma_f32_16x16x32_bf16 v[184:187], a[200:203], a[168:171], v[184:187]
    v_mfma_f32_16x16x32_bf16 v[188:191], a[204:207], a[168:171], v[188:191]
    v_mfma_f32_16x16x32_bf16 v[192:195], a[208:211], a[168:171], v[192:195]
    v_mfma_f32_16x16x32_bf16 v[196:199], a[212:215], a[168:171], v[196:199]
    v_mfma_f32_16x16x32_bf16 v[200:203], a[156:159], a[168:171], v[200:203]
    s_waitcnt vmcnt(27)
    v_mfma_f32_16x16x32_bf16 v[204:207], a[200:203], a[172:175], v[204:207]
    v_mfma_f32_16x16x32_bf16 v[208:211], a[204:207], a[172:175], v[208:211]
    v_mfma_f32_16x16x32_bf16 v[212:215], a[208:211], a[172:175], v[212:215]
    v_mfma_f32_16x16x32_bf16 v[216:219], a[212:215], a[172:175], v[216:219]
    v_mfma_f32_16x16x32_bf16 v[220:223], a[156:159], a[172:175], v[220:223]
    s_waitcnt vmcnt(21)
    v_mfma_f32_16x16x32_bf16 v[144:147], a[216:219], a[180:183], v[144:147]
    v_mfma_f32_16x16x32_bf16 v[148:151], a[228:231], a[180:183], v[148:151]
    v_mfma_f32_16x16x32_bf16 v[152:155], a[232:235], a[180:183], v[152:155]
    v_mfma_f32_16x16x32_bf16 v[156:159], a[236:239], a[180:183], v[156:159]
    v_mfma_f32_16x16x32_bf16 v[160:163], a[176:179], a[180:183], v[160:163]
    s_waitcnt vmcnt(20)
    v_mfma_f32_16x16x32_bf16 v[164:167], a[216:219], a[184:187], v[164:167]
    v_mfma_f32_16x16x32_bf16 v[168:171], a[228:231], a[184:187], v[168:171]
    v_mfma_f32_16x16x32_bf16 v[172:175], a[232:235], a[184:187], v[172:175]
    v_mfma_f32_16x16x32_bf16 v[176:179], a[236:239], a[184:187], v[176:179]
    v_mfma_f32_16x16x32_bf16 v[180:183], a[176:179], a[184:187], v[180:183]
    s_waitcnt vmcnt(19)
    v_mfma_f32_16x16x32_bf16 v[184:187], a[216:219], a[220:223], v[184:187]
    v_mfma_f32_16x16x32_bf16 v[188:191], a[228:231], a[220:223], v[188:191]
    v_mfma_f32_16x16x32_bf16 v[192:195], a[232:235], a[220:223], v[192:195]
    v_mfma_f32_16x16x32_bf16 v[196:199], a[236:239], a[220:223], v[196:199]
    v_mfma_f32_16x16x32_bf16 v[200:203], a[176:179], a[220:223], v[200:203]
    s_waitcnt vmcnt(18)
    v_mfma_f32_16x16x32_bf16 v[204:207], a[216:219], a[224:227], v[204:207]
    v_mfma_f32_16x16x32_bf16 v[208:211], a[228:231], a[224:227], v[208:211]
    v_mfma_f32_16x16x32_bf16 v[212:215], a[232:235], a[224:227], v[212:215]
    v_mfma_f32_16x16x32_bf16 v[216:219], a[236:239], a[224:227], v[216:219]
    v_mfma_f32_16x16x32_bf16 v[220:223], a[176:179], a[224:227], v[220:223]
    s_waitcnt vmcnt(7)
    v_mfma_f32_16x16x32_bf16 v[164:167], a[240:243], a[44:47], v[164:167]
    v_mfma_f32_16x16x32_bf16 v[168:171], a[8:11], a[44:47], v[168:171]
    v_mfma_f32_16x16x32_bf16 v[172:175], a[12:15], a[44:47], v[172:175]
    v_mfma_f32_16x16x32_bf16 v[176:179], a[16:19], a[44:47], v[176:179]
    v_mfma_f32_16x16x32_bf16 v[180:183], a[244:247], a[44:47], v[180:183]
    s_waitcnt vmcnt(6)
    v_mfma_f32_16x16x32_bf16 v[164:167], a[248:251], a[48:51], v[164:167]
    v_mfma_f32_16x16x32_bf16 v[168:171], a[252:255], a[48:51], v[168:171]
    v_mfma_f32_16x16x32_bf16 v[172:175], a[0:3], a[48:51], v[172:175]
    v_mfma_f32_16x16x32_bf16 v[176:179], a[4:7], a[48:51], v[176:179]
    v_mfma_f32_16x16x32_bf16 v[180:183], a[20:23], a[48:51], v[180:183]
    s_waitcnt vmcnt(5)
    v_mfma_f32_16x16x32_bf16 v[184:187], a[240:243], a[52:55], v[184:187]
    v_mfma_f32_16x16x32_bf16 v[188:191], a[8:11], a[52:55], v[188:191]
    v_mfma_f32_16x16x32_bf16 v[192:195], a[12:15], a[52:55], v[192:195]
    ds_write_b128 v244, v[164:167] offset:0
    v_mfma_f32_16x16x32_bf16 v[196:199], a[16:19], a[52:55], v[196:199]
    ds_write_b128 v244, v[168:171] offset:1024
    v_mfma_f32_16x16x32_bf16 v[200:203], a[244:247], a[52:55], v[200:203]
    ds_write_b128 v244, v[172:175] offset:2048
    s_waitcnt vmcnt(4)
    v_mfma_f32_16x16x32_bf16 v[184:187], a[248:251], a[24:27], v[184:187]
    ds_write_b128 v244, v[176:179] offset:3072
    v_mfma_f32_16x16x32_bf16 v[188:191], a[252:255], a[24:27], v[188:191]
    ds_write_b128 v244, v[180:183] offset:4096
    v_mfma_f32_16x16x32_bf16 v[192:195], a[0:3], a[24:27], v[192:195]
    v_mfma_f32_16x16x32_bf16 v[196:199], a[4:7], a[24:27], v[196:199]
    v_mfma_f32_16x16x32_bf16 v[200:203], a[20:23], a[24:27], v[200:203]
    s_waitcnt vmcnt(3)
    v_mfma_f32_16x16x32_bf16 v[204:207], a[240:243], a[28:31], v[204:207]
    v_mfma_f32_16x16x32_bf16 v[208:211], a[8:11], a[28:31], v[208:211]
    v_mfma_f32_16x16x32_bf16 v[212:215], a[12:15], a[28:31], v[212:215]
    ds_write_b128 v245, v[184:187] offset:0
    v_mfma_f32_16x16x32_bf16 v[216:219], a[16:19], a[28:31], v[216:219]
    ds_write_b128 v245, v[188:191] offset:1024
    v_mfma_f32_16x16x32_bf16 v[220:223], a[244:247], a[28:31], v[220:223]
    ds_write_b128 v245, v[192:195] offset:2048
    s_waitcnt vmcnt(2)
    v_mfma_f32_16x16x32_bf16 v[204:207], a[248:251], a[32:35], v[204:207]
    ds_write_b128 v245, v[196:199] offset:3072
    v_mfma_f32_16x16x32_bf16 v[208:211], a[252:255], a[32:35], v[208:211]
    ds_write_b128 v245, v[200:203] offset:4096
    v_mfma_f32_16x16x32_bf16 v[212:215], a[0:3], a[32:35], v[212:215]
    v_mfma_f32_16x16x32_bf16 v[216:219], a[4:7], a[32:35], v[216:219]
    v_mfma_f32_16x16x32_bf16 v[220:223], a[20:23], a[32:35], v[220:223]
    s_waitcnt vmcnt(1)
    v_mfma_f32_16x16x32_bf16 v[144:147], a[240:243], a[36:39], v[144:147]
    v_mfma_f32_16x16x32_bf16 v[148:151], a[8:11], a[36:39], v[148:151]
    v_mfma_f32_16x16x32_bf16 v[152:155], a[12:15], a[36:39], v[152:155]
    ds_write_b128 v246, v[204:207] offset:0
    v_mfma_f32_16x16x32_bf16 v[156:159], a[16:19], a[36:39], v[156:159]
    ds_write_b128 v246, v[208:211] offset:1024
    v_mfma_f32_16x16x32_bf16 v[160:163], a[244:247], a[36:39], v[160:163]
    ds_write_b128 v246, v[212:215] offset:2048
    s_waitcnt vmcnt(0)
    v_mfma_f32_16x16x32_bf16 v[144:147], a[248:251], a[40:43], v[144:147]
    ds_write_b128 v246, v[216:219] offset:3072
    v_mfma_f32_16x16x32_bf16 v[148:151], a[252:255], a[40:43], v[148:151]
    ds_write_b128 v246, v[220:223] offset:4096
    v_mfma_f32_16x16x32_bf16 v[152:155], a[0:3], a[40:43], v[152:155]
    v_mfma_f32_16x16x32_bf16 v[156:159], a[4:7], a[40:43], v[156:159]
    v_mfma_f32_16x16x32_bf16 v[160:163], a[20:23], a[40:43], v[160:163]
    s_lshl_b32 s37, s48, 3
    s_add_u32 s37, s37, s49
    s_cmp_eq_u32 s37, 248
    s_cselect_b32 s37, 0, 0x80000000
    s_add_u32 s37, s37, 0x11f2000
    v_mov_b32 v62, s37
    v_mov_b32 v63, s43
    buffer_store_dword v63, v62, s[8:11], 0 offen sc1
    s_waitcnt lgkmcnt(0)
    s_barrier
    ds_read_b128 v[84:87], v247 offset:0
    ds_read_b128 v[104:107], v247 offset:5120
    ds_read_b128 v[124:127], v247 offset:10240
    ds_read_b128 v[88:91], v247 offset:1024
    ds_read_b128 v[108:111], v247 offset:6144
    ds_read_b128 v[128:131], v247 offset:11264
    ds_read_b128 v[92:95], v247 offset:2048
    ds_read_b128 v[112:115], v247 offset:7168
    ds_read_b128 v[132:135], v247 offset:12288
    ds_read_b128 v[96:99], v247 offset:3072
    ds_read_b128 v[116:119], v247 offset:8192
    ds_read_b128 v[136:139], v247 offset:13312
    ds_read_b128 v[100:103], v247 offset:4096
    ds_read_b128 v[120:123], v247 offset:9216
    ds_read_b128 v[140:143], v247 offset:14336
    s_waitcnt lgkmcnt(13)
    v_pk_add_f32 v[84:85], v[84:85], v[104:105]
    v_pk_add_f32 v[86:87], v[86:87], v[106:107]
    s_waitcnt lgkmcnt(12)
    v_pk_add_f32 v[144:145], v[144:145], v[124:125]
    v_pk_add_f32 v[146:147], v[146:147], v[126:127]
    v_pk_add_f32 v[144:145], v[144:145], v[84:85]
    v_pk_add_f32 v[146:147], v[146:147], v[86:87]
    v_pk_mul_f32 v[164:165], v[144:145], v[252:253]
    v_pk_mul_f32 v[166:167], v[146:147], v[252:253]
    v_exp_f32 v164, v164
    v_exp_f32 v165, v165
    v_exp_f32 v166, v166
    v_exp_f32 v167, v167
    s_waitcnt lgkmcnt(10)
    v_pk_add_f32 v[88:89], v[88:89], v[108:109]
    v_pk_add_f32 v[90:91], v[90:91], v[110:111]
    s_waitcnt lgkmcnt(9)
    v_pk_add_f32 v[148:149], v[148:149], v[128:129]
    v_pk_add_f32 v[150:151], v[150:151], v[130:131]
    v_pk_add_f32 v[148:149], v[148:149], v[88:89]
    v_pk_add_f32 v[150:151], v[150:151], v[90:91]
    v_pk_mul_f32 v[168:169], v[148:149], v[252:253]
    v_pk_mul_f32 v[170:171], v[150:151], v[252:253]
    v_pk_add_f32 v[164:165], v[164:165], v[250:251]
    v_pk_add_f32 v[166:167], v[166:167], v[250:251]
    v_pk_mul_f32 v[144:145], v[144:145], v[64:65]
    v_pk_mul_f32 v[146:147], v[146:147], v[66:67]
    v_rcp_f32 v164, v164
    v_rcp_f32 v165, v165
    v_rcp_f32 v166, v166
    v_rcp_f32 v167, v167
    v_exp_f32 v168, v168
    v_exp_f32 v169, v169
    v_exp_f32 v170, v170
    v_exp_f32 v171, v171
    s_waitcnt lgkmcnt(7)
    v_pk_add_f32 v[92:93], v[92:93], v[112:113]
    v_pk_add_f32 v[94:95], v[94:95], v[114:115]
    s_waitcnt lgkmcnt(6)
    v_pk_add_f32 v[152:153], v[152:153], v[132:133]
    v_pk_add_f32 v[154:155], v[154:155], v[134:135]
    v_pk_add_f32 v[152:153], v[152:153], v[92:93]
    v_pk_add_f32 v[154:155], v[154:155], v[94:95]
    v_pk_mul_f32 v[172:173], v[152:153], v[252:253]
    v_pk_mul_f32 v[174:175], v[154:155], v[252:253]
    v_pk_add_f32 v[168:169], v[168:169], v[250:251]
    v_pk_add_f32 v[170:171], v[170:171], v[250:251]
    v_pk_mul_f32 v[148:149], v[148:149], v[68:69]
    v_pk_mul_f32 v[150:151], v[150:151], v[70:71]
    v_rcp_f32 v168, v168
    v_rcp_f32 v169, v169
    v_rcp_f32 v170, v170
    v_rcp_f32 v171, v171
    v_pk_fma_f32 v[224:225], v[144:145], v[164:165], v[224:225]
    v_pk_fma_f32 v[226:227], v[146:147], v[166:167], v[226:227]
    buffer_store_dwordx4 v[224:227], v20, s[12:15], 0 offen offset:0 sc1
    v_exp_f32 v172, v172
    v_exp_f32 v173, v173
    v_exp_f32 v174, v174
    v_exp_f32 v175, v175
    s_waitcnt lgkmcnt(4)
    v_pk_add_f32 v[96:97], v[96:97], v[116:117]
    v_pk_add_f32 v[98:99], v[98:99], v[118:119]
    s_waitcnt lgkmcnt(3)
    v_pk_add_f32 v[156:157], v[156:157], v[136:137]
    v_pk_add_f32 v[158:159], v[158:159], v[138:139]
    v_pk_add_f32 v[156:157], v[156:157], v[96:97]
    v_pk_add_f32 v[158:159], v[158:159], v[98:99]
    v_pk_mul_f32 v[176:177], v[156:157], v[252:253]
    v_pk_mul_f32 v[178:179], v[158:159], v[252:253]
    v_pk_add_f32 v[172:173], v[172:173], v[250:251]
    v_pk_add_f32 v[174:175], v[174:175], v[250:251]
    v_pk_mul_f32 v[152:153], v[152:153], v[72:73]
    v_pk_mul_f32 v[154:155], v[154:155], v[74:75]
    v_rcp_f32 v172, v172
    v_rcp_f32 v173, v173
    v_rcp_f32 v174, v174
    v_rcp_f32 v175, v175
    v_pk_fma_f32 v[228:229], v[148:149], v[168:169], v[228:229]
    v_pk_fma_f32 v[230:231], v[150:151], v[170:171], v[230:231]
    buffer_store_dwordx4 v[228:231], v20, s[12:15], 0 offen offset:64 sc1
    v_exp_f32 v176, v176
    v_exp_f32 v177, v177
    v_exp_f32 v178, v178
    v_exp_f32 v179, v179
    s_waitcnt lgkmcnt(1)
    v_pk_add_f32 v[100:101], v[100:101], v[120:121]
    v_pk_add_f32 v[102:103], v[102:103], v[122:123]
    s_waitcnt lgkmcnt(0)
    v_pk_add_f32 v[160:161], v[160:161], v[140:141]
    v_pk_add_f32 v[162:163], v[162:163], v[142:143]
    v_pk_add_f32 v[160:161], v[160:161], v[100:101]
    v_pk_add_f32 v[162:163], v[162:163], v[102:103]
    v_pk_mul_f32 v[180:181], v[160:161], v[252:253]
    v_pk_mul_f32 v[182:183], v[162:163], v[252:253]
    v_pk_add_f32 v[176:177], v[176:177], v[250:251]
    v_pk_add_f32 v[178:179], v[178:179], v[250:251]
    v_pk_mul_f32 v[156:157], v[156:157], v[76:77]
    v_pk_mul_f32 v[158:159], v[158:159], v[78:79]
    v_rcp_f32 v176, v176
    v_rcp_f32 v177, v177
    v_rcp_f32 v178, v178
    v_rcp_f32 v179, v179
    v_pk_fma_f32 v[232:233], v[152:153], v[172:173], v[232:233]
    v_pk_fma_f32 v[234:235], v[154:155], v[174:175], v[234:235]
    buffer_store_dwordx4 v[232:235], v20, s[12:15], 0 offen offset:128 sc1
    v_exp_f32 v180, v180
    v_exp_f32 v181, v181
    v_exp_f32 v182, v182
    v_exp_f32 v183, v183
    v_pk_add_f32 v[180:181], v[180:181], v[250:251]
    v_pk_add_f32 v[182:183], v[182:183], v[250:251]
    v_pk_mul_f32 v[160:161], v[160:161], v[80:81]
    v_pk_mul_f32 v[162:163], v[162:163], v[82:83]
    v_rcp_f32 v180, v180
    v_rcp_f32 v181, v181
    v_rcp_f32 v182, v182
    v_rcp_f32 v183, v183
    v_pk_fma_f32 v[236:237], v[156:157], v[176:177], v[236:237]
    v_pk_fma_f32 v[238:239], v[158:159], v[178:179], v[238:239]
    buffer_store_dwordx4 v[236:239], v20, s[12:15], 0 offen offset:192 sc1
    v_pk_fma_f32 v[240:241], v[160:161], v[180:181], v[240:241]
    v_pk_fma_f32 v[242:243], v[162:163], v[182:183], v[242:243]
    buffer_store_dwordx4 v[240:243], v20, s[12:15], 0 offen offset:256 sc1
    s_endpgm
K1P_retry:
    s_add_u32 s44, s44, 1
    s_cmp_gt_u32 s44, 200000
    s_cbranch_scc1 K1P_back
    buffer_load_dwordx2 v[224:225], v28, s[20:23], 0 offen offset:0 sc1
    buffer_load_dwordx2 v[226:227], v28, s[20:23], 0 offen offset:2048 sc1
    buffer_load_dwordx2 v[228:229], v29, s[20:23], 0 offen offset:0 sc1
    buffer_load_dwordx2 v[230:231], v29, s[20:23], 0 offen offset:2048 sc1
    buffer_load_dwordx2 v[232:233], v30, s[20:23], 0 offen offset:0 sc1
    buffer_load_dwordx2 v[234:235], v30, s[20:23], 0 offen offset:2048 sc1
    buffer_load_dwordx2 v[236:237], v31, s[20:23], 0 offen offset:0 sc1
    buffer_load_dwordx2 v[238:239], v31, s[20:23], 0 offen offset:2048 sc1
    s_waitcnt vmcnt(0)
    v_mov_b32 v26, 0
    v_cmp_eq_u32 s[64:65], s43, v225
    v_cmp_eq_u32 s[66:67], s43, v227
    v_cmp_eq_u32 s[68:69], s43, v229
    v_cmp_eq_u32 s[70:71], s43, v231
    v_cmp_eq_u32 s[72:73], s43, v233
    v_cmp_eq_u32 s[74:75], s43, v235
    v_cmp_eq_u32 s[76:77], s43, v237
    v_cmp_eq_u32 s[78:79], s43, v239
    v_addc_co_u32 v26, vcc, 0, v26, s[64:65]
    v_addc_co_u32 v26, vcc, 0, v26, s[66:67]
    v_addc_co_u32 v26, vcc, 0, v26, s[68:69]
    v_addc_co_u32 v26, vcc, 0, v26, s[70:71]
    v_addc_co_u32 v26, vcc, 0, v26, s[72:73]
    v_addc_co_u32 v26, vcc, 0, v26, s[74:75]
    v_addc_co_u32 v26, vcc, 0, v26, s[76:77]
    v_addc_co_u32 v26, vcc, 0, v26, s[78:79]
    v_cmp_ne_u32 vcc, v26, v25
    s_cbranch_vccnz K1P_retry
    s_branch K1P_back
FP0_retry:
    s_add_u32 s44, s44, 1
    s_cmp_gt_u32 s44, 200000
    s_cbranch_scc1 FP0_back
    s_load_dwordx16 s[64:79], s[32:33], 0 glc
    s_waitcnt lgkmcnt(0)
    s_cmp_lg_u64 s[64:65], s[28:29]
    s_cbranch_scc1 FP0_retry
    s_cmp_lg_u64 s[66:67], s[28:29]
    s_cbranch_scc1 FP0_retry
    s_cmp_lg_u64 s[68:69], s[28:29]
    s_cbranch_scc1 FP0_retry
    s_cmp_lg_u64 s[70:71], s[28:29]
    s_cbranch_scc1 FP0_retry
    s_cmp_lg_u64 s[72:73], s[28:29]
    s_cbranch_scc1 FP0_retry
    s_cmp_lg_u64 s[74:75], s[28:29]
    s_cbranch_scc1 FP0_retry
    s_cmp_lg_u64 s[76:77], s[28:29]
    s_cbranch_scc1 FP0_retry
    s_cmp_lg_u64 s[78:79], s[28:29]
    s_cbranch_scc1 FP0_retry
    s_branch FP0_back
FP1_retry:
    s_add_u32 s44, s44, 1
    s_cmp_gt_u32 s44, 200000
    s_cbranch_scc1 FP1_back
    s_load_dwordx8 s[64:71], s[34:35], 0 glc
    s_waitcnt lgkmcnt(0)
    s_cmp_lg_u64 s[64:65], s[28:29]
    s_cbranch_scc1 FP1_retry
    s_cmp_lg_u64 s[66:67], s[28:29]
    s_cbranch_scc1 FP1_retry
    s_cmp_lg_u64 s[68:69], s[28:29]
    s_cbranch_scc1 FP1_retry
    s_cmp_lg_u64 s[70:71], s[28:29]
    s_cbranch_scc1 FP1_retry
    s_branch FP1_back
XP_retry:
    s_add_u32 s44, s44, 1
    s_cmp_gt_u32 s44, 200000
    s_cbranch_scc1 XP_back
    s_load_dwordx16 s[64:79], s[46:47], 0 glc
    s_waitcnt lgkmcnt(0)
    s_cmp_lg_u64 s[64:65], s[100:101]
    s_cbranch_scc1 XP_retry
    s_cmp_lg_u64 s[66:67], s[100:101]
    s_cbranch_scc1 XP_retry
    s_cmp_lg_u64 s[68:69], s[100:101]
    s_cbranch_scc1 XP_retry
    s_cmp_lg_u64 s[70:71], s[100:101]
    s_cbranch_scc1 XP_retry
    s_cmp_lg_u64 s[72:73], s[100:101]
    s_cbranch_scc1 XP_retry
    s_cmp_lg_u64 s[74:75], s[100:101]
    s_cbranch_scc1 XP_retry
    s_cmp_lg_u64 s[76:77], s[100:101]
    s_cbranch_scc1 XP_retry
    s_cmp_lg_u64 s[78:79], s[100:101]
    s_cbranch_scc1 XP_retry
    s_branch XP_back
PFP_retry:
    s_add_u32 s44, s44, 1
    s_cmp_gt_u32 s44, 200000
    s_cbranch_scc1 PFP_back
    s_and_b32 s6, s2, 7
    s_lshl_b32 s6, s6, 10
    s_add_u32 s6, s6, 0x11f0000
    buffer_load_dwordx4 v[248:251], v2, s[8:11], s6 offen sc1
    s_waitcnt vmcnt(0)
    v_xor_b32 v248, s43, v248
    v_xor_b32 v249, s43, v249
    v_xor_b32 v250, s43, v250
    v_xor_b32 v251, s43, v251
    v_or3_b32 v248, v248, v249, v250
    v_or_b32 v248, v248, v251
    v_cmp_ne_u32 vcc, 0, v248
    s_cbranch_vccnz PFP_retry
    s_branch PFP_back
K1Q_start:
    v_lshrrev_b32 v208, 3, v1
    v_and_b32 v209, 7, v1
    v_lshrrev_b32 v210, 1, v208
    v_and_b32 v211, 1, v210
    v_lshlrev_b32 v211, 2, v211
    v_xor_b32 v211, v211, v209
    v_lshlrev_b32 v211, 4, v211
    v_mul_u32_u24 v212, 3072, v208
    v_add_u32 v211, v211, v212
    s_lshr_b32 s37, s3, 1
    s_mul_i32 s38, s37, 98304
    v_add_u32 v4, s38, v211
    v_add_u32 v5, 23552, v4
    v_add_u32 v6, 47104, v4
    v_add_u32 v7, 70656, v4
    s_and_b32 s45, s3, 1
    s_lshl_b32 s38, s45, 2
    v_add_u32 v210, s38, v210
    v_xor_b32 v210, v210, v209
    v_lshlrev_b32 v210, 4, v210
    v_mul_u32_u24 v212, 1280, v208
    v_add_u32 v210, v210, v212
    s_mul_i32 s38, s37, 40960
    v_add_u32 v8, s38, v210
    v_add_u32 v9, 9216, v8
    v_add_u32 v10, 18432, v8
    v_add_u32 v11, 27648, v8
    s_lshl_b32 s35, s45, 13
    s_lshl_b32 s38, s37, 12
    s_add_u32 s35, s35, s38
    s_mov_b32 s36, s35
    s_mul_i32 s32, s30, 384
    s_add_u32 s33, s32, 256
    s_mul_i32 s41, s30, 5
    s_add_u32 s41, s41, 1
    s_mul_i32 s34, s41, 20480
    s_lshl_b32 s31, s28, 2
    s_add_u32 s31, s31, s3
    s_mul_i32 s31, s31, 40960
    s_cmp_eq_u32 s45, 0
    s_cselect_b32 s12, s52, s54
    s_cselect_b32 s13, s53, s55
    s_cselect_b32 s16, s48, s50
    s_cselect_b32 s17, s49, s51
    s_mov_b32 s14, 1966080
    s_mov_b32 s15, 0x20000
    s_mov_b32 s18, 819200
    s_mov_b32 s19, 0x20000
    s_waitcnt vmcnt(0)
    buffer_store_dword v107, v106, s[8:11], s7 offen sc1
    v_lshlrev_b32 v126, 16, v126
    v_mul_f32 v126, 0x3fb8aa3b, v126
    v_exp_f32 v126, v126
    v_lshlrev_b32 v124, 16, v124
    v_lshlrev_b32 v125, 16, v125
    v_mov_b32 v127, 1.0
    v_cvt_pk_bf16_f32 v126, v126, v126
    v_lshlrev_b32 v126, 16, v126
    v_mul_f32 v142, v126, v124
    v_mul_f32 v143, v126, v125
    v_mul_f32 v138, 0x3fb8aa3b, v142
    v_mul_f32 v139, 0x3e22f983, v143
    v_exp_f32 v138, v138
    v_rndne_f32 v140, v139
    v_sub_f32 v139, v139, v140
    v_cos_f32 v140, v139
    v_sin_f32 v139, v139
    v_mul_f32 v128, v138, v140
    v_mul_f32 v139, v138, v139
    v_mul_f32 v129, v139, v127
    v_mul_f32 v138, 0x41b8aa3b, v142
    v_mul_f32 v139, 0x4022f983, v143
    v_exp_f32 v138, v138
    v_rndne_f32 v140, v139
    v_sub_f32 v139, v139, v140
    v_cos_f32 v140, v139
    v_sin_f32 v139, v139
    v_mul_f32 v132, v138, v140
    v_mul_f32 v139, v138, v139
    v_mul_f32 v133, v139, v127
    v_mul_f32 v138, 0x4338aa3b, v142
    v_mul_f32 v139, 0x41a2f983, v143
    v_exp_f32 v138, v138
    v_rndne_f32 v140, v139
    v_sub_f32 v139, v139, v140
    v_cos_f32 v140, v139
    v_sin_f32 v139, v139
    v_mul_f32 v134, v138, v140
    v_mul_f32 v139, v138, v139
    v_mul_f32 v135, v139, v127
    v_mul_f32 v138, 0x43b8aa3b, v142
    v_mul_f32 v139, 0x4222f983, v143
    v_exp_f32 v138, v138
    v_rndne_f32 v140, v139
    v_sub_f32 v139, v139, v140
    v_cos_f32 v140, v139
    v_sin_f32 v139, v139
    v_mul_f32 v136, v138, v140
    v_mul_f32 v139, v138, v139
    v_mul_f32 v137, v139, v127
    v_add_f32 v141, -1.0, v128
    v_mul_f32 v126, v124, v124
    v_fmac_f32 v126, v125, v125
    v_rcp_f32 v126, v126
    v_mul_f32 v138, v141, v124
    v_fmac_f32 v138, v129, v125
    v_mul_f32 v139, v141, v125
    v_fma_f32 v139, v129, v124, -v139
    v_add_f32 v126, v126, v126
    v_mul_f32 v130, v138, v126
    v_mul_f32 v131, -v139, v126
    v_bfe_u32 v138, v1, 4, 1
    v_lshlrev_b32 v138, 3, v138
    v_and_b32 v140, 7, v1
    v_add_u32 v138, v138, v140
    v_lshlrev_b32 v138, 2, v138
    v_bfe_u32 v139, v1, 3, 1
    v_lshlrev_b32 v139, 31, v139
    v_or_b32 v139, 1.0, v139
    s_lshl_b32 s37, s3, 6
    v_add_u32 v140, s37, v138
    ds_bpermute_b32 v32, v138, v128 offset:0
    ds_bpermute_b32 v33, v138, v129 offset:0
    ds_bpermute_b32 v34, v138, v130 offset:0
    ds_bpermute_b32 v35, v138, v131 offset:0
    ds_bpermute_b32 v36, v138, v128 offset:64
    ds_bpermute_b32 v37, v138, v129 offset:64
    ds_bpermute_b32 v38, v138, v130 offset:64
    ds_bpermute_b32 v39, v138, v131 offset:64
    ds_bpermute_b32 v40, v138, v128 offset:128
    ds_bpermute_b32 v41, v138, v129 offset:128
    ds_bpermute_b32 v42, v138, v130 offset:128
    ds_bpermute_b32 v43, v138, v131 offset:128
    ds_bpermute_b32 v44, v138, v128 offset:192
    ds_bpermute_b32 v45, v138, v129 offset:192
    ds_bpermute_b32 v46, v138, v130 offset:192
    ds_bpermute_b32 v47, v138, v131 offset:192
    ds_bpermute_b32 v48, v140, v132
    ds_bpermute_b32 v49, v140, v133
    ds_bpermute_b32 v50, v140, v134
    ds_bpermute_b32 v51, v140, v135
    ds_bpermute_b32 v52, v140, v136
    ds_bpermute_b32 v53, v140, v137
    s_waitcnt lgkmcnt(15)
    v_mul_f32 v33, v33, v139
    v_mul_f32 v34, v34, v139
    v_mul_f32 v37, v37, v139
    v_mul_f32 v38, v38, v139
    s_waitcnt lgkmcnt(12)
    v_mul_f32 v41, v41, v139
    s_waitcnt lgkmcnt(11)
    v_mul_f32 v42, v42, v139
    s_waitcnt lgkmcnt(8)
    v_mul_f32 v45, v45, v139
    s_waitcnt lgkmcnt(7)
    v_mul_f32 v46, v46, v139
    s_waitcnt lgkmcnt(4)
    v_mul_f32 v49, v49, v139
    s_waitcnt lgkmcnt(2)
    v_mul_f32 v51, v51, v139
    s_waitcnt lgkmcnt(0)
    v_mul_f32 v53, v53, v139
    s_mov_b32 s26, 1966080
    s_mov_b32 s27, 0x20000
    s_lshl_b32 s72, s2, 1
    s_lshr_b32 s73, s3, 1
    s_add_u32 s72, s72, s73
    s_mul_i32 s73, s72, 52429
    s_lshr_b32 s73, s73, 19
    s_mul_i32 s74, s73, 10
    s_sub_u32 s74, s72, s74
    s_and_b32 s75, s3, 1
    s_lshl_b32 s76, s73, 1
    s_add_u32 s76, s76, s75
    s_mul_i32 s76, s76, 20480
    s_lshl_b32 s77, s74, 7
    s_add_u32 s76, s76, s77
    v_bfe_u32 v160, v191, 1, 1
    v_lshlrev_b32 v160, 2, v160
    v_xor_b32 v160, v160, v190
    v_lshlrev_b32 v160, 4, v160
    v_mul_u32_u24 v162, 1280, v191
    v_add_u32 v160, v160, v162
    v_add_u32 v161, 9216, v160
    s_lshl_b32 s77, s3, 11
    s_add_u32 s78, s77, 144384
    s_mov_b32 m0, s78
    s_nop 0
    buffer_load_dwordx4 v160, s[24:27], s76 offen  lds
    buffer_load_dwordx4 v161, s[24:27], s76 offen offset:1024  lds
    v_lshrrev_b32 v168, 4, v1
    v_bfe_u32 v169, v1, 2, 2
    v_and_b32 v170, 3, v1
    v_and_b32 v171, 1, v168
    v_lshrrev_b32 v172, 1, v168
    v_lshlrev_b32 v164, 2, v171
    v_add_u32 v164, v164, v169
    v_lshlrev_b32 v164, 7, v164
    v_lshlrev_b32 v173, 1, v172
    v_lshrrev_b32 v174, 1, v170
    v_add_u32 v173, v173, v174
    v_lshrrev_b32 v174, 1, v169
    v_lshlrev_b32 v174, 2, v174
    v_xor_b32 v173, v173, v174
    v_lshlrev_b32 v173, 4, v173
    v_and_b32 v174, 1, v170
    v_lshlrev_b32 v174, 3, v174
    v_add3_u32 v164, v164, v173, v174
    v_add_u32 v164, s78, v164
    v_xor_b32 v165, 64, v164
    s_lshl_b32 s74, s74, 2
    s_mul_i32 s73, s73, 5
    s_cmp_lt_u32 s2, 240
    s_cselect_b32 s72, 0, 0x80000000
    s_add_u32 s72, s72, 0x300000
    s_lshl_b32 s75, s75, 9
    s_add_u32 s72, s72, s75
    v_lshlrev_b32 v174, 8, v171
    v_and_b32 v169, 15, v1
    v_lshlrev_b32 v169, 4, v169
    v_add3_u32 v169, v169, v174, s72
    v_add_u32 v173, s74, v172
    v_add_u32 v173, 0, v173
    v_mul_u32_u24 v174, 52, v173
    v_lshrrev_b32 v174, 8, v174
    v_mul_u32_u24 v174, 235, v174
    v_add3_u32 v173, v173, v174, s73
    v_lshlrev_b32 v173, 10, v173
    v_add_u32 v166, v173, v169
    v_add_u32 v173, s74, v172
    v_add_u32 v173, 2, v173
    v_mul_u32_u24 v174, 52, v173
    v_lshrrev_b32 v174, 8, v174
    v_mul_u32_u24 v174, 235, v174
    v_add3_u32 v173, v173, v174, s73
    v_lshlrev_b32 v173, 10, v173
    v_add_u32 v167, v173, v169
    s_lshl_b32 s72, s2, 2
    s_add_u32 s72, s72, s3
    s_cmp_ge_u32 s72, 400
    s_cselect_b32 s73, 1, 0
    s_cselect_b32 s74, 400, 0
    s_cselect_b32 s64, s70, s68
    s_cselect_b32 s65, s71, s69
    s_sub_u32 s74, s72, s74
    s_mul_i32 s75, s74, 52429
    s_lshr_b32 s75, s75, 19
    s_mul_i32 s76, s75, 10
    s_sub_u32 s74, s74, s76
    s_mov_b32 s66, 819200
    s_mov_b32 s67, 0x20000
    s_mul_i32 s76, s75, 20480
    s_lshl_b32 s78, s74, 7
    s_add_u32 s76, s76, s78
    v_lshrrev_b32 v173, 1, v191
    v_xor_b32 v173, v173, v190
    v_lshlrev_b32 v173, 4, v173
    v_add_u32 v160, v173, v162
    v_xor_b32 v161, 64, v160
    v_add_u32 v161, 9216, v161
    s_add_u32 s78, s77, 152576
    s_mov_b32 m0, s78
    s_nop 0
    buffer_load_dwordx4 v160, s[64:67], s76 offen  lds
    buffer_load_dwordx4 v161, s[64:67], s76 offen offset:1024  lds
    v_and_b32 v173, 15, v1
    v_lshrrev_b32 v174, 1, v173
    v_xor_b32 v174, v168, v174
    v_lshlrev_b32 v174, 4, v174
    v_lshlrev_b32 v173, 7, v173
    v_add3_u32 v168, v173, v174, s78
    v_xor_b32 v169, 64, v168
    s_mul_i32 s76, s75, 52
    s_lshr_b32 s76, s76, 8
    s_mul_i32 s76, s76, 195
    s_add_u32 s76, s76, s75
    s_mul_i32 s73, s73, 100
    s_add_u32 s76, s76, s73
    s_mul_i32 s74, s74, 10
    s_add_u32 s76, s76, s74
    s_lshl_b32 s76, s76, 10
    s_cmp_lt_u32 s72, 800
    s_cselect_b32 s72, 0, 0x80000000
    s_add_u32 s72, s72, 0x1040000
    s_add_u32 s76, s76, s72
    v_add_u32 v170, s76, v2
    v_add_u32 v171, 5120, v170
    s_add_u32 s46, s4, s6
    s_addc_u32 s47, s5, 0
    s_mov_b32 s100, s43
    s_mov_b32 s101, s43
    s_load_dwordx16 s[64:79], s[46:47], 0 glc
    s_add_u32 s62, s62, 1
    s_cmp_eq_u32 s62, 10
    s_cselect_b32 s62, 0, s62
    s_add_u32 m0, s36, 20480
    s_lshl_b32 s45, s62, 7
    s_add_u32 s45, s45, s34
    buffer_load_dwordx4 v8, s[16:19], s45 offen offset:0  lds
    buffer_load_dwordx4 v9, s[16:19], s45 offen offset:1024  lds
    buffer_load_dwordx4 v10, s[16:19], s45 offen offset:2048  lds
    buffer_load_dwordx4 v11, s[16:19], s45 offen offset:3072  lds
    v_and_b32 v208, 31, v1
    v_lshrrev_b32 v209, 5, v1
    v_bfe_u32 v210, v1, 2, 2
    v_and_b32 v211, 3, v1
    v_bfe_u32 v212, v1, 4, 1
    v_lshlrev_b32 v213, 1, v212
    v_lshrrev_b32 v214, 1, v211
    v_add_u32 v213, v213, v214
    v_lshrrev_b32 v214, 1, v210
    v_lshlrev_b32 v214, 2, v214
    v_xor_b32 v213, v213, v214
    v_lshlrev_b32 v213, 4, v213
    v_and_b32 v214, 1, v211
    v_lshlrev_b32 v214, 3, v214
    v_add_u32 v213, v213, v214
    v_lshlrev_b32 v214, 7, v210
    v_add_u32 v213, v213, v214
    v_lshlrev_b32 v214, 10, v209
    v_add_u32 v12, v213, v214
    v_xor_b32 v13, 64, v12
    v_bfe_u32 v215, v208, 3, 1
    v_lshlrev_b32 v213, 13, v215
    v_lshlrev_b32 v214, 10, v212
    v_add_u32 v213, v213, v214
    v_and_b32 v214, 7, v208
    v_lshlrev_b32 v214, 7, v214
    v_add_u32 v213, v213, v214
    v_bfe_u32 v214, v208, 1, 3
    v_xor_b32 v214, v214, v209
    v_lshlrev_b32 v214, 4, v214
    v_xor_b32 v216, 0, v214
    v_add_u32 v14, v213, v216
    v_xor_b32 v216, 32, v214
    v_add_u32 v15, v213, v216
    v_xor_b32 v216, 64, v214
    v_add_u32 v16, v213, v216
    v_xor_b32 v216, 96, v214
    v_add_u32 v17, v213, v216
    s_mov_b32 s44, 0
    s_waitcnt lgkmcnt(0)
    s_cmp_lg_u64 s[64:65], s[100:101]
    s_cbranch_scc1 XQ_retry
    s_cmp_lg_u64 s[66:67], s[100:101]
    s_cbranch_scc1 XQ_retry
    s_cmp_lg_u64 s[68:69], s[100:101]
    s_cbranch_scc1 XQ_retry
    s_cmp_lg_u64 s[70:71], s[100:101]
    s_cbranch_scc1 XQ_retry
    s_cmp_lg_u64 s[72:73], s[100:101]
    s_cbranch_scc1 XQ_retry
    s_cmp_lg_u64 s[74:75], s[100:101]
    s_cbranch_scc1 XQ_retry
    s_cmp_lg_u64 s[76:77], s[100:101]
    s_cbranch_scc1 XQ_retry
    s_cmp_lg_u64 s[78:79], s[100:101]
    s_cbranch_scc1 XQ_retry
XQ_back:
    s_nop 0
    s_load_dwordx2 s[64:65], s[0:1], 0
    s_load_dwordx2 s[66:67], s[0:1], 64
    s_load_dwordx2 s[68:69], s[0:1], 104
    s_mov_b32 s101, s63
    s_lshl_b32 s46, s101, 12
    s_add_u32 s46, s46, s31
    buffer_load_dwordx4 a[0:3], v2, s[8:11], s46 offen offset:0 sc1
    buffer_load_dwordx4 a[4:7], v2, s[8:11], s46 offen offset:1024 sc1
    buffer_load_dwordx4 a[8:11], v2, s[8:11], s46 offen offset:2048 sc1
    buffer_load_dwordx4 a[12:15], v2, s[8:11], s46 offen offset:3072 sc1
    s_add_u32 s101, s101, 1
    s_cmp_eq_u32 s101, 10
    s_cselect_b32 s101, 0, s101
    s_lshl_b32 s46, s101, 12
    s_add_u32 s46, s46, s31
    buffer_load_dwordx4 a[16:19], v2, s[8:11], s46 offen offset:0 sc1
    buffer_load_dwordx4 a[20:23], v2, s[8:11], s46 offen offset:1024 sc1
    buffer_load_dwordx4 a[24:27], v2, s[8:11], s46 offen offset:2048 sc1
    buffer_load_dwordx4 a[28:31], v2, s[8:11], s46 offen offset:3072 sc1
    s_waitcnt lgkmcnt(0)
    s_barrier
    ds_read_b128 a[160:163], v14 offset:0
    ds_read_b128 a[164:167], v14 offset:2048
    ds_read_b128 a[168:171], v14 offset:4096
    ds_read_b128 a[172:175], v14 offset:6144
    ds_read_b128 a[176:179], v15 offset:0
    ds_read_b128 a[180:183], v15 offset:2048
    ds_read_b128 a[184:187], v15 offset:4096
    s_waitcnt vmcnt(7) lgkmcnt(3)
    v_mfma_f32_32x32x16_bf16 v[64:79], a[0:3], a[160:163], 0
    ds_read_b128 a[188:191], v15 offset:6144
    s_add_u32 s62, s62, 1
    s_cmp_eq_u32 s62, 10
    s_cselect_b32 s62, 0, s62
    v_mfma_f32_32x32x16_bf16 v[80:95], a[0:3], a[164:167], 0
    ds_read_b128 a[160:163], v16 offset:0
    s_add_u32 m0, s36, 40960
    s_lshl_b32 s45, s62, 7
    s_add_u32 s45, s45, s34
    buffer_load_dwordx4 v8, s[16:19], s45 offen offset:0  lds
    v_mfma_f32_32x32x16_bf16 v[96:111], a[0:3], a[168:171], 0
    ds_read_b128 a[164:167], v16 offset:2048
    v_mfma_f32_32x32x16_bf16 v[112:127], a[0:3], a[172:175], 0
    ds_read_b128 a[168:171], v16 offset:4096
    buffer_load_dwordx4 v9, s[16:19], s45 offen offset:1024  lds
    s_waitcnt vmcnt(8) lgkmcnt(3)
    v_mfma_f32_32x32x16_bf16 v[64:79], a[4:7], a[176:179], v[64:79]
    ds_read_b128 a[172:175], v16 offset:6144
    v_mfma_f32_32x32x16_bf16 v[80:95], a[4:7], a[180:183], v[80:95]
    ds_read_b128 a[176:179], v17 offset:0
    buffer_load_dwordx4 v10, s[16:19], s45 offen offset:2048  lds
    v_mfma_f32_32x32x16_bf16 v[96:111], a[4:7], a[184:187], v[96:111]
    ds_read_b128 a[180:183], v17 offset:2048
    v_mfma_f32_32x32x16_bf16 v[112:127], a[4:7], a[188:191], v[112:127]
    ds_read_b128 a[184:187], v17 offset:4096
    buffer_load_dwordx4 v11, s[16:19], s45 offen offset:3072  lds
    s_add_u32 s101, s101, 1
    s_cmp_eq_u32 s101, 10
    s_cselect_b32 s101, 0, s101
    ds_read_b64_tr_b16 v[172:173], v164
    ds_read_b64_tr_b16 v[174:175], v164 offset:1024
    ds_read_b64_tr_b16 v[176:177], v165
    ds_read_b64_tr_b16 v[178:179], v165 offset:1024
    ds_read_b128 v[180:183], v168
    ds_read_b128 v[184:187], v169
    s_waitcnt lgkmcnt(4)
    buffer_store_dwordx4 v[172:175], v166, s[8:11], 0 offen sc1
    s_waitcnt lgkmcnt(2)
    buffer_store_dwordx4 v[176:179], v167, s[8:11], 0 offen sc1
    s_waitcnt lgkmcnt(1)
    buffer_store_dwordx4 v[180:183], v170, s[8:11], 0 offen sc1
    s_waitcnt lgkmcnt(0)
    buffer_store_dwordx4 v[184:187], v171, s[8:11], 0 offen sc1
    s_waitcnt vmcnt(13)
    v_mfma_f32_32x32x16_bf16 v[64:79], a[8:11], a[160:163], v[64:79]
    ds_read_b128 a[188:191], v17 offset:6144
    s_lshl_b32 s46, s101, 12
    s_add_u32 s46, s46, s31
    v_mfma_f32_32x32x16_bf16 v[80:95], a[8:11], a[164:167], v[80:95]
    s_barrier
    ds_read_b128 a[160:163], v14 offset:20480
    buffer_load_dwordx4 a[32:35], v2, s[8:11], s46 offen offset:0 sc1
    v_mfma_f32_32x32x16_bf16 v[96:111], a[8:11], a[168:171], v[96:111]
    ds_read_b128 a[164:167], v14 offset:22528
    v_mfma_f32_32x32x16_bf16 v[112:127], a[8:11], a[172:175], v[112:127]
    ds_read_b128 a[168:171], v14 offset:24576
    buffer_load_dwordx4 a[36:39], v2, s[8:11], s46 offen offset:1024 sc1
    s_waitcnt vmcnt(14) lgkmcnt(3)
    v_mfma_f32_32x32x16_bf16 v[64:79], a[12:15], a[176:179], v[64:79]
    ds_read_b128 a[172:175], v14 offset:26624
    v_mfma_f32_32x32x16_bf16 v[80:95], a[12:15], a[180:183], v[80:95]
    ds_read_b128 a[176:179], v15 offset:20480
    buffer_load_dwordx4 a[40:43], v2, s[8:11], s46 offen offset:2048 sc1
    v_mfma_f32_32x32x16_bf16 v[96:111], a[12:15], a[184:187], v[96:111]
    ds_read_b128 a[180:183], v15 offset:22528
    v_mfma_f32_32x32x16_bf16 v[112:127], a[12:15], a[188:191], v[112:127]
    ds_read_b128 a[184:187], v15 offset:24576
    buffer_load_dwordx4 a[44:47], v2, s[8:11], s46 offen offset:3072 sc1
    s_add_u32 s62, s62, 1
    s_cmp_eq_u32 s62, 10
    s_cselect_b32 s62, 0, s62
    s_waitcnt vmcnt(15) lgkmcnt(3)
    v_mfma_f32_32x32x16_bf16 v[64:79], a[16:19], a[160:163], v[64:79]
    ds_read_b128 a[188:191], v15 offset:26624
    s_add_u32 m0, s36, 61440
    s_lshl_b32 s45, s62, 7
    s_add_u32 s45, s45, s34
    v_mfma_f32_32x32x16_bf16 v[80:95], a[16:19], a[164:167], v[80:95]
    ds_read_b128 a[160:163], v16 offset:20480
    buffer_load_dwordx4 v8, s[16:19], s45 offen offset:0  lds
    v_mfma_f32_32x32x16_bf16 v[96:111], a[16:19], a[168:171], v[96:111]
    ds_read_b128 a[164:167], v16 offset:22528
    v_mfma_f32_32x32x16_bf16 v[112:127], a[16:19], a[172:175], v[112:127]
    ds_read_b128 a[168:171], v16 offset:24576
    buffer_load_dwordx4 v9, s[16:19], s45 offen offset:1024  lds
    s_waitcnt vmcnt(16) lgkmcnt(3)
    v_mfma_f32_32x32x16_bf16 v[64:79], a[20:23], a[176:179], v[64:79]
    ds_read_b128 a[172:175], v16 offset:26624
    v_mfma_f32_32x32x16_bf16 v[80:95], a[20:23], a[180:183], v[80:95]
    ds_read_b128 a[176:179], v17 offset:20480
    buffer_load_dwordx4 v10, s[16:19], s45 offen offset:2048  lds
    v_mfma_f32_32x32x16_bf16 v[96:111], a[20:23], a[184:187], v[96:111]
    ds_read_b128 a[180:183], v17 offset:22528
    v_mfma_f32_32x32x16_bf16 v[112:127], a[20:23], a[188:191], v[112:127]
    ds_read_b128 a[184:187], v17 offset:24576
    buffer_load_dwordx4 v11, s[16:19], s45 offen offset:3072  lds
    s_add_u32 s101, s101, 1
    s_cmp_eq_u32 s101, 10
    s_cselect_b32 s101, 0, s101
    s_waitcnt vmcnt(17) lgkmcnt(3)
    v_mfma_f32_32x32x16_bf16 v[64:79], a[24:27], a[160:163], v[64:79]
    ds_read_b128 a[188:191], v17 offset:26624
    s_lshl_b32 s46, s101, 12
    s_add_u32 s46, s46, s31
    v_and_b32 v208, 31, v1
    v_mfma_f32_32x32x16_bf16 v[80:95], a[24:27], a[164:167], v[80:95]
    s_waitcnt vmcnt(12)
    s_barrier
    ds_read_b128 a[160:163], v14 offset:40960
    buffer_load_dwordx4 a[48:51], v2, s[8:11], s46 offen offset:0 sc1
    v_lshrrev_b32 v209, 5, v1
    v_mfma_f32_32x32x16_bf16 v[96:111], a[24:27], a[168:171], v[96:111]
    ds_read_b128 a[164:167], v14 offset:43008
    v_bfe_u32 v210, v1, 2, 2
    v_and_b32 v211, 3, v1
    v_bfe_u32 v212, v1, 4, 1
    s_lshl_b32 s37, s3, 3
    v_mfma_f32_32x32x16_bf16 v[112:127], a[24:27], a[172:175], v[112:127]
    ds_read_b128 a[168:171], v14 offset:45056
    buffer_load_dwordx4 a[52:55], v2, s[8:11], s46 offen offset:1024 sc1
    s_add_u32 s37, s37, 143360
    v_lshlrev_b32 v213, 5, v208
    v_lshlrev_b32 v214, 2, v209
    s_waitcnt lgkmcnt(3)
    v_mfma_f32_32x32x16_bf16 v[64:79], a[28:31], a[176:179], v[64:79]
    ds_read_b128 a[172:175], v14 offset:47104
    v_add3_u32 v18, v213, v214, s37
    s_lshl_b32 s37, s3, 10
    s_add_u32 s37, s37, 143360
    v_mfma_f32_32x32x16_bf16 v[80:95], a[28:31], a[180:183], v[80:95]
    ds_read_b128 a[176:179], v15 offset:40960
    buffer_load_dwordx4 a[56:59], v2, s[8:11], s46 offen offset:2048 sc1
    v_add_u32 v19, s37, v213
    s_mul_i32 s37, s3, 2560
    s_add_u32 s37, s37, 151552
    v_mfma_f32_32x32x16_bf16 v[96:111], a[28:31], a[184:187], v[96:111]
    ds_read_b128 a[180:183], v15 offset:43008
    v_mul_u32_u24 v213, 80, v208
    v_lshlrev_b32 v214, 5, v209
    v_add3_u32 v20, v213, v214, s37
    v_lshrrev_b32 v213, 4, v1
    v_mfma_f32_32x32x16_bf16 v[112:127], a[28:31], a[188:191], v[112:127]
    ds_read_b128 a[184:187], v15 offset:45056
    buffer_load_dwordx4 a[60:63], v2, s[8:11], s46 offen offset:3072 sc1
    s_add_u32 s62, s62, 1
    s_cmp_eq_u32 s62, 10
    s_cselect_b32 s62, 0, s62
    s_waitcnt vmcnt(11) lgkmcnt(3)
    v_mfma_f32_32x32x16_bf16 v[64:79], a[32:35], a[160:163], v[64:79]
    ds_read_b128 a[188:191], v15 offset:47104
    s_add_u32 m0, s36, 81920
    s_lshl_b32 s45, s62, 7
    s_add_u32 s45, s45, s34
    v_mfma_f32_32x32x16_bf16 v[80:95], a[32:35], a[164:167], v[80:95]
    ds_read_b128 a[160:163], v16 offset:40960
    buffer_load_dwordx4 v8, s[16:19], s45 offen offset:0  lds
    v_lshlrev_b32 v213, 3, v213
    v_add_u32 v213, v213, v210
    v_mul_u32_u24 v213, 80, v213
    v_mfma_f32_32x32x16_bf16 v[96:111], a[32:35], a[168:171], v[96:111]
    ds_read_b128 a[164:167], v16 offset:43008
    v_lshlrev_b32 v214, 3, v211
    v_add3_u32 v21, v213, v214, s37
    v_mul_u32_u24 v213, 81920, v212
    v_lshlrev_b32 v214, 8, v209
    v_mfma_f32_32x32x16_bf16 v[112:127], a[32:35], a[172:175], v[112:127]
    ds_read_b128 a[168:171], v16 offset:45056
    buffer_load_dwordx4 v9, s[16:19], s45 offen offset:1024  lds
    v_add_u32 v213, v213, v214
    v_and_b32 v214, 15, v1
    v_lshlrev_b32 v214, 4, v214
    s_waitcnt vmcnt(12) lgkmcnt(3)
    v_mfma_f32_32x32x16_bf16 v[64:79], a[36:39], a[176:179], v[64:79]
    ds_read_b128 a[172:175], v16 offset:47104
    v_add_u32 v22, v213, v214
    v_bfe_u32 v213, v208, 2, 1
    v_lshlrev_b32 v213, 10, v213
    v_mfma_f32_32x32x16_bf16 v[80:95], a[36:39], a[180:183], v[80:95]
    ds_read_b128 a[176:179], v17 offset:40960
    buffer_load_dwordx4 v10, s[16:19], s45 offen offset:2048  lds
    v_lshlrev_b32 v214, 8, v209
    v_add_u32 v213, v213, v214
    v_lshrrev_b32 v214, 3, v208
    v_mfma_f32_32x32x16_bf16 v[96:111], a[36:39], a[184:187], v[96:111]
    ds_read_b128 a[180:183], v17 offset:43008
    v_lshlrev_b32 v214, 2, v214
    v_add_u32 v214, v214, v211
    v_lshlrev_b32 v214, 4, v214
    v_add_u32 v23, v213, v214
    v_mfma_f32_32x32x16_bf16 v[112:127], a[36:39], a[188:191], v[112:127]
    ds_read_b128 a[184:187], v17 offset:45056
    buffer_load_dwordx4 v11, s[16:19], s45 offen offset:3072  lds
    s_add_u32 s101, s101, 1
    s_cmp_eq_u32 s101, 10
    s_cselect_b32 s101, 0, s101
    s_waitcnt vmcnt(13) lgkmcnt(3)
    v_mfma_f32_32x32x16_bf16 v[64:79], a[40:43], a[160:163], v[64:79]
    ds_read_b128 a[188:191], v17 offset:47104
    s_lshl_b32 s46, s101, 12
    s_add_u32 s46, s46, s31
    s_lshl_b32 s37, s28, 1
    v_mfma_f32_32x32x16_bf16 v[80:95], a[40:43], a[164:167], v[80:95]
    s_waitcnt vmcnt(8)
    s_barrier
    ds_read_b128 a[160:163], v14 offset:61440
    buffer_load_dwordx4 a[64:67], v2, s[8:11], s46 offen offset:0 sc1
    s_lshr_b32 s38, s3, 1
    v_mfma_f32_32x32x16_bf16 v[96:111], a[40:43], a[168:171], v[96:111]
    ds_read_b128 a[164:167], v14 offset:63488
    s_add_u32 s37, s37, s38
    s_and_b32 s38, s3, 1
    s_lshl_b32 s38, s38, 11
    s_mul_i32 s39, s37, 196608
    v_mfma_f32_32x32x16_bf16 v[112:127], a[40:43], a[172:175], v[112:127]
    v_add_u32 v14, 0xf000, v14
    ds_read_b128 a[168:171], v14 offset:4096
    buffer_load_dwordx4 a[68:71], v2, s[8:11], s46 offen offset:1024 sc1
    s_add_u32 s39, s39, s38
    s_add_u32 s39, s39, 0x500000
    s_waitcnt lgkmcnt(3)
    v_mfma_f32_32x32x16_bf16 v[64:79], a[44:47], a[176:179], v[64:79]
    ds_read_b128 a[172:175], v14 offset:6144
    s_mul_i32 s40, s37, 163840
    s_add_u32 s40, s40, s38
    s_add_u32 s40, s40, 0xb00000
    v_mfma_f32_32x32x16_bf16 v[80:95], a[44:47], a[180:183], v[80:95]
    ds_read_b128 a[176:179], v15 offset:61440
    buffer_load_dwordx4 a[72:75], v2, s[8:11], s46 offen offset:2048 sc1
    s_mul_i32 s37, s30, 24576
    s_add_u32 s39, s39, s37
    s_lshl_b32 s37, s29, 14
    v_mfma_f32_32x32x16_bf16 v[96:111], a[44:47], a[184:187], v[96:111]
    ds_read_b128 a[180:183], v15 offset:63488
    s_add_u32 s37, s37, 0x1000000
    s_add_u32 s20, s4, s37
    s_addc_u32 s21, s5, 0
    s_mov_b32 s22, 0x4000
    v_mfma_f32_32x32x16_bf16 v[112:127], a[44:47], a[188:191], v[112:127]
    v_add_u32 v15, 0xf000, v15
    ds_read_b128 a[184:187], v15 offset:4096
    buffer_load_dwordx4 a[76:79], v2, s[8:11], s46 offen offset:3072 sc1
    s_add_u32 s62, s62, 1
    s_cmp_eq_u32 s62, 10
    s_cselect_b32 s62, 0, s62
    s_waitcnt vmcnt(11) lgkmcnt(3)
    v_mfma_f32_32x32x16_bf16 v[64:79], a[48:51], a[160:163], v[64:79]
    ds_read_b128 a[188:191], v15 offset:6144
    s_add_u32 m0, s36, 102400
    s_lshl_b32 s45, s62, 7
    s_add_u32 s45, s45, s34
    v_mfma_f32_32x32x16_bf16 v[80:95], a[48:51], a[164:167], v[80:95]
    ds_read_b128 a[160:163], v16 offset:61440
    buffer_load_dwordx4 v8, s[16:19], s45 offen offset:0  lds
    s_mov_b32 s23, 0x20000
    s_sub_u32 s37, 15, s28
    s_lshl_b32 s37, s37, 10
    v_mfma_f32_32x32x16_bf16 v[96:111], a[48:51], a[168:171], v[96:111]
    ds_read_b128 a[164:167], v16 offset:63488
    s_lshl_b32 s38, s3, 8
    s_add_u32 s37, s37, s38
    v_lshlrev_b32 v213, 3, v208
    v_add_u32 v213, s37, v213
    v_mfma_f32_32x32x16_bf16 v[112:127], a[48:51], a[172:175], v[112:127]
    v_add_u32 v16, 0xf000, v16
    ds_read_b128 a[168:171], v16 offset:4096
    buffer_load_dwordx4 v9, s[16:19], s45 offen offset:1024  lds
    v_lshlrev_b32 v214, 10, v209
    v_add_u32 v28, v213, v214
    s_waitcnt vmcnt(12) lgkmcnt(3)
    v_mfma_f32_32x32x16_bf16 v[64:79], a[52:55], a[176:179], v[64:79]
    ds_read_b128 a[172:175], v16 offset:6144
    v_add_u32 v28, 1024, v28
    v_add_u32 v29, 4096, v28
    v_add_u32 v30, 8192, v28
    v_mfma_f32_32x32x16_bf16 v[80:95], a[52:55], a[180:183], v[80:95]
    ds_read_b128 a[176:179], v17 offset:61440
    buffer_load_dwordx4 v10, s[16:19], s45 offen offset:2048  lds
    v_add_u32 v31, 12288, v28
    v_lshlrev_b32 v214, 31, v209
    v_or_b32 v24, v213, v214
    v_mfma_f32_32x32x16_bf16 v[96:111], a[52:55], a[184:187], v[96:111]
    ds_read_b128 a[180:183], v17 offset:63488
    s_add_u32 s37, s28, 1
    v_sub_u32 v25, s37, v209
    v_lshrrev_b32 v25, 1, v25
    s_mov_b32 s42, 0xbfb8aa3b
    v_mfma_f32_32x32x16_bf16 v[112:127], a[52:55], a[188:191], v[112:127]
    v_add_u32 v17, 0xf000, v17
    ds_read_b128 a[184:187], v17 offset:4096
    buffer_load_dwordx4 v11, s[16:19], s45 offen offset:3072  lds
    s_add_u32 s101, s101, 1
    s_cmp_eq_u32 s101, 10
    s_cselect_b32 s101, 0, s101
    s_waitcnt vmcnt(13) lgkmcnt(3)
    v_mfma_f32_32x32x16_bf16 v[64:79], a[56:59], a[160:163], v[64:79]
    ds_read_b128 a[188:191], v17 offset:6144
    s_lshl_b32 s46, s101, 12
    s_add_u32 s46, s46, s31
    v_mov_b32 v54, 1.0
    v_mfma_f32_32x32x16_bf16 v[80:95], a[56:59], a[164:167], v[80:95]
    s_waitcnt vmcnt(8)
    s_barrier
    s_cmp_eq_u32 s3, 0
    s_cselect_b32 s7, 8, 0
    v_cmp_gt_u32 vcc, s7, v1
    v_lshlrev_b32 v248, 10, v1
    v_mov_b32 v249, 0x80000000
    v_cndmask_b32 v248, v249, v248, vcc
    v_mov_b32 v249, s43
    s_lshl_b32 s7, s2, 2
    s_add_u32 s7, s7, 0x11f0000
    buffer_store_dword v249, v248, s[8:11], s7 offen sc1
    ds_read_b128 a[160:163], v14 offset:20480
    buffer_load_dwordx4 a[80:83], v2, s[8:11], s46 offen offset:0 sc1
    v_mov_b32 v55, 1.0
    v_mfma_f32_32x32x16_bf16 v[96:111], a[56:59], a[168:171], v[96:111]
    ds_read_b128 a[164:167], v14 offset:22528
    v_mov_b32 v56, s42
    v_mov_b32 v57, s42
    s_and_b32 s37, s2, 7
    s_lshr_b32 s38, s2, 3
    v_mfma_f32_32x32x16_bf16 v[112:127], a[56:59], a[172:175], v[112:127]
    ds_read_b128 a[168:171], v14 offset:24576
    buffer_load_dwordx4 a[84:87], v2, s[8:11], s46 offen offset:1024 sc1
    s_and_b32 s48, s37, 3
    s_lshl_b32 s48, s48, 3
    s_and_b32 s49, s38, 7
    s_waitcnt lgkmcnt(3)
    v_mfma_f32_32x32x16_bf16 v[64:79], a[60:63], a[176:179], v[64:79]
    ds_read_b128 a[172:175], v14 offset:26624
    s_add_u32 s48, s48, s49
    s_lshr_b32 s49, s37, 2
    s_lshl_b32 s49, s49, 2
    v_mfma_f32_32x32x16_bf16 v[80:95], a[60:63], a[180:183], v[80:95]
    ds_read_b128 a[176:179], v15 offset:20480
    buffer_load_dwordx4 a[88:91], v2, s[8:11], s46 offen offset:2048 sc1
    s_lshr_b32 s38, s38, 3
    s_add_u32 s49, s49, s38
    v_add_u32 v3, 4096, v2
    v_mfma_f32_32x32x16_bf16 v[96:111], a[60:63], a[184:187], v[96:111]
    ds_read_b128 a[180:183], v15 offset:22528
    s_mul_i32 s50, s49, 204800
    s_mul_i32 s37, s3, 51200
    s_add_u32 s50, s50, s37
    s_add_u32 s50, s50, 0x1040000
    v_mfma_f32_32x32x16_bf16 v[112:127], a[60:63], a[188:191], v[112:127]
    ds_read_b128 a[184:187], v15 offset:24576
    buffer_load_dwordx4 a[92:95], v2, s[8:11], s46 offen offset:3072 sc1
    s_add_u32 s62, s62, 1
    s_cmp_eq_u32 s62, 10
    s_cselect_b32 s62, 0, s62
    s_waitcnt vmcnt(12) lgkmcnt(3)
    v_mfma_f32_32x32x16_bf16 v[64:79], a[64:67], a[160:163], v[64:79]
    ds_read_b128 a[188:191], v15 offset:26624
    s_add_u32 m0, s36, 122880
    s_lshl_b32 s45, s62, 7
    s_add_u32 s45, s45, s34
    v_mfma_f32_32x32x16_bf16 v[80:95], a[64:67], a[164:167], v[80:95]
    ds_read_b128 a[160:163], v16 offset:20480
    buffer_load_dwordx4 v8, s[16:19], s45 offen offset:0  lds
    s_mul_i32 s51, s49, 245760
    s_mul_i32 s37, s3, 61440
    s_add_u32 s51, s51, s37
    v_mfma_f32_32x32x16_bf16 v[96:111], a[64:67], a[168:171], v[96:111]
    ds_read_b128 a[164:167], v16 offset:22528
    s_add_u32 s51, s51, 0x300000
    s_mul_i32 s52, s48, 163840
    s_mul_i32 s37, s3, 40960
    s_add_u32 s52, s52, s37
    v_mfma_f32_32x32x16_bf16 v[112:127], a[64:67], a[172:175], v[112:127]
    ds_read_b128 a[168:171], v16 offset:24576
    buffer_load_dwordx4 v9, s[16:19], s45 offen offset:1024  lds
    s_add_u32 s52, s52, 0xb00000
    s_mul_i32 s53, s48, 196608
    s_mul_i32 s37, s3, 49152
    s_waitcnt vmcnt(13) lgkmcnt(3)
    v_mfma_f32_32x32x16_bf16 v[64:79], a[68:71], a[176:179], v[64:79]
    ds_read_b128 a[172:175], v16 offset:26624
    s_add_u32 s53, s53, s37
    s_add_u32 s53, s53, 0x500000
    s_lshl_b32 s60, s48, 3
    v_mfma_f32_32x32x16_bf16 v[80:95], a[68:71], a[180:183], v[80:95]
    ds_read_b128 a[176:179], v17 offset:20480
    buffer_load_dwordx4 v10, s[16:19], s45 offen offset:2048  lds
    s_add_u32 s60, s60, s49
    s_lshl_b32 s60, s60, 8
    s_add_u32 s60, s60, 0x11d0000
    v_mfma_f32_32x32x16_bf16 v[96:111], a[68:71], a[184:187], v[96:111]
    ds_read_b128 a[180:183], v17 offset:22528
    s_lshl_b32 s61, s28, 1
    s_lshr_b32 s37, s3, 1
    s_add_u32 s61, s61, s37
    s_lshl_b32 s61, s61, 11
    v_mfma_f32_32x32x16_bf16 v[112:127], a[68:71], a[188:191], v[112:127]
    ds_read_b128 a[184:187], v17 offset:24576
    buffer_load_dwordx4 v11, s[16:19], s45 offen offset:3072  lds
    s_add_u32 s101, s101, 1
    s_cmp_eq_u32 s101, 10
    s_cselect_b32 s101, 0, s101
    s_waitcnt vmcnt(14) lgkmcnt(3)
    v_mfma_f32_32x32x16_bf16 v[64:79], a[72:75], a[160:163], v[64:79]
    ds_read_b128 a[188:191], v17 offset:26624
    s_lshl_b32 s46, s101, 12
    s_add_u32 s46, s46, s31
    s_lshl_b32 s37, s29, 3
    v_mfma_f32_32x32x16_bf16 v[80:95], a[72:75], a[164:167], v[80:95]
    s_waitcnt vmcnt(9)
    s_barrier
    ds_read_b128 a[160:163], v14 offset:40960
    buffer_load_dwordx4 a[96:99], v2, s[8:11], s46 offen offset:0 sc1
    s_add_u32 s61, s61, s37
    v_mfma_f32_32x32x16_bf16 v[96:111], a[72:75], a[168:171], v[96:111]
    ds_read_b128 a[164:167], v14 offset:43008
    s_and_b32 s37, s3, 1
    s_lshl_b32 s38, s37, 2
    s_add_u32 s61, s61, s38
    s_add_u32 s61, s61, 0x11d0000
    v_mfma_f32_32x32x16_bf16 v[112:127], a[72:75], a[172:175], v[112:127]
    ds_read_b128 a[168:171], v14 offset:45056
    buffer_load_dwordx4 a[100:103], v2, s[8:11], s46 offen offset:1024 sc1
    v_lshrrev_b32 v61, 3, v1
    v_min_u32 v61, 1, v61
    v_lshlrev_b32 v61, 31, v61
    s_waitcnt lgkmcnt(3)
    v_mfma_f32_32x32x16_bf16 v[64:79], a[76:79], a[176:179], v[64:79]
    ds_read_b128 a[172:175], v14 offset:47104
    v_lshlrev_b32 v27, 8, v1
    v_or_b32 v27, v27, v61
    v_mfma_f32_32x32x16_bf16 v[80:95], a[76:79], a[180:183], v[80:95]
    ds_read_b128 a[176:179], v15 offset:40960
    buffer_load_dwordx4 a[104:107], v2, s[8:11], s46 offen offset:2048 sc1
    v_mfma_f32_32x32x16_bf16 v[96:111], a[76:79], a[184:187], v[96:111]
    ds_read_b128 a[180:183], v15 offset:43008
    v_mfma_f32_32x32x16_bf16 v[112:127], a[76:79], a[188:191], v[112:127]
    ds_read_b128 a[184:187], v15 offset:45056
    buffer_load_dwordx4 a[108:111], v2, s[8:11], s46 offen offset:3072 sc1
    s_add_u32 s62, s62, 1
    s_cmp_eq_u32 s62, 10
    s_cselect_b32 s62, 0, s62
    s_waitcnt vmcnt(11) lgkmcnt(3)
    v_mfma_f32_32x32x16_bf16 v[64:79], a[80:83], a[160:163], v[64:79]
    ds_read_b128 a[188:191], v15 offset:47104
    s_add_u32 m0, s36, 0
    s_lshl_b32 s45, s62, 7
    s_add_u32 s45, s45, s34
    v_mfma_f32_32x32x16_bf16 v[80:95], a[80:83], a[164:167], v[80:95]
    ds_read_b128 a[160:163], v16 offset:40960
    buffer_load_dwordx4 v8, s[16:19], s45 offen offset:0  lds
    v_mfma_f32_32x32x16_bf16 v[96:111], a[80:83], a[168:171], v[96:111]
    ds_read_b128 a[164:167], v16 offset:43008
    v_mfma_f32_32x32x16_bf16 v[112:127], a[80:83], a[172:175], v[112:127]
    ds_read_b128 a[168:171], v16 offset:45056
    buffer_load_dwordx4 v9, s[16:19], s45 offen offset:1024  lds
    s_waitcnt vmcnt(12) lgkmcnt(3)
    v_mfma_f32_32x32x16_bf16 v[64:79], a[84:87], a[176:179], v[64:79]
    ds_read_b128 a[172:175], v16 offset:47104
    v_mfma_f32_32x32x16_bf16 v[80:95], a[84:87], a[180:183], v[80:95]
    ds_read_b128 a[176:179], v17 offset:40960
    buffer_load_dwordx4 v10, s[16:19], s45 offen offset:2048  lds
    v_mfma_f32_32x32x16_bf16 v[96:111], a[84:87], a[184:187], v[96:111]
    ds_read_b128 a[180:183], v17 offset:43008
    v_mfma_f32_32x32x16_bf16 v[112:127], a[84:87], a[188:191], v[112:127]
    ds_read_b128 a[184:187], v17 offset:45056
    buffer_load_dwordx4 v11, s[16:19], s45 offen offset:3072  lds
    s_add_u32 s101, s101, 1
    s_cmp_eq_u32 s101, 10
    s_cselect_b32 s101, 0, s101
    s_waitcnt vmcnt(13) lgkmcnt(3)
    v_mfma_f32_32x32x16_bf16 v[64:79], a[88:91], a[160:163], v[64:79]
    ds_read_b128 a[188:191], v17 offset:47104
    s_lshl_b32 s46, s101, 12
    s_add_u32 s46, s46, s31
    v_mfma_f32_32x32x16_bf16 v[80:95], a[88:91], a[164:167], v[80:95]
    s_waitcnt vmcnt(8)
    s_barrier
    ds_read_b128 a[160:163], v14 offset:61440
    buffer_load_dwordx4 a[112:115], v2, s[8:11], s46 offen offset:0 sc1
    v_mfma_f32_32x32x16_bf16 v[96:111], a[88:91], a[168:171], v[96:111]
    ds_read_b128 a[164:167], v14 offset:63488
    v_mfma_f32_32x32x16_bf16 v[112:127], a[88:91], a[172:175], v[112:127]
    v_add_u32 v14, 0xf000, v14
    ds_read_b128 a[168:171], v14 offset:4096
    buffer_load_dwordx4 a[116:119], v2, s[8:11], s46 offen offset:1024 sc1
    s_waitcnt lgkmcnt(3)
    v_mfma_f32_32x32x16_bf16 v[64:79], a[92:95], a[176:179], v[64:79]
    ds_read_b128 a[172:175], v14 offset:6144
    v_mfma_f32_32x32x16_bf16 v[80:95], a[92:95], a[180:183], v[80:95]
    ds_read_b128 a[176:179], v15 offset:61440
    buffer_load_dwordx4 a[120:123], v2, s[8:11], s46 offen offset:2048 sc1
    v_mfma_f32_32x32x16_bf16 v[96:111], a[92:95], a[184:187], v[96:111]
    ds_read_b128 a[180:183], v15 offset:63488
    v_mfma_f32_32x32x16_bf16 v[112:127], a[92:95], a[188:191], v[112:127]
    v_add_u32 v15, 0xf000, v15
    ds_read_b128 a[184:187], v15 offset:4096
    buffer_load_dwordx4 a[124:127], v2, s[8:11], s46 offen offset:3072 sc1
    s_add_u32 s62, s62, 1
    s_cmp_eq_u32 s62, 10
    s_cselect_b32 s62, 0, s62
    s_waitcnt vmcnt(11) lgkmcnt(3)
    v_mfma_f32_32x32x16_bf16 v[64:79], a[96:99], a[160:163], v[64:79]
    ds_read_b128 a[188:191], v15 offset:6144
    s_add_u32 m0, s36, 20480
    s_lshl_b32 s45, s62, 7
    s_add_u32 s45, s45, s34
    v_mfma_f32_32x32x16_bf16 v[80:95], a[96:99], a[164:167], v[80:95]
    ds_read_b128 a[160:163], v16 offset:61440
    buffer_load_dwordx4 v8, s[16:19], s45 offen offset:0  lds
    v_mfma_f32_32x32x16_bf16 v[96:111], a[96:99], a[168:171], v[96:111]
    ds_read_b128 a[164:167], v16 offset:63488
    v_mfma_f32_32x32x16_bf16 v[112:127], a[96:99], a[172:175], v[112:127]
    v_add_u32 v16, 0xf000, v16
    ds_read_b128 a[168:171], v16 offset:4096
    buffer_load_dwordx4 v9, s[16:19], s45 offen offset:1024  lds
    s_waitcnt vmcnt(12) lgkmcnt(3)
    v_mfma_f32_32x32x16_bf16 v[64:79], a[100:103], a[176:179], v[64:79]
    ds_read_b128 a[172:175], v16 offset:6144
    v_mfma_f32_32x32x16_bf16 v[80:95], a[100:103], a[180:183], v[80:95]
    ds_read_b128 a[176:179], v17 offset:61440
    buffer_load_dwordx4 v10, s[16:19], s45 offen offset:2048  lds
    v_mfma_f32_32x32x16_bf16 v[96:111], a[100:103], a[184:187], v[96:111]
    ds_read_b128 a[180:183], v17 offset:63488
    v_mfma_f32_32x32x16_bf16 v[112:127], a[100:103], a[188:191], v[112:127]
    v_add_u32 v17, 0xf000, v17
    ds_read_b128 a[184:187], v17 offset:4096
    buffer_load_dwordx4 v11, s[16:19], s45 offen offset:3072  lds
    s_add_u32 s101, s101, 1
    s_cmp_eq_u32 s101, 10
    s_cselect_b32 s101, 0, s101
    s_waitcnt vmcnt(13) lgkmcnt(3)
    v_mfma_f32_32x32x16_bf16 v[64:79], a[104:107], a[160:163], v[64:79]
    ds_read_b128 a[188:191], v17 offset:6144
    s_lshl_b32 s46, s101, 12
    s_add_u32 s46, s46, s31
    v_mfma_f32_32x32x16_bf16 v[80:95], a[104:107], a[164:167], v[80:95]
    s_waitcnt vmcnt(8)
    s_barrier
    v_add_u32 v14, 0xfffe2000, v14
    ds_read_b128 a[160:163], v14 offset:0
    buffer_load_dwordx4 a[128:131], v2, s[8:11], s46 offen offset:0 sc1
    v_mfma_f32_32x32x16_bf16 v[96:111], a[104:107], a[168:171], v[96:111]
    ds_read_b128 a[164:167], v14 offset:2048
    v_mfma_f32_32x32x16_bf16 v[112:127], a[104:107], a[172:175], v[112:127]
    ds_read_b128 a[168:171], v14 offset:4096
    buffer_load_dwordx4 a[132:135], v2, s[8:11], s46 offen offset:1024 sc1
    s_waitcnt lgkmcnt(3)
    v_mfma_f32_32x32x16_bf16 v[64:79], a[108:111], a[176:179], v[64:79]
    ds_read_b128 a[172:175], v14 offset:6144
    v_mfma_f32_32x32x16_bf16 v[80:95], a[108:111], a[180:183], v[80:95]
    v_add_u32 v15, 0xfffe2000, v15
    ds_read_b128 a[176:179], v15 offset:0
    buffer_load_dwordx4 a[136:139], v2, s[8:11], s46 offen offset:2048 sc1
    v_mfma_f32_32x32x16_bf16 v[96:111], a[108:111], a[184:187], v[96:111]
    ds_read_b128 a[180:183], v15 offset:2048
    v_mfma_f32_32x32x16_bf16 v[112:127], a[108:111], a[188:191], v[112:127]
    ds_read_b128 a[184:187], v15 offset:4096
    buffer_load_dwordx4 a[140:143], v2, s[8:11], s46 offen offset:3072 sc1
    s_add_u32 s62, s62, 1
    s_cmp_eq_u32 s62, 10
    s_cselect_b32 s62, 0, s62
    s_waitcnt vmcnt(11) lgkmcnt(3)
    v_mfma_f32_32x32x16_bf16 v[64:79], a[112:115], a[160:163], v[64:79]
    ds_read_b128 a[188:191], v15 offset:6144
    s_add_u32 m0, s36, 40960
    s_lshl_b32 s45, s62, 7
    s_add_u32 s45, s45, s34
    v_mfma_f32_32x32x16_bf16 v[80:95], a[112:115], a[164:167], v[80:95]
    v_add_u32 v16, 0xfffe2000, v16
    ds_read_b128 a[160:163], v16 offset:0
    buffer_load_dwordx4 v8, s[16:19], s45 offen offset:0  lds
    v_mfma_f32_32x32x16_bf16 v[96:111], a[112:115], a[168:171], v[96:111]
    ds_read_b128 a[164:167], v16 offset:2048
    v_mfma_f32_32x32x16_bf16 v[112:127], a[112:115], a[172:175], v[112:127]
    ds_read_b128 a[168:171], v16 offset:4096
    buffer_load_dwordx4 v9, s[16:19], s45 offen offset:1024  lds
    s_waitcnt vmcnt(12) lgkmcnt(3)
    v_mfma_f32_32x32x16_bf16 v[64:79], a[116:119], a[176:179], v[64:79]
    ds_read_b128 a[172:175], v16 offset:6144
    v_mfma_f32_32x32x16_bf16 v[80:95], a[116:119], a[180:183], v[80:95]
    v_add_u32 v17, 0xfffe2000, v17
    ds_read_b128 a[176:179], v17 offset:0
    buffer_load_dwordx4 v10, s[16:19], s45 offen offset:2048  lds
    v_mfma_f32_32x32x16_bf16 v[96:111], a[116:119], a[184:187], v[96:111]
    ds_read_b128 a[180:183], v17 offset:2048
    v_mfma_f32_32x32x16_bf16 v[112:127], a[116:119], a[188:191], v[112:127]
    ds_read_b128 a[184:187], v17 offset:4096
    buffer_load_dwordx4 v11, s[16:19], s45 offen offset:3072  lds
    s_add_u32 s101, s101, 1
    s_cmp_eq_u32 s101, 10
    s_cselect_b32 s101, 0, s101
    s_waitcnt vmcnt(13) lgkmcnt(3)
    v_mfma_f32_32x32x16_bf16 v[64:79], a[120:123], a[160:163], v[64:79]
    ds_read_b128 a[188:191], v17 offset:6144
    s_lshl_b32 s46, s101, 12
    s_add_u32 s46, s46, s31
    v_mfma_f32_32x32x16_bf16 v[80:95], a[120:123], a[164:167], v[80:95]
    s_waitcnt vmcnt(8)
    s_barrier
    ds_read_b128 a[160:163], v14 offset:20480
    buffer_load_dwordx4 a[144:147], v2, s[8:11], s46 offen offset:0 sc1
    v_mfma_f32_32x32x16_bf16 v[96:111], a[120:123], a[168:171], v[96:111]
    ds_read_b128 a[164:167], v14 offset:22528
    v_mfma_f32_32x32x16_bf16 v[112:127], a[120:123], a[172:175], v[112:127]
    ds_read_b128 a[168:171], v14 offset:24576
    buffer_load_dwordx4 a[148:151], v2, s[8:11], s46 offen offset:1024 sc1
    s_waitcnt lgkmcnt(3)
    v_mfma_f32_32x32x16_bf16 v[64:79], a[124:127], a[176:179], v[64:79]
    ds_read_b128 a[172:175], v14 offset:26624
    v_mfma_f32_32x32x16_bf16 v[80:95], a[124:127], a[180:183], v[80:95]
    ds_read_b128 a[176:179], v15 offset:20480
    buffer_load_dwordx4 a[152:155], v2, s[8:11], s46 offen offset:2048 sc1
    v_mfma_f32_32x32x16_bf16 v[96:111], a[124:127], a[184:187], v[96:111]
    ds_read_b128 a[180:183], v15 offset:22528
    v_mfma_f32_32x32x16_bf16 v[112:127], a[124:127], a[188:191], v[112:127]
    ds_read_b128 a[184:187], v15 offset:24576
    buffer_load_dwordx4 a[156:159], v2, s[8:11], s46 offen offset:3072 sc1
    s_add_u32 s62, s62, 1
    s_cmp_eq_u32 s62, 10
    s_cselect_b32 s62, 0, s62
    s_waitcnt vmcnt(11) lgkmcnt(3)
    v_mfma_f32_32x32x16_bf16 v[64:79], a[128:131], a[160:163], v[64:79]
    ds_read_b128 a[188:191], v15 offset:26624
    s_add_u32 m0, s35, 61440
    s_mul_i32 s45, s62, 196608
    s_add_u32 s45, s45, s33
    v_mfma_f32_32x32x16_bf16 v[80:95], a[128:131], a[164:167], v[80:95]
    ds_read_b128 a[160:163], v16 offset:20480
    buffer_load_dwordx4 v4, s[12:15], s45 offen offset:0  lds
    v_mfma_f32_32x32x16_bf16 v[96:111], a[128:131], a[168:171], v[96:111]
    ds_read_b128 a[164:167], v16 offset:22528
    v_mfma_f32_32x32x16_bf16 v[112:127], a[128:131], a[172:175], v[112:127]
    ds_read_b128 a[168:171], v16 offset:24576
    buffer_load_dwordx4 v5, s[12:15], s45 offen offset:1024  lds
    s_waitcnt vmcnt(12) lgkmcnt(3)
    v_mfma_f32_32x32x16_bf16 v[64:79], a[132:135], a[176:179], v[64:79]
    ds_read_b128 a[172:175], v16 offset:26624
    v_mfma_f32_32x32x16_bf16 v[80:95], a[132:135], a[180:183], v[80:95]
    ds_read_b128 a[176:179], v17 offset:20480
    buffer_load_dwordx4 v6, s[12:15], s45 offen offset:2048  lds
    v_mfma_f32_32x32x16_bf16 v[96:111], a[132:135], a[184:187], v[96:111]
    ds_read_b128 a[180:183], v17 offset:22528
    v_mfma_f32_32x32x16_bf16 v[112:127], a[132:135], a[188:191], v[112:127]
    ds_read_b128 a[184:187], v17 offset:24576
    buffer_load_dwordx4 v7, s[12:15], s45 offen offset:3072  lds
    s_add_u32 s62, s62, 1
    s_cmp_eq_u32 s62, 10
    s_cselect_b32 s62, 0, s62
    s_and_b32 s6, s2, 7
    s_lshl_b32 s6, s6, 10
    s_add_u32 s6, s6, 0x11f0000
    buffer_load_dwordx4 v[248:251], v2, s[8:11], s6 offen sc1
    s_waitcnt vmcnt(14) lgkmcnt(3)
    v_mfma_f32_32x32x16_bf16 v[64:79], a[136:139], a[160:163], v[64:79]
    ds_read_b128 a[188:191], v17 offset:26624
    s_add_u32 m0, s35, 81920
    s_mul_i32 s45, s62, 196608
    s_add_u32 s45, s45, s33
    v_mfma_f32_32x32x16_bf16 v[80:95], a[136:139], a[164:167], v[80:95]
    s_waitcnt vmcnt(9)
    s_barrier
    ds_read_b128 a[160:163], v14 offset:40960
    buffer_load_dwordx4 v4, s[12:15], s45 offen offset:0  lds
    s_mov_b32 s16, s64
    v_mfma_f32_32x32x16_bf16 v[96:111], a[136:139], a[168:171], v[96:111]
    ds_read_b128 a[164:167], v14 offset:43008
    s_mov_b32 s17, s65
    s_mov_b32 s24, s66
    s_mov_b32 s25, s67
    s_mov_b32 s30, s68
    v_mfma_f32_32x32x16_bf16 v[112:127], a[136:139], a[172:175], v[112:127]
    ds_read_b128 a[168:171], v14 offset:45056
    buffer_load_dwordx4 v5, s[12:15], s45 offen offset:1024  lds
    s_mov_b32 s31, s69
    s_mov_b32 s18, 2621440
    s_mov_b32 s19, 0x20000
    s_waitcnt lgkmcnt(3)
    v_mfma_f32_32x32x16_bf16 v[64:79], a[140:143], a[176:179], v[64:79]
    ds_read_b128 a[172:175], v14 offset:47104
    s_mov_b32 s26, 1280
    s_mov_b32 s27, 0x20000
    v_mfma_f32_32x32x16_bf16 v[80:95], a[140:143], a[180:183], v[80:95]
    ds_read_b128 a[176:179], v15 offset:40960
    buffer_load_dwordx4 v6, s[12:15], s45 offen offset:2048  lds
    v_mfma_f32_32x32x16_bf16 v[96:111], a[140:143], a[184:187], v[96:111]
    ds_read_b128 a[180:183], v15 offset:43008
    v_mfma_f32_32x32x16_bf16 v[112:127], a[140:143], a[188:191], v[112:127]
    ds_read_b128 a[184:187], v15 offset:45056
    buffer_load_dwordx4 v7, s[12:15], s45 offen offset:3072  lds
    s_add_u32 s62, s62, 1
    s_cmp_eq_u32 s62, 10
    s_cselect_b32 s62, 0, s62
    s_waitcnt vmcnt(12) lgkmcnt(3)
    v_mfma_f32_32x32x16_bf16 v[64:79], a[144:147], a[160:163], v[64:79]
    ds_read_b128 a[188:191], v15 offset:47104
    s_add_u32 m0, s35, 102400
    s_mul_i32 s45, s62, 196608
    s_add_u32 s45, s45, s33
    v_mfma_f32_32x32x16_bf16 v[80:95], a[144:147], a[164:167], v[80:95]
    ds_read_b128 a[160:163], v16 offset:40960
    buffer_load_dwordx4 v4, s[12:15], s45 offen offset:0  lds
    v_mfma_f32_32x32x16_bf16 v[96:111], a[144:147], a[168:171], v[96:111]
    ds_read_b128 a[164:167], v16 offset:43008
    v_mfma_f32_32x32x16_bf16 v[112:127], a[144:147], a[172:175], v[112:127]
    ds_read_b128 a[168:171], v16 offset:45056
    buffer_load_dwordx4 v5, s[12:15], s45 offen offset:1024  lds
    s_waitcnt vmcnt(13) lgkmcnt(3)
    v_mfma_f32_32x32x16_bf16 v[64:79], a[148:151], a[176:179], v[64:79]
    ds_read_b128 a[172:175], v16 offset:47104
    v_mfma_f32_32x32x16_bf16 v[80:95], a[148:151], a[180:183], v[80:95]
    ds_read_b128 a[176:179], v17 offset:40960
    buffer_load_dwordx4 v6, s[12:15], s45 offen offset:2048  lds
    v_mfma_f32_32x32x16_bf16 v[96:111], a[148:151], a[184:187], v[96:111]
    ds_read_b128 a[180:183], v17 offset:43008
    v_mfma_f32_32x32x16_bf16 v[112:127], a[148:151], a[188:191], v[112:127]
    ds_read_b128 a[184:187], v17 offset:45056
    buffer_load_dwordx4 v7, s[12:15], s45 offen offset:3072  lds
    s_add_u32 s62, s62, 1
    s_cmp_eq_u32 s62, 10
    s_cselect_b32 s62, 0, s62
    s_waitcnt vmcnt(14) lgkmcnt(3)
    v_mfma_f32_32x32x16_bf16 v[64:79], a[152:155], a[160:163], v[64:79]
    ds_read_b128 a[188:191], v17 offset:47104
    s_add_u32 m0, s35, 122880
    s_mul_i32 s45, s62, 196608
    s_add_u32 s45, s45, s33
    v_mfma_f32_32x32x16_bf16 v[80:95], a[152:155], a[164:167], v[80:95]
    s_waitcnt vmcnt(9)
    s_barrier
    ds_read_b64_tr_b16 a[160:161], v12 offset:61440
    ds_read_b64_tr_b16 a[162:163], v12 offset:61952
    buffer_load_dwordx4 v4, s[12:15], s45 offen offset:0  lds
    v_mfma_f32_32x32x16_bf16 v[96:111], a[152:155], a[168:171], v[96:111]
    v_add_u32 v12, 0xf000, v12
    ds_read_b64_tr_b16 a[164:165], v12 offset:8192
    ds_read_b64_tr_b16 a[166:167], v12 offset:8704
    s_waitcnt vmcnt(9)
    v_xor_b32 v248, s43, v248
    v_xor_b32 v249, s43, v249
    v_mfma_f32_32x32x16_bf16 v[112:127], a[152:155], a[172:175], v[112:127]
    ds_read_b64_tr_b16 a[168:169], v13 offset:61440
    ds_read_b64_tr_b16 a[170:171], v13 offset:61952
    buffer_load_dwordx4 v5, s[12:15], s45 offen offset:1024  lds
    v_xor_b32 v250, s43, v250
    v_xor_b32 v251, s43, v251
    s_waitcnt lgkmcnt(6)
    v_mfma_f32_32x32x16_bf16 v[64:79], a[156:159], a[176:179], v[64:79]
    v_add_u32 v13, 0xf000, v13
    ds_read_b64_tr_b16 a[172:173], v13 offset:8192
    ds_read_b64_tr_b16 a[174:175], v13 offset:8704
    v_or3_b32 v248, v248, v249, v250
    v_mfma_f32_32x32x16_bf16 v[80:95], a[156:159], a[180:183], v[80:95]
    ds_read_b64_tr_b16 a[176:177], v12 offset:2048
    ds_read_b64_tr_b16 a[178:179], v12 offset:2560
    buffer_load_dwordx4 v6, s[12:15], s45 offen offset:2048  lds
    v_or_b32 v248, v248, v251
    v_cmp_ne_u32 vcc, 0, v248
    v_mfma_f32_32x32x16_bf16 v[96:111], a[156:159], a[184:187], v[96:111]
    ds_read_b64_tr_b16 a[180:181], v12 offset:10240
    ds_read_b64_tr_b16 a[182:183], v12 offset:10752
    s_cbranch_vccnz PFQ_retry
PFQ_back:
    v_mfma_f32_32x32x16_bf16 v[112:127], a[156:159], a[188:191], v[112:127]
    ds_read_b64_tr_b16 a[184:185], v13 offset:2048
    ds_read_b64_tr_b16 a[186:187], v13 offset:2560
    buffer_load_dwordx4 v7, s[12:15], s45 offen offset:3072  lds
    s_add_u32 s62, s62, 1
    s_cmp_eq_u32 s62, 10
    s_cselect_b32 s62, 0, s62
    s_waitcnt lgkmcnt(6)
    v_mfma_f32_32x32x16_bf16 v[144:159], a[160:163], a[0:3], 0
    ds_read_b64_tr_b16 a[188:189], v13 offset:10240
    ds_read_b64_tr_b16 a[190:191], v13 offset:10752
    s_add_u32 m0, s35, 0
    s_mul_i32 s45, s62, 196608
    s_add_u32 s45, s45, s33
    v_mfma_f32_32x32x16_bf16 v[160:175], a[164:167], a[0:3], 0
    ds_read_b64_tr_b16 a[160:161], v12 offset:4096
    ds_read_b64_tr_b16 a[162:163], v12 offset:4608
    v_fma_f32 v209, v32, v64, v65
    v_fma_f32 v211, v36, v80, v81
    v_fma_f32 v213, v40, v96, v97
    v_fma_f32 v215, v44, v112, v113
    buffer_load_dwordx4 v4, s[12:15], s45 offen offset:0  lds
    v_mfma_f32_32x32x16_bf16 v[176:191], a[168:171], a[0:3], 0
    ds_read_b64_tr_b16 a[164:165], v12 offset:12288
    ds_read_b64_tr_b16 a[166:167], v12 offset:12800
    v_fmac_f32_dpp v209, v64, -v33 row_ror:8 row_mask:0xf bank_mask:0xf
    v_fmac_f32_dpp v211, v80, -v37 row_ror:8 row_mask:0xf bank_mask:0xf
    v_fmac_f32_dpp v213, v96, -v41 row_ror:8 row_mask:0xf bank_mask:0xf
    v_fmac_f32_dpp v215, v112, -v45 row_ror:8 row_mask:0xf bank_mask:0xf
    v_fma_f32 v208, v32, v209, v66
    v_fma_f32 v210, v36, v211, v82
    v_fma_f32 v212, v40, v213, v98
    v_fma_f32 v214, v44, v215, v114
    v_fmac_f32_dpp v208, v209, -v33 row_ror:8 row_mask:0xf bank_mask:0xf
    v_fmac_f32_dpp v210, v211, -v37 row_ror:8 row_mask:0xf bank_mask:0xf
    v_mfma_f32_32x32x16_bf16 v[192:207], a[172:175], a[0:3], 0
    ds_read_b64_tr_b16 a[168:169], v13 offset:4096
    ds_read_b64_tr_b16 a[170:171], v13 offset:4608
    v_fmac_f32_dpp v212, v213, -v41 row_ror:8 row_mask:0xf bank_mask:0xf
    v_fmac_f32_dpp v214, v215, -v45 row_ror:8 row_mask:0xf bank_mask:0xf
    v_fma_f32 v209, v32, v208, v67
    v_fma_f32 v211, v36, v210, v83
    v_fma_f32 v213, v40, v212, v99
    v_fma_f32 v215, v44, v214, v115
    v_fmac_f32_dpp v209, v208, -v33 row_ror:8 row_mask:0xf bank_mask:0xf
    v_fmac_f32_dpp v211, v210, -v37 row_ror:8 row_mask:0xf bank_mask:0xf
    v_fmac_f32_dpp v213, v212, -v41 row_ror:8 row_mask:0xf bank_mask:0xf
    v_fmac_f32_dpp v215, v214, -v45 row_ror:8 row_mask:0xf bank_mask:0xf
    buffer_load_dwordx4 v5, s[12:15], s45 offen offset:1024  lds
    s_waitcnt lgkmcnt(6)
    v_mfma_f32_32x32x16_bf16 v[144:159], a[176:179], a[4:7], v[144:159]
    ds_read_b64_tr_b16 a[172:173], v13 offset:12288
    ds_read_b64_tr_b16 a[174:175], v13 offset:12800
    v_fma_f32 v208, v32, v209, v68
    v_fma_f32 v210, v36, v211, v84
    v_fma_f32 v212, v40, v213, v100
    v_fma_f32 v214, v44, v215, v116
    v_fmac_f32_dpp v208, v209, -v33 row_ror:8 row_mask:0xf bank_mask:0xf
    v_fmac_f32_dpp v210, v211, -v37 row_ror:8 row_mask:0xf bank_mask:0xf
    v_fmac_f32_dpp v212, v213, -v41 row_ror:8 row_mask:0xf bank_mask:0xf
    v_fmac_f32_dpp v214, v215, -v45 row_ror:8 row_mask:0xf bank_mask:0xf
    v_fma_f32 v209, v32, v208, v69
    v_mfma_f32_32x32x16_bf16 v[160:175], a[180:183], a[4:7], v[160:175]
    ds_read_b64_tr_b16 a[176:177], v12 offset:6144
    ds_read_b64_tr_b16 a[178:179], v12 offset:6656
    v_fma_f32 v211, v36, v210, v85
    v_fma_f32 v213, v40, v212, v101
    v_fma_f32 v215, v44, v214, v117
    v_fmac_f32_dpp v209, v208, -v33 row_ror:8 row_mask:0xf bank_mask:0xf
    v_fmac_f32_dpp v211, v210, -v37 row_ror:8 row_mask:0xf bank_mask:0xf
    v_fmac_f32_dpp v213, v212, -v41 row_ror:8 row_mask:0xf bank_mask:0xf
    v_fmac_f32_dpp v215, v214, -v45 row_ror:8 row_mask:0xf bank_mask:0xf
    v_fma_f32 v208, v32, v209, v70
    v_fma_f32 v210, v36, v211, v86
    v_fma_f32 v212, v40, v213, v102
    buffer_load_dwordx4 v6, s[12:15], s45 offen offset:2048  lds
    v_mfma_f32_32x32x16_bf16 v[176:191], a[184:187], a[4:7], v[176:191]
    ds_read_b64_tr_b16 a[180:181], v12 offset:14336
    ds_read_b64_tr_b16 a[182:183], v12 offset:14848
    v_fma_f32 v214, v44, v215, v118
    v_fmac_f32_dpp v208, v209, -v33 row_ror:8 row_mask:0xf bank_mask:0xf
    v_fmac_f32_dpp v210, v211, -v37 row_ror:8 row_mask:0xf bank_mask:0xf
    v_fmac_f32_dpp v212, v213, -v41 row_ror:8 row_mask:0xf bank_mask:0xf
    v_fmac_f32_dpp v214, v215, -v45 row_ror:8 row_mask:0xf bank_mask:0xf
    v_fma_f32 v209, v32, v208, v71
    v_fma_f32 v211, v36, v210, v87
    v_fma_f32 v213, v40, v212, v103
    v_fma_f32 v215, v44, v214, v119
    v_fmac_f32_dpp v209, v208, -v33 row_ror:8 row_mask:0xf bank_mask:0xf
    v_mfma_f32_32x32x16_bf16 v[192:207], a[188:191], a[4:7], v[192:207]
    ds_read_b64_tr_b16 a[184:185], v13 offset:6144
    ds_read_b64_tr_b16 a[186:187], v13 offset:6656
    v_fmac_f32_dpp v211, v210, -v37 row_ror:8 row_mask:0xf bank_mask:0xf
    v_fmac_f32_dpp v213, v212, -v41 row_ror:8 row_mask:0xf bank_mask:0xf
    v_fmac_f32_dpp v215, v214, -v45 row_ror:8 row_mask:0xf bank_mask:0xf
    v_fma_f32 v208, v32, v209, v72
    v_fma_f32 v210, v36, v211, v88
    v_fma_f32 v212, v40, v213, v104
    v_fma_f32 v214, v44, v215, v120
    v_fmac_f32_dpp v208, v209, -v33 row_ror:8 row_mask:0xf bank_mask:0xf
    v_fmac_f32_dpp v210, v211, -v37 row_ror:8 row_mask:0xf bank_mask:0xf
    v_fmac_f32_dpp v212, v213, -v41 row_ror:8 row_mask:0xf bank_mask:0xf
    buffer_load_dwordx4 v7, s[12:15], s45 offen offset:3072  lds
    s_add_u32 s62, s62, 1
    s_waitcnt lgkmcnt(6)
    v_mfma_f32_32x32x16_bf16 v[144:159], a[160:163], a[8:11], v[144:159]
    ds_read_b64_tr_b16 a[188:189], v13 offset:14336
    ds_read_b64_tr_b16 a[190:191], v13 offset:14848
    v_fmac_f32_dpp v214, v215, -v45 row_ror:8 row_mask:0xf bank_mask:0xf
    v_fma_f32 v209, v32, v208, v73
    v_fma_f32 v211, v36, v210, v89
    v_fma_f32 v213, v40, v212, v105
    v_fma_f32 v215, v44, v214, v121
    v_fmac_f32_dpp v209, v208, -v33 row_ror:8 row_mask:0xf bank_mask:0xf
    v_fmac_f32_dpp v211, v210, -v37 row_ror:8 row_mask:0xf bank_mask:0xf
    v_fmac_f32_dpp v213, v212, -v41 row_ror:8 row_mask:0xf bank_mask:0xf
    v_fmac_f32_dpp v215, v214, -v45 row_ror:8 row_mask:0xf bank_mask:0xf
    s_cmp_eq_u32 s62, 10
    s_cselect_b32 s62, 0, s62
    v_mfma_f32_32x32x16_bf16 v[160:175], a[164:167], a[8:11], v[160:175]
    s_waitcnt vmcnt(12)
    s_barrier
    ds_read_b64_tr_b16 a[160:161], v12 offset:20480
    ds_read_b64_tr_b16 a[162:163], v12 offset:20992
    v_fma_f32 v208, v32, v209, v74
    v_fma_f32 v210, v36, v211, v90
    v_fma_f32 v212, v40, v213, v106
    v_fma_f32 v214, v44, v215, v122
    v_fmac_f32_dpp v208, v209, -v33 row_ror:8 row_mask:0xf bank_mask:0xf
    v_fmac_f32_dpp v210, v211, -v37 row_ror:8 row_mask:0xf bank_mask:0xf
    v_fmac_f32_dpp v212, v213, -v41 row_ror:8 row_mask:0xf bank_mask:0xf
    v_fmac_f32_dpp v214, v215, -v45 row_ror:8 row_mask:0xf bank_mask:0xf
    s_add_u32 m0, s35, 20480
    s_mul_i32 s45, s62, 196608
    v_mfma_f32_32x32x16_bf16 v[176:191], a[168:171], a[8:11], v[176:191]
    ds_read_b64_tr_b16 a[164:165], v12 offset:28672
    ds_read_b64_tr_b16 a[166:167], v12 offset:29184
    v_fma_f32 v209, v32, v208, v75
    v_fma_f32 v211, v36, v210, v91
    v_fma_f32 v213, v40, v212, v107
    v_fma_f32 v215, v44, v214, v123
    v_fmac_f32_dpp v209, v208, -v33 row_ror:8 row_mask:0xf bank_mask:0xf
    v_fmac_f32_dpp v211, v210, -v37 row_ror:8 row_mask:0xf bank_mask:0xf
    v_fmac_f32_dpp v213, v212, -v41 row_ror:8 row_mask:0xf bank_mask:0xf
    v_fmac_f32_dpp v215, v214, -v45 row_ror:8 row_mask:0xf bank_mask:0xf
    v_fma_f32 v208, v32, v209, v76
    v_fma_f32 v210, v36, v211, v92
    s_add_u32 s45, s45, s33
    buffer_load_dwordx4 v4, s[12:15], s45 offen offset:0  lds
    v_mfma_f32_32x32x16_bf16 v[192:207], a[172:175], a[8:11], v[192:207]
    ds_read_b64_tr_b16 a[168:169], v13 offset:20480
    ds_read_b64_tr_b16 a[170:171], v13 offset:20992
    v_fma_f32 v212, v40, v213, v108
    v_fma_f32 v214, v44, v215, v124
    v_fmac_f32_dpp v208, v209, -v33 row_ror:8 row_mask:0xf bank_mask:0xf
    v_fmac_f32_dpp v210, v211, -v37 row_ror:8 row_mask:0xf bank_mask:0xf
    v_fmac_f32_dpp v212, v213, -v41 row_ror:8 row_mask:0xf bank_mask:0xf
    v_fmac_f32_dpp v214, v215, -v45 row_ror:8 row_mask:0xf bank_mask:0xf
    v_fma_f32 v209, v32, v208, v77
    v_fma_f32 v211, v36, v210, v93
    v_fma_f32 v213, v40, v212, v109
    v_fma_f32 v215, v44, v214, v125
    s_waitcnt lgkmcnt(6)
    v_mfma_f32_32x32x16_bf16 v[144:159], a[176:179], a[12:15], v[144:159]
    ds_read_b64_tr_b16 a[172:173], v13 offset:28672
    ds_read_b64_tr_b16 a[174:175], v13 offset:29184
    v_fmac_f32_dpp v209, v208, -v33 row_ror:8 row_mask:0xf bank_mask:0xf
    v_fmac_f32_dpp v211, v210, -v37 row_ror:8 row_mask:0xf bank_mask:0xf
    v_fmac_f32_dpp v213, v212, -v41 row_ror:8 row_mask:0xf bank_mask:0xf
    v_fmac_f32_dpp v215, v214, -v45 row_ror:8 row_mask:0xf bank_mask:0xf
    v_fma_f32 v208, v32, v209, v78
    v_fma_f32 v210, v36, v211, v94
    v_fma_f32 v212, v40, v213, v110
    v_fma_f32 v214, v44, v215, v126
    v_fmac_f32_dpp v208, v209, -v33 row_ror:8 row_mask:0xf bank_mask:0xf
    buffer_load_dwordx4 v5, s[12:15], s45 offen offset:1024  lds
    v_mfma_f32_32x32x16_bf16 v[160:175], a[180:183], a[12:15], v[160:175]
    ds_read_b64_tr_b16 a[176:177], v12 offset:22528
    ds_read_b64_tr_b16 a[178:179], v12 offset:23040
    v_fmac_f32_dpp v210, v211, -v37 row_ror:8 row_mask:0xf bank_mask:0xf
    v_fmac_f32_dpp v212, v213, -v41 row_ror:8 row_mask:0xf bank_mask:0xf
    v_fmac_f32_dpp v214, v215, -v45 row_ror:8 row_mask:0xf bank_mask:0xf
    v_fma_f32 v209, v32, v208, v79
    v_fma_f32 v211, v36, v210, v95
    v_fma_f32 v213, v40, v212, v111
    v_fma_f32 v215, v44, v214, v127
    v_fmac_f32_dpp v209, v208, -v33 row_ror:8 row_mask:0xf bank_mask:0xf
    v_fmac_f32_dpp v211, v210, -v37 row_ror:8 row_mask:0xf bank_mask:0xf
    v_fmac_f32_dpp v213, v212, -v41 row_ror:8 row_mask:0xf bank_mask:0xf
    v_mfma_f32_32x32x16_bf16 v[176:191], a[184:187], a[12:15], v[176:191]
    ds_read_b64_tr_b16 a[180:181], v12 offset:30720
    ds_read_b64_tr_b16 a[182:183], v12 offset:31232
    v_fmac_f32_dpp v215, v214, -v45 row_ror:8 row_mask:0xf bank_mask:0xf
    v_mul_f32 v208, v34, v209
    v_mul_f32 v210, v38, v211
    v_mul_f32 v212, v42, v213
    v_mul_f32 v214, v46, v215
    v_fmac_f32_dpp v208, v209, v35 row_ror:8 row_mask:0xf bank_mask:0xf
    v_fmac_f32_dpp v210, v211, v39 row_ror:8 row_mask:0xf bank_mask:0xf
    v_fmac_f32_dpp v212, v213, v43 row_ror:8 row_mask:0xf bank_mask:0xf
    v_fmac_f32_dpp v214, v215, v47 row_ror:8 row_mask:0xf bank_mask:0xf
    ds_write_b32 v18, v208 offset:0
    buffer_load_dwordx4 v6, s[12:15], s45 offen offset:2048  lds
    v_mfma_f32_32x32x16_bf16 v[192:207], a[188:191], a[12:15], v[192:207]
    ds_read_b64_tr_b16 a[184:185], v13 offset:22528
    ds_read_b64_tr_b16 a[186:187], v13 offset:23040
    ds_write_b32 v18, v210 offset:1024
    ds_write_b32 v18, v212 offset:2048
    ds_write_b32 v18, v214 offset:3072
    s_waitcnt lgkmcnt(0)
    s_barrier
    ds_read_b128 v[216:219], v19
    ds_read_b128 v[220:223], v19 offset:16
    s_waitcnt lgkmcnt(1)
    v_fma_f32 v210, v48, v216, v217
    v_fmac_f32_dpp v210, v216, v49 row_ror:8 row_mask:0xf bank_mask:0xf
    v_fma_f32 v208, v48, v210, v218
    v_mfma_f32_32x32x16_bf16 v[144:159], a[160:163], a[16:19], v[144:159]
    ds_read_b64_tr_b16 a[188:189], v13 offset:30720
    ds_read_b64_tr_b16 a[190:191], v13 offset:31232
    v_fmac_f32_dpp v208, v210, v49 row_ror:8 row_mask:0xf bank_mask:0xf
    v_fma_f32 v210, v48, v208, v219
    s_nop 0
    v_fmac_f32_dpp v210, v208, v49 row_ror:8 row_mask:0xf bank_mask:0xf
    s_waitcnt lgkmcnt(2)
    v_fma_f32 v208, v48, v210, v220
    v_fmac_f32_dpp v208, v210, v49 row_ror:8 row_mask:0xf bank_mask:0xf
    v_fma_f32 v210, v48, v208, v221
    s_nop 0
    v_fmac_f32_dpp v210, v208, v49 row_ror:8 row_mask:0xf bank_mask:0xf
    v_fma_f32 v208, v48, v210, v222
    s_nop 0
    v_fmac_f32_dpp v208, v210, v49 row_ror:8 row_mask:0xf bank_mask:0xf
    buffer_load_dwordx4 v7, s[12:15], s45 offen offset:3072  lds
    s_add_u32 s62, s62, 1
    v_mfma_f32_32x32x16_bf16 v[160:175], a[164:167], a[16:19], v[160:175]
    ds_read_b64_tr_b16 a[160:161], v12 offset:24576
    ds_read_b64_tr_b16 a[162:163], v12 offset:25088
    v_fma_f32 v210, v48, v208, v223
    v_fmac_f32_dpp v210, v208, v49 row_ror:8 row_mask:0xf bank_mask:0xf
    v_mov_b32 v211, s43
    buffer_store_dwordx2 v[210:211], v24, s[20:23], 0 offen sc1
    s_cmp_eq_u32 s62, 10
    s_cselect_b32 s62, 0, s62
    s_add_u32 m0, s35, 40960
    s_mul_i32 s45, s62, 196608
    s_add_u32 s45, s45, s33
    v_mfma_f32_32x32x16_bf16 v[176:191], a[168:171], a[16:19], v[176:191]
    ds_read_b64_tr_b16 a[164:165], v12 offset:32768
    ds_read_b64_tr_b16 a[166:167], v12 offset:33280
    buffer_load_dwordx4 v4, s[12:15], s45 offen offset:0  lds
    v_mul_f32 v212, v34, v64
    v_mul_f32 v213, v38, v80
    v_mul_f32 v214, v42, v96
    v_mfma_f32_32x32x16_bf16 v[192:207], a[172:175], a[16:19], v[192:207]
    ds_read_b64_tr_b16 a[168:169], v13 offset:24576
    ds_read_b64_tr_b16 a[170:171], v13 offset:25088
    v_mul_f32 v215, v46, v112
    v_fmac_f32_dpp v212, v64, v35 row_ror:8 row_mask:0xf bank_mask:0xf
    v_fmac_f32_dpp v213, v80, v39 row_ror:8 row_mask:0xf bank_mask:0xf
    v_fmac_f32_dpp v214, v96, v43 row_ror:8 row_mask:0xf bank_mask:0xf
    s_waitcnt lgkmcnt(6)
    v_mfma_f32_32x32x16_bf16 v[144:159], a[176:179], a[20:23], v[144:159]
    ds_read_b64_tr_b16 a[172:173], v13 offset:32768
    ds_read_b64_tr_b16 a[174:175], v13 offset:33280
    buffer_load_dwordx4 v5, s[12:15], s45 offen offset:1024  lds
    v_fmac_f32_dpp v215, v112, v47 row_ror:8 row_mask:0xf bank_mask:0xf
    v_mul_f32 v64, v34, v65
    v_mfma_f32_32x32x16_bf16 v[160:175], a[180:183], a[20:23], v[160:175]
    ds_read_b64_tr_b16 a[176:177], v12 offset:26624
    ds_read_b64_tr_b16 a[178:179], v12 offset:27136
    v_mul_f32 v80, v38, v81
    v_mul_f32 v96, v42, v97
    v_mul_f32 v112, v46, v113
    v_fmac_f32_dpp v64, v65, v35 row_ror:8 row_mask:0xf bank_mask:0xf
    v_mfma_f32_32x32x16_bf16 v[176:191], a[184:187], a[20:23], v[176:191]
    ds_read_b64_tr_b16 a[180:181], v12 offset:34816
    ds_read_b64_tr_b16 a[182:183], v12 offset:35328
    buffer_load_dwordx4 v6, s[12:15], s45 offen offset:2048  lds
    v_fmac_f32_dpp v80, v81, v39 row_ror:8 row_mask:0xf bank_mask:0xf
    v_fmac_f32_dpp v96, v97, v43 row_ror:8 row_mask:0xf bank_mask:0xf
    v_fmac_f32_dpp v112, v113, v47 row_ror:8 row_mask:0xf bank_mask:0xf
    v_mfma_f32_32x32x16_bf16 v[192:207], a[188:191], a[20:23], v[192:207]
    ds_read_b64_tr_b16 a[184:185], v13 offset:26624
    ds_read_b64_tr_b16 a[186:187], v13 offset:27136
    v_mul_f32 v65, v34, v66
    v_mul_f32 v81, v38, v82
    v_mul_f32 v97, v42, v98
    v_mul_f32 v113, v46, v114
    s_waitcnt lgkmcnt(6)
    v_mfma_f32_32x32x16_bf16 v[144:159], a[160:163], a[24:27], v[144:159]
    ds_read_b64_tr_b16 a[188:189], v13 offset:34816
    ds_read_b64_tr_b16 a[190:191], v13 offset:35328
    buffer_load_dwordx4 v7, s[12:15], s45 offen offset:3072  lds
    v_fmac_f32_dpp v65, v66, v35 row_ror:8 row_mask:0xf bank_mask:0xf
    v_fmac_f32_dpp v81, v82, v39 row_ror:8 row_mask:0xf bank_mask:0xf
    v_mfma_f32_32x32x16_bf16 v[160:175], a[164:167], a[24:27], v[160:175]
    s_waitcnt vmcnt(17)
    s_barrier
    ds_read_b64_tr_b16 a[160:161], v12 offset:40960
    ds_read_b64_tr_b16 a[162:163], v12 offset:41472
    s_add_u32 s62, s62, 1
    s_cmp_eq_u32 s62, 10
    s_cselect_b32 s62, 0, s62
    v_mfma_f32_32x32x16_bf16 v[176:191], a[168:171], a[24:27], v[176:191]
    ds_read_b64_tr_b16 a[164:165], v12 offset:49152
    ds_read_b64_tr_b16 a[166:167], v12 offset:49664
    s_add_u32 m0, s35, 61440
    s_mul_i32 s45, s62, 196608
    s_add_u32 s45, s45, s33
    buffer_load_dwordx4 v4, s[12:15], s45 offen offset:0  lds
    v_mfma_f32_32x32x16_bf16 v[192:207], a[172:175], a[24:27], v[192:207]
    ds_read_b64_tr_b16 a[168:169], v13 offset:40960
    ds_read_b64_tr_b16 a[170:171], v13 offset:41472
    v_fmac_f32_dpp v97, v98, v43 row_ror:8 row_mask:0xf bank_mask:0xf
    v_fmac_f32_dpp v113, v114, v47 row_ror:8 row_mask:0xf bank_mask:0xf
    v_mul_f32 v66, v34, v67
    v_mul_f32 v82, v38, v83
    s_waitcnt lgkmcnt(6)
    v_mfma_f32_32x32x16_bf16 v[144:159], a[176:179], a[28:31], v[144:159]
    ds_read_b64_tr_b16 a[172:173], v13 offset:49152
    ds_read_b64_tr_b16 a[174:175], v13 offset:49664
    buffer_load_dwordx4 v5, s[12:15], s45 offen offset:1024  lds
    v_mul_f32 v98, v42, v99
    v_mul_f32 v114, v46, v115
    v_mfma_f32_32x32x16_bf16 v[160:175], a[180:183], a[28:31], v[160:175]
    ds_read_b64_tr_b16 a[176:177], v12 offset:43008
    ds_read_b64_tr_b16 a[178:179], v12 offset:43520
    v_fmac_f32_dpp v66, v67, v35 row_ror:8 row_mask:0xf bank_mask:0xf
    v_fmac_f32_dpp v82, v83, v39 row_ror:8 row_mask:0xf bank_mask:0xf
    v_fmac_f32_dpp v98, v99, v43 row_ror:8 row_mask:0xf bank_mask:0xf
    v_fmac_f32_dpp v114, v115, v47 row_ror:8 row_mask:0xf bank_mask:0xf
    v_mfma_f32_32x32x16_bf16 v[176:191], a[184:187], a[28:31], v[176:191]
    ds_read_b64_tr_b16 a[180:181], v12 offset:51200
    ds_read_b64_tr_b16 a[182:183], v12 offset:51712
    buffer_load_dwordx4 v6, s[12:15], s45 offen offset:2048  lds
    v_mul_f32 v67, v34, v68
    v_mul_f32 v83, v38, v84
    v_mul_f32 v99, v42, v100
    v_mfma_f32_32x32x16_bf16 v[192:207], a[188:191], a[28:31], v[192:207]
    ds_read_b64_tr_b16 a[184:185], v13 offset:43008
    ds_read_b64_tr_b16 a[186:187], v13 offset:43520
    v_mul_f32 v115, v46, v116
    v_fmac_f32_dpp v67, v68, v35 row_ror:8 row_mask:0xf bank_mask:0xf
    v_fmac_f32_dpp v83, v84, v39 row_ror:8 row_mask:0xf bank_mask:0xf
    v_fmac_f32_dpp v99, v100, v43 row_ror:8 row_mask:0xf bank_mask:0xf
    s_waitcnt lgkmcnt(6)
    v_mfma_f32_32x32x16_bf16 v[144:159], a[160:163], a[32:35], v[144:159]
    ds_read_b64_tr_b16 a[188:189], v13 offset:51200
    ds_read_b64_tr_b16 a[190:191], v13 offset:51712
    buffer_load_dwordx4 v7, s[12:15], s45 offen offset:3072  lds
    v_fmac_f32_dpp v115, v116, v47 row_ror:8 row_mask:0xf bank_mask:0xf
    v_mul_f32 v68, v34, v69
    v_mfma_f32_32x32x16_bf16 v[160:175], a[164:167], a[32:35], v[160:175]
    ds_read_b64_tr_b16 a[160:161], v12 offset:45056
    ds_read_b64_tr_b16 a[162:163], v12 offset:45568
    v_mul_f32 v84, v38, v85
    v_mul_f32 v100, v42, v101
    v_mul_f32 v116, v46, v117
    v_fmac_f32_dpp v68, v69, v35 row_ror:8 row_mask:0xf bank_mask:0xf
    v_mfma_f32_32x32x16_bf16 v[176:191], a[168:171], a[32:35], v[176:191]
    ds_read_b64_tr_b16 a[164:165], v12 offset:53248
    ds_read_b64_tr_b16 a[166:167], v12 offset:53760
    v_fmac_f32_dpp v84, v85, v39 row_ror:8 row_mask:0xf bank_mask:0xf
    v_fmac_f32_dpp v100, v101, v43 row_ror:8 row_mask:0xf bank_mask:0xf
    v_fmac_f32_dpp v116, v117, v47 row_ror:8 row_mask:0xf bank_mask:0xf
    v_mul_f32 v69, v34, v70
    s_add_u32 s54, s50, 0
    buffer_load_dwordx4 a[192:195], v2, s[8:11], s54 offen offset:0 sc1
    v_mfma_f32_32x32x16_bf16 v[192:207], a[172:175], a[32:35], v[192:207]
    ds_read_b64_tr_b16 a[168:169], v13 offset:45056
    ds_read_b64_tr_b16 a[170:171], v13 offset:45568
    v_mul_f32 v85, v38, v86
    v_mul_f32 v101, v42, v102
    v_mul_f32 v117, v46, v118
    v_fmac_f32_dpp v69, v70, v35 row_ror:8 row_mask:0xf bank_mask:0xf
    s_waitcnt lgkmcnt(6)
    v_mfma_f32_32x32x16_bf16 v[144:159], a[176:179], a[36:39], v[144:159]
    ds_read_b64_tr_b16 a[172:173], v13 offset:53248
    ds_read_b64_tr_b16 a[174:175], v13 offset:53760
    v_fmac_f32_dpp v85, v86, v39 row_ror:8 row_mask:0xf bank_mask:0xf
    v_fmac_f32_dpp v101, v102, v43 row_ror:8 row_mask:0xf bank_mask:0xf
    v_fmac_f32_dpp v117, v118, v47 row_ror:8 row_mask:0xf bank_mask:0xf
    buffer_load_dwordx4 a[196:199], v2, s[8:11], s54 offen offset:1024 sc1
    v_mfma_f32_32x32x16_bf16 v[160:175], a[180:183], a[36:39], v[160:175]
    ds_read_b64_tr_b16 a[176:177], v12 offset:47104
    ds_read_b64_tr_b16 a[178:179], v12 offset:47616
    v_mul_f32 v70, v34, v71
    v_mul_f32 v86, v38, v87
    v_mul_f32 v102, v42, v103
    v_mul_f32 v118, v46, v119
    v_mfma_f32_32x32x16_bf16 v[176:191], a[184:187], a[36:39], v[176:191]
    ds_read_b64_tr_b16 a[180:181], v12 offset:55296
    ds_read_b64_tr_b16 a[182:183], v12 offset:55808
    v_fmac_f32_dpp v70, v71, v35 row_ror:8 row_mask:0xf bank_mask:0xf
    v_fmac_f32_dpp v86, v87, v39 row_ror:8 row_mask:0xf bank_mask:0xf
    v_fmac_f32_dpp v102, v103, v43 row_ror:8 row_mask:0xf bank_mask:0xf
    v_fmac_f32_dpp v118, v119, v47 row_ror:8 row_mask:0xf bank_mask:0xf
    buffer_load_dwordx4 a[200:203], v2, s[8:11], s54 offen offset:2048 sc1
    v_mfma_f32_32x32x16_bf16 v[192:207], a[188:191], a[36:39], v[192:207]
    ds_read_b64_tr_b16 a[184:185], v13 offset:47104
    ds_read_b64_tr_b16 a[186:187], v13 offset:47616
    v_mul_f32 v71, v34, v72
    v_mul_f32 v87, v38, v88
    v_mul_f32 v103, v42, v104
    v_mul_f32 v119, v46, v120
    s_waitcnt lgkmcnt(6)
    v_mfma_f32_32x32x16_bf16 v[144:159], a[160:163], a[40:43], v[144:159]
    ds_read_b64_tr_b16 a[188:189], v13 offset:55296
    ds_read_b64_tr_b16 a[190:191], v13 offset:55808
    v_fmac_f32_dpp v71, v72, v35 row_ror:8 row_mask:0xf bank_mask:0xf
    v_fmac_f32_dpp v87, v88, v39 row_ror:8 row_mask:0xf bank_mask:0xf
    v_fmac_f32_dpp v103, v104, v43 row_ror:8 row_mask:0xf bank_mask:0xf
    buffer_load_dwordx4 a[204:207], v2, s[8:11], s54 offen offset:3072 sc1
    v_mfma_f32_32x32x16_bf16 v[160:175], a[164:167], a[40:43], v[160:175]
    s_waitcnt vmcnt(21)
    s_barrier
    ds_read_b64_tr_b16 a[160:161], v12 offset:61440
    ds_read_b64_tr_b16 a[162:163], v12 offset:61952
    s_add_u32 s62, s62, 1
    s_cmp_eq_u32 s62, 10
    s_cselect_b32 s62, 0, s62
    v_mfma_f32_32x32x16_bf16 v[176:191], a[168:171], a[40:43], v[176:191]
    v_add_u32 v12, 0xf000, v12
    ds_read_b64_tr_b16 a[164:165], v12 offset:8192
    ds_read_b64_tr_b16 a[166:167], v12 offset:8704
    s_add_u32 m0, s35, 81920
    s_mul_i32 s45, s62, 196608
    s_add_u32 s45, s45, s33
    v_mfma_f32_32x32x16_bf16 v[192:207], a[172:175], a[40:43], v[192:207]
    ds_read_b64_tr_b16 a[168:169], v13 offset:61440
    ds_read_b64_tr_b16 a[170:171], v13 offset:61952
    buffer_load_dwordx4 v4, s[12:15], s45 offen offset:0  lds
    v_fmac_f32_dpp v119, v120, v47 row_ror:8 row_mask:0xf bank_mask:0xf
    v_mul_f32 v72, v34, v73
    v_mul_f32 v88, v38, v89
    s_waitcnt lgkmcnt(6)
    v_mfma_f32_32x32x16_bf16 v[144:159], a[176:179], a[44:47], v[144:159]
    v_add_u32 v13, 0xf000, v13
    ds_read_b64_tr_b16 a[172:173], v13 offset:8192
    ds_read_b64_tr_b16 a[174:175], v13 offset:8704
    v_mul_f32 v104, v42, v105
    v_mul_f32 v120, v46, v121
    v_mfma_f32_32x32x16_bf16 v[160:175], a[180:183], a[44:47], v[160:175]
    ds_read_b64_tr_b16 a[176:177], v12 offset:2048
    ds_read_b64_tr_b16 a[178:179], v12 offset:2560
    buffer_load_dwordx4 v5, s[12:15], s45 offen offset:1024  lds
    v_fmac_f32_dpp v72, v73, v35 row_ror:8 row_mask:0xf bank_mask:0xf
    v_fmac_f32_dpp v88, v89, v39 row_ror:8 row_mask:0xf bank_mask:0xf
    v_fmac_f32_dpp v104, v105, v43 row_ror:8 row_mask:0xf bank_mask:0xf
    v_mfma_f32_32x32x16_bf16 v[176:191], a[184:187], a[44:47], v[176:191]
    ds_read_b64_tr_b16 a[180:181], v12 offset:10240
    ds_read_b64_tr_b16 a[182:183], v12 offset:10752
    v_fmac_f32_dpp v120, v121, v47 row_ror:8 row_mask:0xf bank_mask:0xf
    v_mul_f32 v73, v34, v74
    v_mul_f32 v89, v38, v90
    v_mul_f32 v105, v42, v106
    v_mfma_f32_32x32x16_bf16 v[192:207], a[188:191], a[44:47], v[192:207]
    ds_read_b64_tr_b16 a[184:185], v13 offset:2048
    ds_read_b64_tr_b16 a[186:187], v13 offset:2560
    buffer_load_dwordx4 v6, s[12:15], s45 offen offset:2048  lds
    v_mul_f32 v121, v46, v122
    v_fmac_f32_dpp v73, v74, v35 row_ror:8 row_mask:0xf bank_mask:0xf
    v_fmac_f32_dpp v89, v90, v39 row_ror:8 row_mask:0xf bank_mask:0xf
    s_waitcnt lgkmcnt(6)
    v_mfma_f32_32x32x16_bf16 v[144:159], a[160:163], a[48:51], v[144:159]
    ds_read_b64_tr_b16 a[188:189], v13 offset:10240
    ds_read_b64_tr_b16 a[190:191], v13 offset:10752
    buffer_load_dwordx2 v[224:225], v28, s[20:23], 0 offen offset:0 sc1
    buffer_load_dwordx2 v[226:227], v28, s[20:23], 0 offen offset:2048 sc1
    v_fmac_f32_dpp v105, v106, v43 row_ror:8 row_mask:0xf bank_mask:0xf
    v_mfma_f32_32x32x16_bf16 v[160:175], a[164:167], a[48:51], v[160:175]
    ds_read_b64_tr_b16 a[160:161], v12 offset:4096
    ds_read_b64_tr_b16 a[162:163], v12 offset:4608
    buffer_load_dwordx2 v[228:229], v29, s[20:23], 0 offen offset:0 sc1
    buffer_load_dwordx2 v[230:231], v29, s[20:23], 0 offen offset:2048 sc1
    buffer_load_dwordx4 v7, s[12:15], s45 offen offset:3072  lds
    v_fmac_f32_dpp v121, v122, v47 row_ror:8 row_mask:0xf bank_mask:0xf
    v_mfma_f32_32x32x16_bf16 v[176:191], a[168:171], a[48:51], v[176:191]
    ds_read_b64_tr_b16 a[164:165], v12 offset:12288
    ds_read_b64_tr_b16 a[166:167], v12 offset:12800
    buffer_load_dwordx2 v[232:233], v30, s[20:23], 0 offen offset:0 sc1
    buffer_load_dwordx2 v[234:235], v30, s[20:23], 0 offen offset:2048 sc1
    v_mul_f32 v74, v34, v75
    v_mul_f32 v90, v38, v91
    v_mfma_f32_32x32x16_bf16 v[192:207], a[172:175], a[48:51], v[192:207]
    ds_read_b64_tr_b16 a[168:169], v13 offset:4096
    ds_read_b64_tr_b16 a[170:171], v13 offset:4608
    buffer_load_dwordx2 v[236:237], v31, s[20:23], 0 offen offset:0 sc1
    buffer_load_dwordx2 v[238:239], v31, s[20:23], 0 offen offset:2048 sc1
    v_mul_f32 v106, v42, v107
    v_mul_f32 v122, v46, v123
    buffer_load_dwordx4 a[208:211], v3, s[8:11], s54 offen offset:0 sc1
    s_waitcnt lgkmcnt(6)
    v_mfma_f32_32x32x16_bf16 v[144:159], a[176:179], a[52:55], v[144:159]
    ds_read_b64_tr_b16 a[172:173], v13 offset:12288
    ds_read_b64_tr_b16 a[174:175], v13 offset:12800
    v_fmac_f32_dpp v74, v75, v35 row_ror:8 row_mask:0xf bank_mask:0xf
    v_fmac_f32_dpp v90, v91, v39 row_ror:8 row_mask:0xf bank_mask:0xf
    v_fmac_f32_dpp v106, v107, v43 row_ror:8 row_mask:0xf bank_mask:0xf
    v_mfma_f32_32x32x16_bf16 v[160:175], a[180:183], a[52:55], v[160:175]
    ds_read_b64_tr_b16 a[176:177], v12 offset:6144
    ds_read_b64_tr_b16 a[178:179], v12 offset:6656
    v_fmac_f32_dpp v122, v123, v47 row_ror:8 row_mask:0xf bank_mask:0xf
    v_mul_f32 v75, v34, v76
    v_mul_f32 v91, v38, v92
    v_mul_f32 v107, v42, v108
    s_add_u32 s54, s50, 5120
    buffer_load_dwordx4 a[212:215], v2, s[8:11], s54 offen offset:0 sc1
    v_mfma_f32_32x32x16_bf16 v[176:191], a[184:187], a[52:55], v[176:191]
    ds_read_b64_tr_b16 a[180:181], v12 offset:14336
    ds_read_b64_tr_b16 a[182:183], v12 offset:14848
    v_mul_f32 v123, v46, v124
    v_fmac_f32_dpp v75, v76, v35 row_ror:8 row_mask:0xf bank_mask:0xf
    v_fmac_f32_dpp v91, v92, v39 row_ror:8 row_mask:0xf bank_mask:0xf
    v_fmac_f32_dpp v107, v108, v43 row_ror:8 row_mask:0xf bank_mask:0xf
    v_mfma_f32_32x32x16_bf16 v[192:207], a[188:191], a[52:55], v[192:207]
    ds_read_b64_tr_b16 a[184:185], v13 offset:6144
    ds_read_b64_tr_b16 a[186:187], v13 offset:6656
    v_fmac_f32_dpp v123, v124, v47 row_ror:8 row_mask:0xf bank_mask:0xf
    v_mul_f32 v76, v34, v77
    v_mul_f32 v92, v38, v93
    v_mul_f32 v108, v42, v109
    buffer_load_dwordx4 a[216:219], v2, s[8:11], s54 offen offset:1024 sc1
    s_waitcnt lgkmcnt(6)
    v_mfma_f32_32x32x16_bf16 v[144:159], a[160:163], a[56:59], v[144:159]
    ds_read_b64_tr_b16 a[188:189], v13 offset:14336
    ds_read_b64_tr_b16 a[190:191], v13 offset:14848
    v_mul_f32 v124, v46, v125
    v_fmac_f32_dpp v76, v77, v35 row_ror:8 row_mask:0xf bank_mask:0xf
    v_fmac_f32_dpp v92, v93, v39 row_ror:8 row_mask:0xf bank_mask:0xf
    v_mfma_f32_32x32x16_bf16 v[160:175], a[164:167], a[56:59], v[160:175]
    s_waitcnt vmcnt(32)
    s_barrier
    v_add_u32 v12, 0xfffe2000, v12
    ds_read_b64_tr_b16 a[160:161], v12 offset:0
    ds_read_b64_tr_b16 a[162:163], v12 offset:512
    s_add_u32 s62, s62, 1
    v_mfma_f32_32x32x16_bf16 v[176:191], a[168:171], a[56:59], v[176:191]
    ds_read_b64_tr_b16 a[164:165], v12 offset:8192
    ds_read_b64_tr_b16 a[166:167], v12 offset:8704
    s_cmp_eq_u32 s62, 10
    s_cselect_b32 s62, 0, s62
    s_add_u32 m0, s35, 102400
    s_mul_i32 s45, s62, 196608
    v_mfma_f32_32x32x16_bf16 v[192:207], a[172:175], a[56:59], v[192:207]
    v_add_u32 v13, 0xfffe2000, v13
    ds_read_b64_tr_b16 a[168:169], v13 offset:0
    ds_read_b64_tr_b16 a[170:171], v13 offset:512
    s_add_u32 s45, s45, s33
    buffer_load_dwordx4 v4, s[12:15], s45 offen offset:0  lds
    v_fmac_f32_dpp v108, v109, v43 row_ror:8 row_mask:0xf bank_mask:0xf
    s_waitcnt lgkmcnt(6)
    v_mfma_f32_32x32x16_bf16 v[144:159], a[176:179], a[60:63], v[144:159]
    ds_read_b64_tr_b16 a[172:173], v13 offset:8192
    ds_read_b64_tr_b16 a[174:175], v13 offset:8704
    v_fmac_f32_dpp v124, v125, v47 row_ror:8 row_mask:0xf bank_mask:0xf
    v_mul_f32 v77, v34, v78
    v_mul_f32 v93, v38, v94
    v_mfma_f32_32x32x16_bf16 v[160:175], a[180:183], a[60:63], v[160:175]
    ds_read_b64_tr_b16 a[176:177], v12 offset:2048
    ds_read_b64_tr_b16 a[178:179], v12 offset:2560
    buffer_load_dwordx4 v5, s[12:15], s45 offen offset:1024  lds
    v_mul_f32 v109, v42, v110
    v_mul_f32 v125, v46, v126
    v_fmac_f32_dpp v77, v78, v35 row_ror:8 row_mask:0xf bank_mask:0xf
    v_mfma_f32_32x32x16_bf16 v[176:191], a[184:187], a[60:63], v[176:191]
    ds_read_b64_tr_b16 a[180:181], v12 offset:10240
    ds_read_b64_tr_b16 a[182:183], v12 offset:10752
    v_fmac_f32_dpp v93, v94, v39 row_ror:8 row_mask:0xf bank_mask:0xf
    v_fmac_f32_dpp v109, v110, v43 row_ror:8 row_mask:0xf bank_mask:0xf
    v_fmac_f32_dpp v125, v126, v47 row_ror:8 row_mask:0xf bank_mask:0xf
    v_mul_f32 v78, v34, v79
    v_mfma_f32_32x32x16_bf16 v[192:207], a[188:191], a[60:63], v[192:207]
    ds_read_b64_tr_b16 a[184:185], v13 offset:2048
    ds_read_b64_tr_b16 a[186:187], v13 offset:2560
    buffer_load_dwordx4 v6, s[12:15], s45 offen offset:2048  lds
    v_mul_f32 v94, v38, v95
    v_mul_f32 v110, v42, v111
    v_mul_f32 v126, v46, v127
    s_waitcnt lgkmcnt(6)
    v_mfma_f32_32x32x16_bf16 v[144:159], a[160:163], a[64:67], v[144:159]
    ds_read_b64_tr_b16 a[188:189], v13 offset:10240
    ds_read_b64_tr_b16 a[190:191], v13 offset:10752
    v_mov_b32 v26, 0
    s_waitcnt vmcnt(14)
    v_cmp_eq_u32 s[64:65], s43, v225
    s_waitcnt vmcnt(13)
    v_cmp_eq_u32 s[66:67], s43, v227
    v_fmac_f32_dpp v78, v79, v35 row_ror:8 row_mask:0xf bank_mask:0xf
    v_fmac_f32_dpp v94, v95, v39 row_ror:8 row_mask:0xf bank_mask:0xf
    v_mfma_f32_32x32x16_bf16 v[160:175], a[164:167], a[64:67], v[160:175]
    ds_read_b64_tr_b16 a[160:161], v12 offset:4096
    ds_read_b64_tr_b16 a[162:163], v12 offset:4608
    s_waitcnt vmcnt(12)
    v_cmp_eq_u32 s[68:69], s43, v229
    s_waitcnt vmcnt(11)
    v_cmp_eq_u32 s[70:71], s43, v231
    s_waitcnt vmcnt(9)
    v_cmp_eq_u32 s[72:73], s43, v233
    s_waitcnt vmcnt(8)
    v_cmp_eq_u32 s[74:75], s43, v235
    s_waitcnt vmcnt(7)
    v_cmp_eq_u32 s[76:77], s43, v237
    buffer_load_dwordx4 v7, s[12:15], s45 offen offset:3072  lds
    v_fmac_f32_dpp v110, v111, v43 row_ror:8 row_mask:0xf bank_mask:0xf
    v_mfma_f32_32x32x16_bf16 v[176:191], a[168:171], a[64:67], v[176:191]
    ds_read_b64_tr_b16 a[164:165], v12 offset:12288
    ds_read_b64_tr_b16 a[166:167], v12 offset:12800
    s_waitcnt vmcnt(7)
    v_cmp_eq_u32 s[78:79], s43, v239
    v_addc_co_u32 v26, vcc, 0, v26, s[64:65]
    v_addc_co_u32 v26, vcc, 0, v26, s[66:67]
    v_addc_co_u32 v26, vcc, 0, v26, s[68:69]
    v_addc_co_u32 v26, vcc, 0, v26, s[70:71]
    v_mfma_f32_32x32x16_bf16 v[192:207], a[172:175], a[64:67], v[192:207]
    ds_read_b64_tr_b16 a[168:169], v13 offset:4096
    ds_read_b64_tr_b16 a[170:171], v13 offset:4608
    v_addc_co_u32 v26, vcc, 0, v26, s[72:73]
    v_addc_co_u32 v26, vcc, 0, v26, s[74:75]
    v_addc_co_u32 v26, vcc, 0, v26, s[76:77]
    v_addc_co_u32 v26, vcc, 0, v26, s[78:79]
    v_cmp_ne_u32 vcc, v26, v25
    buffer_load_dwordx4 a[220:223], v2, s[8:11], s54 offen offset:2048 sc1
    s_waitcnt lgkmcnt(6)
    v_mfma_f32_32x32x16_bf16 v[144:159], a[176:179], a[68:71], v[144:159]
    ds_read_b64_tr_b16 a[172:173], v13 offset:12288
    ds_read_b64_tr_b16 a[174:175], v13 offset:12800
    s_cbranch_vccnz K1Q_retry
K1Q_back:
    v_fma_f32 v208, v52, v238, v236
    v_fmac_f32_dpp v208, v238, v53 row_ror:8 row_mask:0xf bank_mask:0xf
    v_fma_f32 v209, v52, v208, v234
    v_mfma_f32_32x32x16_bf16 v[160:175], a[180:183], a[68:71], v[160:175]
    ds_read_b64_tr_b16 a[176:177], v12 offset:6144
    ds_read_b64_tr_b16 a[178:179], v12 offset:6656
    v_fmac_f32_dpp v209, v208, v53 row_ror:8 row_mask:0xf bank_mask:0xf
    v_fma_f32 v208, v52, v209, v232
    s_nop 0
    v_fmac_f32_dpp v208, v209, v53 row_ror:8 row_mask:0xf bank_mask:0xf
    v_fma_f32 v209, v52, v208, v230
    s_nop 0
    v_fmac_f32_dpp v209, v208, v53 row_ror:8 row_mask:0xf bank_mask:0xf
    buffer_load_dwordx4 a[224:227], v2, s[8:11], s54 offen offset:3072 sc1
    v_mfma_f32_32x32x16_bf16 v[176:191], a[184:187], a[68:71], v[176:191]
    ds_read_b64_tr_b16 a[180:181], v12 offset:14336
    ds_read_b64_tr_b16 a[182:183], v12 offset:14848
    v_fma_f32 v208, v52, v209, v228
    v_fmac_f32_dpp v208, v209, v53 row_ror:8 row_mask:0xf bank_mask:0xf
    v_fma_f32 v209, v52, v208, v226
    s_nop 0
    v_fmac_f32_dpp v209, v208, v53 row_ror:8 row_mask:0xf bank_mask:0xf
    v_fma_f32 v208, v52, v209, v224
    v_mfma_f32_32x32x16_bf16 v[192:207], a[188:191], a[68:71], v[192:207]
    ds_read_b64_tr_b16 a[184:185], v13 offset:6144
    ds_read_b64_tr_b16 a[186:187], v13 offset:6656
    v_fmac_f32_dpp v208, v209, v53 row_ror:8 row_mask:0xf bank_mask:0xf
    v_mov_b32 v210, v208
    s_nop 1
    v_permlane32_swap_b32 v208, v210
    v_fma_f32 v240, v50, v210, v208
    s_nop 0
    v_fmac_f32_dpp v240, v210, v51 row_ror:8 row_mask:0xf bank_mask:0xf
    buffer_load_dwordx4 a[228:231], v3, s[8:11], s54 offen offset:0 sc1
    s_waitcnt lgkmcnt(6)
    v_mfma_f32_32x32x16_bf16 v[144:159], a[160:163], a[72:75], v[144:159]
    ds_read_b64_tr_b16 a[188:189], v13 offset:14336
    ds_read_b64_tr_b16 a[190:191], v13 offset:14848
    v_fma_f32 v241, v48, v240, v216
    v_fmac_f32_dpp v241, v240, v49 row_ror:8 row_mask:0xf bank_mask:0xf
    v_fma_f32 v242, v48, v241, v217
    s_nop 0
    v_fmac_f32_dpp v242, v241, v49 row_ror:8 row_mask:0xf bank_mask:0xf
    v_mfma_f32_32x32x16_bf16 v[160:175], a[164:167], a[72:75], v[160:175]
    s_barrier
    ds_read_b64_tr_b16 a[160:161], v12 offset:20480
    ds_read_b64_tr_b16 a[162:163], v12 offset:20992
    v_fma_f32 v243, v48, v242, v218
    v_fmac_f32_dpp v243, v242, v49 row_ror:8 row_mask:0xf bank_mask:0xf
    v_fma_f32 v244, v48, v243, v219
    s_add_u32 s54, s50, 10240
    buffer_load_dwordx4 a[232:235], v2, s[8:11], s54 offen offset:0 sc1
    v_mfma_f32_32x32x16_bf16 v[176:191], a[168:171], a[72:75], v[176:191]
    ds_read_b64_tr_b16 a[164:165], v12 offset:28672
    ds_read_b64_tr_b16 a[166:167], v12 offset:29184
    v_fmac_f32_dpp v244, v243, v49 row_ror:8 row_mask:0xf bank_mask:0xf
    v_fma_f32 v245, v48, v244, v220
    s_nop 0
    v_fmac_f32_dpp v245, v244, v49 row_ror:8 row_mask:0xf bank_mask:0xf
    v_fma_f32 v246, v48, v245, v221
    s_nop 0
    v_fmac_f32_dpp v246, v245, v49 row_ror:8 row_mask:0xf bank_mask:0xf
    v_mfma_f32_32x32x16_bf16 v[192:207], a[172:175], a[72:75], v[192:207]
    ds_read_b64_tr_b16 a[168:169], v13 offset:20480
    ds_read_b64_tr_b16 a[170:171], v13 offset:20992
    v_fma_f32 v247, v48, v246, v222
    v_fmac_f32_dpp v247, v246, v49 row_ror:8 row_mask:0xf bank_mask:0xf
    ds_write_b128 v19, v[240:243] offset:4096
    ds_write_b128 v19, v[244:247] offset:4112
    s_waitcnt lgkmcnt(0)
    buffer_load_dwordx4 a[236:239], v2, s[8:11], s54 offen offset:1024 sc1
    v_mfma_f32_32x32x16_bf16 v[144:159], a[176:179], a[76:79], v[144:159]
    ds_read_b64_tr_b16 a[172:173], v13 offset:28672
    ds_read_b64_tr_b16 a[174:175], v13 offset:29184
    s_barrier
    v_fmac_f32_dpp v126, v127, v47 row_ror:8 row_mask:0xf bank_mask:0xf
    v_mfma_f32_32x32x16_bf16 v[160:175], a[180:183], a[76:79], v[160:175]
    ds_read_b64_tr_b16 a[176:177], v12 offset:22528
    ds_read_b64_tr_b16 a[178:179], v12 offset:23040
    ds_read_b32 v208, v18 offset:4096
    ds_read_b32 v209, v18 offset:5120
    ds_read_b32 v210, v18 offset:6144
    ds_read_b32 v211, v18 offset:7168
    buffer_load_dwordx4 a[240:243], v2, s[8:11], s54 offen offset:2048 sc1
    v_mfma_f32_32x32x16_bf16 v[176:191], a[184:187], a[76:79], v[176:191]
    ds_read_b64_tr_b16 a[180:181], v12 offset:30720
    ds_read_b64_tr_b16 a[182:183], v12 offset:31232
    s_waitcnt lgkmcnt(5)
    v_fmac_f32 v212, v32, v208
    s_waitcnt lgkmcnt(4)
    v_fmac_f32 v213, v36, v209
    s_waitcnt lgkmcnt(3)
    v_fmac_f32 v214, v40, v210
    s_waitcnt lgkmcnt(2)
    v_fmac_f32 v215, v44, v211
    v_fmac_f32_dpp v212, v208, v33 row_ror:8 row_mask:0xf bank_mask:0xf
    v_fmac_f32_dpp v213, v209, v37 row_ror:8 row_mask:0xf bank_mask:0xf
    v_fmac_f32_dpp v214, v210, v41 row_ror:8 row_mask:0xf bank_mask:0xf
    v_fmac_f32_dpp v215, v211, v45 row_ror:8 row_mask:0xf bank_mask:0xf
    v_fmac_f32 v64, v32, v212
    v_fmac_f32 v80, v36, v213
    v_mfma_f32_32x32x16_bf16 v[192:207], a[188:191], a[76:79], v[192:207]
    ds_read_b64_tr_b16 a[184:185], v13 offset:22528
    ds_read_b64_tr_b16 a[186:187], v13 offset:23040
    v_fmac_f32 v96, v40, v214
    v_fmac_f32 v112, v44, v215
    v_fmac_f32_dpp v64, v212, v33 row_ror:8 row_mask:0xf bank_mask:0xf
    v_fmac_f32_dpp v80, v213, v37 row_ror:8 row_mask:0xf bank_mask:0xf
    v_fmac_f32_dpp v96, v214, v41 row_ror:8 row_mask:0xf bank_mask:0xf
    v_fmac_f32_dpp v112, v215, v45 row_ror:8 row_mask:0xf bank_mask:0xf
    v_fmac_f32 v65, v32, v64
    v_fmac_f32 v81, v36, v80
    v_fmac_f32 v97, v40, v96
    v_fmac_f32 v113, v44, v112
    buffer_load_dwordx4 a[244:247], v2, s[8:11], s54 offen offset:3072 sc1
    v_mfma_f32_32x32x16_bf16 v[144:159], a[160:163], a[80:83], v[144:159]
    ds_read_b64_tr_b16 a[188:189], v13 offset:30720
    ds_read_b64_tr_b16 a[190:191], v13 offset:31232
    v_fmac_f32_dpp v65, v64, v33 row_ror:8 row_mask:0xf bank_mask:0xf
    v_fmac_f32_dpp v81, v80, v37 row_ror:8 row_mask:0xf bank_mask:0xf
    v_fmac_f32_dpp v97, v96, v41 row_ror:8 row_mask:0xf bank_mask:0xf
    v_fmac_f32_dpp v113, v112, v45 row_ror:8 row_mask:0xf bank_mask:0xf
    v_fmac_f32 v66, v32, v65
    v_fmac_f32 v82, v36, v81
    v_fmac_f32 v98, v40, v97
    v_fmac_f32 v114, v44, v113
    v_fmac_f32_dpp v66, v65, v33 row_ror:8 row_mask:0xf bank_mask:0xf
    v_mfma_f32_32x32x16_bf16 v[160:175], a[164:167], a[80:83], v[160:175]
    ds_read_b64_tr_b16 a[160:161], v12 offset:24576
    ds_read_b64_tr_b16 a[162:163], v12 offset:25088
    v_fmac_f32_dpp v82, v81, v37 row_ror:8 row_mask:0xf bank_mask:0xf
    v_fmac_f32_dpp v98, v97, v41 row_ror:8 row_mask:0xf bank_mask:0xf
    v_fmac_f32_dpp v114, v113, v45 row_ror:8 row_mask:0xf bank_mask:0xf
    v_fmac_f32 v67, v32, v66
    v_fmac_f32 v83, v36, v82
    v_fmac_f32 v99, v40, v98
    v_fmac_f32 v115, v44, v114
    v_fmac_f32_dpp v67, v66, v33 row_ror:8 row_mask:0xf bank_mask:0xf
    v_fmac_f32_dpp v83, v82, v37 row_ror:8 row_mask:0xf bank_mask:0xf
    v_fmac_f32_dpp v99, v98, v41 row_ror:8 row_mask:0xf bank_mask:0xf
    buffer_load_dwordx4 a[248:251], v3, s[8:11], s54 offen offset:0 sc1
    v_mfma_f32_32x32x16_bf16 v[176:191], a[168:171], a[80:83], v[176:191]
    ds_read_b64_tr_b16 a[164:165], v12 offset:32768
    ds_read_b64_tr_b16 a[166:167], v12 offset:33280
    v_fmac_f32_dpp v115, v114, v45 row_ror:8 row_mask:0xf bank_mask:0xf
    v_fmac_f32 v68, v32, v67
    v_fmac_f32 v84, v36, v83
    v_fmac_f32 v100, v40, v99
    v_fmac_f32 v116, v44, v115
    v_fmac_f32_dpp v68, v67, v33 row_ror:8 row_mask:0xf bank_mask:0xf
    v_fmac_f32_dpp v84, v83, v37 row_ror:8 row_mask:0xf bank_mask:0xf
    v_fmac_f32_dpp v100, v99, v41 row_ror:8 row_mask:0xf bank_mask:0xf
    v_fmac_f32_dpp v116, v115, v45 row_ror:8 row_mask:0xf bank_mask:0xf
    v_fmac_f32 v69, v32, v68
    v_mfma_f32_32x32x16_bf16 v[192:207], a[172:175], a[80:83], v[192:207]
    ds_read_b64_tr_b16 a[168:169], v13 offset:24576
    ds_read_b64_tr_b16 a[170:171], v13 offset:25088
    v_fmac_f32 v85, v36, v84
    v_fmac_f32 v101, v40, v100
    v_fmac_f32 v117, v44, v116
    v_fmac_f32_dpp v69, v68, v33 row_ror:8 row_mask:0xf bank_mask:0xf
    v_fmac_f32_dpp v85, v84, v37 row_ror:8 row_mask:0xf bank_mask:0xf
    v_fmac_f32_dpp v101, v100, v41 row_ror:8 row_mask:0xf bank_mask:0xf
    v_fmac_f32_dpp v117, v116, v45 row_ror:8 row_mask:0xf bank_mask:0xf
    v_fmac_f32 v70, v32, v69
    v_fmac_f32 v86, v36, v85
    v_fmac_f32 v102, v40, v101
    s_add_u32 s54, s50, 15360
    buffer_load_dwordx4 a[252:255], v2, s[8:11], s54 offen offset:0 sc1
    s_waitcnt lgkmcnt(6)
    v_mfma_f32_32x32x16_bf16 v[144:159], a[176:179], a[84:87], v[144:159]
    ds_read_b64_tr_b16 a[172:173], v13 offset:32768
    ds_read_b64_tr_b16 a[174:175], v13 offset:33280
    v_fmac_f32 v118, v44, v117
    v_fmac_f32_dpp v70, v69, v33 row_ror:8 row_mask:0xf bank_mask:0xf
    v_fmac_f32_dpp v86, v85, v37 row_ror:8 row_mask:0xf bank_mask:0xf
    v_fmac_f32_dpp v102, v101, v41 row_ror:8 row_mask:0xf bank_mask:0xf
    v_fmac_f32_dpp v118, v117, v45 row_ror:8 row_mask:0xf bank_mask:0xf
    v_fmac_f32 v71, v32, v70
    v_fmac_f32 v87, v36, v86
    v_fmac_f32 v103, v40, v102
    v_fmac_f32 v119, v44, v118
    v_mfma_f32_32x32x16_bf16 v[160:175], a[180:183], a[84:87], v[160:175]
    ds_read_b64_tr_b16 a[176:177], v12 offset:26624
    ds_read_b64_tr_b16 a[178:179], v12 offset:27136
    v_fmac_f32_dpp v71, v70, v33 row_ror:8 row_mask:0xf bank_mask:0xf
    v_fmac_f32_dpp v87, v86, v37 row_ror:8 row_mask:0xf bank_mask:0xf
    v_fmac_f32_dpp v103, v102, v41 row_ror:8 row_mask:0xf bank_mask:0xf
    v_fmac_f32_dpp v119, v118, v45 row_ror:8 row_mask:0xf bank_mask:0xf
    v_fmac_f32 v72, v32, v71
    v_fmac_f32 v88, v36, v87
    v_fmac_f32 v104, v40, v103
    v_fmac_f32 v120, v44, v119
    v_fmac_f32_dpp v72, v71, v33 row_ror:8 row_mask:0xf bank_mask:0xf
    v_fmac_f32_dpp v88, v87, v37 row_ror:8 row_mask:0xf bank_mask:0xf
    buffer_load_dwordx4 a[0:3], v2, s[8:11], s54 offen offset:1024 sc1
    v_mfma_f32_32x32x16_bf16 v[176:191], a[184:187], a[84:87], v[176:191]
    ds_read_b64_tr_b16 a[180:181], v12 offset:34816
    ds_read_b64_tr_b16 a[182:183], v12 offset:35328
    v_fmac_f32_dpp v104, v103, v41 row_ror:8 row_mask:0xf bank_mask:0xf
    v_fmac_f32_dpp v120, v119, v45 row_ror:8 row_mask:0xf bank_mask:0xf
    v_fmac_f32 v73, v32, v72
    v_fmac_f32 v89, v36, v88
    v_fmac_f32 v105, v40, v104
    v_fmac_f32 v121, v44, v120
    v_fmac_f32_dpp v73, v72, v33 row_ror:8 row_mask:0xf bank_mask:0xf
    v_fmac_f32_dpp v89, v88, v37 row_ror:8 row_mask:0xf bank_mask:0xf
    v_fmac_f32_dpp v105, v104, v41 row_ror:8 row_mask:0xf bank_mask:0xf
    v_fmac_f32_dpp v121, v120, v45 row_ror:8 row_mask:0xf bank_mask:0xf
    v_mfma_f32_32x32x16_bf16 v[192:207], a[188:191], a[84:87], v[192:207]
    ds_read_b64_tr_b16 a[184:185], v13 offset:26624
    ds_read_b64_tr_b16 a[186:187], v13 offset:27136
    v_fmac_f32 v74, v32, v73
    v_fmac_f32 v90, v36, v89
    v_fmac_f32 v106, v40, v105
    v_fmac_f32 v122, v44, v121
    v_fmac_f32_dpp v74, v73, v33 row_ror:8 row_mask:0xf bank_mask:0xf
    v_fmac_f32_dpp v90, v89, v37 row_ror:8 row_mask:0xf bank_mask:0xf
    v_fmac_f32_dpp v106, v105, v41 row_ror:8 row_mask:0xf bank_mask:0xf
    v_fmac_f32_dpp v122, v121, v45 row_ror:8 row_mask:0xf bank_mask:0xf
    v_fmac_f32 v75, v32, v74
    v_fmac_f32 v91, v36, v90
    buffer_load_dwordx4 a[4:7], v2, s[8:11], s54 offen offset:2048 sc1
    s_waitcnt lgkmcnt(6)
    v_mfma_f32_32x32x16_bf16 v[144:159], a[160:163], a[88:91], v[144:159]
    ds_read_b64_tr_b16 a[188:189], v13 offset:34816
    ds_read_b64_tr_b16 a[190:191], v13 offset:35328
    v_fmac_f32 v107, v40, v106
    v_fmac_f32 v123, v44, v122
    v_fmac_f32_dpp v75, v74, v33 row_ror:8 row_mask:0xf bank_mask:0xf
    v_fmac_f32_dpp v91, v90, v37 row_ror:8 row_mask:0xf bank_mask:0xf
    v_fmac_f32_dpp v107, v106, v41 row_ror:8 row_mask:0xf bank_mask:0xf
    v_fmac_f32_dpp v123, v122, v45 row_ror:8 row_mask:0xf bank_mask:0xf
    v_fmac_f32 v76, v32, v75
    v_fmac_f32 v92, v36, v91
    v_fmac_f32 v108, v40, v107
    v_mfma_f32_32x32x16_bf16 v[160:175], a[164:167], a[88:91], v[160:175]
    s_barrier
    ds_read_b64_tr_b16 a[160:161], v12 offset:40960
    ds_read_b64_tr_b16 a[162:163], v12 offset:41472
    v_fmac_f32 v124, v44, v123
    v_fmac_f32_dpp v76, v75, v33 row_ror:8 row_mask:0xf bank_mask:0xf
    v_fmac_f32_dpp v92, v91, v37 row_ror:8 row_mask:0xf bank_mask:0xf
    v_fmac_f32_dpp v108, v107, v41 row_ror:8 row_mask:0xf bank_mask:0xf
    v_fmac_f32_dpp v124, v123, v45 row_ror:8 row_mask:0xf bank_mask:0xf
    v_fmac_f32 v77, v32, v76
    v_fmac_f32 v93, v36, v92
    v_fmac_f32 v109, v40, v108
    buffer_load_dwordx4 a[8:11], v2, s[8:11], s54 offen offset:3072 sc1
    v_mfma_f32_32x32x16_bf16 v[176:191], a[168:171], a[88:91], v[176:191]
    ds_read_b64_tr_b16 a[164:165], v12 offset:49152
    ds_read_b64_tr_b16 a[166:167], v12 offset:49664
    v_fmac_f32 v125, v44, v124
    v_fmac_f32_dpp v77, v76, v33 row_ror:8 row_mask:0xf bank_mask:0xf
    v_fmac_f32_dpp v93, v92, v37 row_ror:8 row_mask:0xf bank_mask:0xf
    v_fmac_f32_dpp v109, v108, v41 row_ror:8 row_mask:0xf bank_mask:0xf
    v_fmac_f32_dpp v125, v124, v45 row_ror:8 row_mask:0xf bank_mask:0xf
    v_fmac_f32 v78, v32, v77
    v_fmac_f32 v94, v36, v93
    v_fmac_f32 v110, v40, v109
    v_fmac_f32 v126, v44, v125
    v_fmac_f32_dpp v78, v77, v33 row_ror:8 row_mask:0xf bank_mask:0xf
    v_mfma_f32_32x32x16_bf16 v[192:207], a[172:175], a[88:91], v[192:207]
    ds_read_b64_tr_b16 a[168:169], v13 offset:40960
    ds_read_b64_tr_b16 a[170:171], v13 offset:41472
    v_fmac_f32_dpp v94, v93, v37 row_ror:8 row_mask:0xf bank_mask:0xf
    v_fmac_f32_dpp v110, v109, v41 row_ror:8 row_mask:0xf bank_mask:0xf
    v_fmac_f32_dpp v126, v125, v45 row_ror:8 row_mask:0xf bank_mask:0xf
    v_cvt_pk_bf16_f32 v216, v212, v64
    v_cvt_pk_bf16_f32 v217, v65, v66
    v_cvt_pk_bf16_f32 v218, v67, v68
    v_cvt_pk_bf16_f32 v219, v69, v70
    v_cvt_pk_bf16_f32 v220, v71, v72
    v_cvt_pk_bf16_f32 v221, v73, v74
    v_cvt_pk_bf16_f32 v222, v75, v76
    buffer_load_dwordx4 a[12:15], v3, s[8:11], s54 offen offset:0 sc1
    s_waitcnt lgkmcnt(6)
    v_mfma_f32_32x32x16_bf16 v[144:159], a[176:179], a[92:95], v[144:159]
    ds_read_b64_tr_b16 a[172:173], v13 offset:49152
    ds_read_b64_tr_b16 a[174:175], v13 offset:49664
    v_cvt_pk_bf16_f32 v223, v77, v78
    ds_write_b128 v20, v[216:219]
    ds_write_b128 v20, v[220:223] offset:16
    ds_read_b64_tr_b16 v[64:65], v21 offset:0
    ds_read_b64_tr_b16 v[66:67], v21 offset:320
    ds_read_b64_tr_b16 v[68:69], v21 offset:32
    ds_read_b64_tr_b16 v[70:71], v21 offset:352
    v_cvt_pk_bf16_f32 v224, v213, v80
    v_cvt_pk_bf16_f32 v225, v81, v82
    v_mfma_f32_32x32x16_bf16 v[160:175], a[180:183], a[92:95], v[160:175]
    ds_read_b64_tr_b16 a[176:177], v12 offset:43008
    ds_read_b64_tr_b16 a[178:179], v12 offset:43520
    v_cvt_pk_bf16_f32 v226, v83, v84
    v_cvt_pk_bf16_f32 v227, v85, v86
    v_cvt_pk_bf16_f32 v228, v87, v88
    v_cvt_pk_bf16_f32 v229, v89, v90
    v_cvt_pk_bf16_f32 v230, v91, v92
    v_cvt_pk_bf16_f32 v231, v93, v94
    ds_write_b128 v20, v[224:227]
    ds_write_b128 v20, v[228:231] offset:16
    ds_read_b64_tr_b16 v[80:81], v21 offset:0
    ds_read_b64_tr_b16 v[82:83], v21 offset:320
    s_add_u32 s54, s50, 20480
    buffer_load_dwordx4 a[16:19], v2, s[8:11], s54 offen offset:0 sc1
    v_mfma_f32_32x32x16_bf16 v[176:191], a[184:187], a[92:95], v[176:191]
    ds_read_b64_tr_b16 a[180:181], v12 offset:51200
    ds_read_b64_tr_b16 a[182:183], v12 offset:51712
    ds_read_b64_tr_b16 v[84:85], v21 offset:32
    ds_read_b64_tr_b16 v[86:87], v21 offset:352
    v_cvt_pk_bf16_f32 v216, v214, v96
    v_cvt_pk_bf16_f32 v217, v97, v98
    v_cvt_pk_bf16_f32 v218, v99, v100
    v_cvt_pk_bf16_f32 v219, v101, v102
    v_cvt_pk_bf16_f32 v220, v103, v104
    v_cvt_pk_bf16_f32 v221, v105, v106
    v_cvt_pk_bf16_f32 v222, v107, v108
    v_cvt_pk_bf16_f32 v223, v109, v110
    v_mfma_f32_32x32x16_bf16 v[192:207], a[188:191], a[92:95], v[192:207]
    ds_read_b64_tr_b16 a[184:185], v13 offset:43008
    ds_read_b64_tr_b16 a[186:187], v13 offset:43520
    ds_write_b128 v20, v[216:219]
    ds_write_b128 v20, v[220:223] offset:16
    ds_read_b64_tr_b16 v[96:97], v21 offset:0
    ds_read_b64_tr_b16 v[98:99], v21 offset:320
    ds_read_b64_tr_b16 v[100:101], v21 offset:32
    ds_read_b64_tr_b16 v[102:103], v21 offset:352
    v_cvt_pk_bf16_f32 v224, v215, v112
    v_cvt_pk_bf16_f32 v225, v113, v114
    v_cvt_pk_bf16_f32 v226, v115, v116
    v_cvt_pk_bf16_f32 v227, v117, v118
    buffer_load_dwordx4 a[20:23], v2, s[8:11], s54 offen offset:1024 sc1
    s_waitcnt lgkmcnt(15)
    v_mfma_f32_32x32x16_bf16 v[144:159], a[160:163], a[96:99], v[144:159]
    ds_read_b64_tr_b16 a[188:189], v13 offset:51200
    ds_read_b64_tr_b16 a[190:191], v13 offset:51712
    v_cvt_pk_bf16_f32 v228, v119, v120
    v_cvt_pk_bf16_f32 v229, v121, v122
    v_cvt_pk_bf16_f32 v230, v123, v124
    v_cvt_pk_bf16_f32 v231, v125, v126
    ds_write_b128 v20, v[224:227]
    ds_write_b128 v20, v[228:231] offset:16
    ds_read_b64_tr_b16 v[112:113], v21 offset:0
    ds_read_b64_tr_b16 v[114:115], v21 offset:320
    ds_read_b64_tr_b16 v[116:117], v21 offset:32
    v_mfma_f32_32x32x16_bf16 v[160:175], a[164:167], a[96:99], v[160:175]
    ds_read_b64_tr_b16 a[160:161], v12 offset:45056
    ds_read_b64_tr_b16 a[162:163], v12 offset:45568
    ds_read_b64_tr_b16 v[118:119], v21 offset:352
    s_add_u32 s6, s41, 0
    s_lshr_b32 s7, s6, 1
    s_lshl_b32 s7, s7, 12
    s_and_b32 s6, s6, 1
    s_lshl_b32 s6, s6, 9
    s_add_u32 s6, s6, s7
    s_add_u32 s6, s6, s40
    buffer_store_dwordx4 v[64:67], v22, s[8:11], s6 offen offset:0 sc1
    v_mfma_f32_32x32x16_bf16 v[176:191], a[168:171], a[96:99], v[176:191]
    ds_read_b64_tr_b16 a[164:165], v12 offset:53248
    ds_read_b64_tr_b16 a[166:167], v12 offset:53760
    v_mfma_f32_32x32x16_bf16 v[192:207], a[172:175], a[96:99], v[192:207]
    ds_read_b64_tr_b16 a[168:169], v13 offset:45056
    ds_read_b64_tr_b16 a[170:171], v13 offset:45568
    buffer_store_dwordx4 v[68:71], v22, s[8:11], s6 offen offset:1024 sc1
    s_add_u32 s6, s41, 1
    s_lshr_b32 s7, s6, 1
    s_lshl_b32 s7, s7, 12
    s_waitcnt lgkmcnt(12)
    v_mfma_f32_32x32x16_bf16 v[144:159], a[176:179], a[100:103], v[144:159]
    ds_read_b64_tr_b16 a[172:173], v13 offset:53248
    ds_read_b64_tr_b16 a[174:175], v13 offset:53760
    s_and_b32 s6, s6, 1
    s_lshl_b32 s6, s6, 9
    s_add_u32 s6, s6, s7
    v_mfma_f32_32x32x16_bf16 v[160:175], a[180:183], a[100:103], v[160:175]
    ds_read_b64_tr_b16 a[176:177], v12 offset:47104
    ds_read_b64_tr_b16 a[178:179], v12 offset:47616
    s_add_u32 s6, s6, s40
    buffer_store_dwordx4 v[80:83], v22, s[8:11], s6 offen offset:0 sc1
    v_mfma_f32_32x32x16_bf16 v[176:191], a[184:187], a[100:103], v[176:191]
    ds_read_b64_tr_b16 a[180:181], v12 offset:55296
    ds_read_b64_tr_b16 a[182:183], v12 offset:55808
    v_mfma_f32_32x32x16_bf16 v[192:207], a[188:191], a[100:103], v[192:207]
    ds_read_b64_tr_b16 a[184:185], v13 offset:47104
    ds_read_b64_tr_b16 a[186:187], v13 offset:47616
    buffer_store_dwordx4 v[84:87], v22, s[8:11], s6 offen offset:1024 sc1
    s_add_u32 s6, s41, 2
    s_lshr_b32 s7, s6, 1
    s_lshl_b32 s7, s7, 12
    s_waitcnt lgkmcnt(6)
    v_mfma_f32_32x32x16_bf16 v[144:159], a[160:163], a[104:107], v[144:159]
    ds_read_b64_tr_b16 a[188:189], v13 offset:55296
    ds_read_b64_tr_b16 a[190:191], v13 offset:55808
    s_and_b32 s6, s6, 1
    s_lshl_b32 s6, s6, 9
    s_add_u32 s6, s6, s7
    v_mfma_f32_32x32x16_bf16 v[160:175], a[164:167], a[104:107], v[160:175]
    s_barrier
    ds_read_b64_tr_b16 a[160:161], v12 offset:61440
    ds_read_b64_tr_b16 a[162:163], v12 offset:61952
    s_add_u32 s6, s6, s40
    buffer_store_dwordx4 v[96:99], v22, s[8:11], s6 offen offset:0 sc1
    v_mfma_f32_32x32x16_bf16 v[176:191], a[168:171], a[104:107], v[176:191]
    v_add_u32 v12, 0xf000, v12
    ds_read_b64_tr_b16 a[164:165], v12 offset:8192
    ds_read_b64_tr_b16 a[166:167], v12 offset:8704
    v_mfma_f32_32x32x16_bf16 v[192:207], a[172:175], a[104:107], v[192:207]
    ds_read_b64_tr_b16 a[168:169], v13 offset:61440
    ds_read_b64_tr_b16 a[170:171], v13 offset:61952
    buffer_store_dwordx4 v[100:103], v22, s[8:11], s6 offen offset:1024 sc1
    s_add_u32 s6, s41, 3
    s_lshr_b32 s7, s6, 1
    s_lshl_b32 s7, s7, 12
    s_waitcnt lgkmcnt(6)
    v_mfma_f32_32x32x16_bf16 v[144:159], a[176:179], a[108:111], v[144:159]
    v_add_u32 v13, 0xf000, v13
    ds_read_b64_tr_b16 a[172:173], v13 offset:8192
    ds_read_b64_tr_b16 a[174:175], v13 offset:8704
    s_and_b32 s6, s6, 1
    s_lshl_b32 s6, s6, 9
    v_mfma_f32_32x32x16_bf16 v[160:175], a[180:183], a[108:111], v[160:175]
    ds_read_b64_tr_b16 a[176:177], v12 offset:2048
    ds_read_b64_tr_b16 a[178:179], v12 offset:2560
    s_add_u32 s6, s6, s7
    s_add_u32 s6, s6, s40
    buffer_store_dwordx4 v[112:115], v22, s[8:11], s6 offen offset:0 sc1
    v_mfma_f32_32x32x16_bf16 v[176:191], a[184:187], a[108:111], v[176:191]
    ds_read_b64_tr_b16 a[180:181], v12 offset:10240
    ds_read_b64_tr_b16 a[182:183], v12 offset:10752
    v_mfma_f32_32x32x16_bf16 v[192:207], a[188:191], a[108:111], v[192:207]
    ds_read_b64_tr_b16 a[184:185], v13 offset:2048
    ds_read_b64_tr_b16 a[186:187], v13 offset:2560
    buffer_store_dwordx4 v[116:119], v22, s[8:11], s6 offen offset:1024 sc1
    s_add_u32 s37, s3, 0
    s_and_b32 s37, s37, 3
    s_lshl_b32 s37, s37, 10
    s_waitcnt lgkmcnt(6)
    v_mfma_f32_32x32x16_bf16 v[144:159], a[160:163], a[112:115], v[144:159]
    ds_read_b64_tr_b16 a[188:189], v13 offset:10240
    ds_read_b64_tr_b16 a[190:191], v13 offset:10752
    v_add_u32 v4, s37, v2
    s_add_u32 s37, s3, 1
    s_and_b32 s37, s37, 3
    v_mfma_f32_32x32x16_bf16 v[160:175], a[164:167], a[112:115], v[160:175]
    ds_read_b64_tr_b16 a[160:161], v12 offset:4096
    ds_read_b64_tr_b16 a[162:163], v12 offset:4608
    s_lshl_b32 s37, s37, 10
    v_add_u32 v5, s37, v2
    s_add_u32 s37, s3, 2
    s_and_b32 s37, s37, 3
    buffer_load_dwordx4 a[24:27], v2, s[8:11], s54 offen offset:2048 sc1
    v_mfma_f32_32x32x16_bf16 v[176:191], a[168:171], a[112:115], v[176:191]
    ds_read_b64_tr_b16 a[164:165], v12 offset:12288
    ds_read_b64_tr_b16 a[166:167], v12 offset:12800
    s_lshl_b32 s37, s37, 10
    v_add_u32 v6, s37, v2
    s_add_u32 s37, s3, 3
    s_and_b32 s37, s37, 3
    v_mfma_f32_32x32x16_bf16 v[192:207], a[172:175], a[112:115], v[192:207]
    ds_read_b64_tr_b16 a[168:169], v13 offset:4096
    ds_read_b64_tr_b16 a[170:171], v13 offset:4608
    s_lshl_b32 s37, s37, 10
    v_add_u32 v7, s37, v2
    s_mov_b32 s12, s30
    s_mov_b32 s13, s31
    buffer_load_dwordx4 a[28:31], v2, s[8:11], s54 offen offset:3072 sc1
    s_waitcnt lgkmcnt(6)
    v_mfma_f32_32x32x16_bf16 v[144:159], a[176:179], a[116:119], v[144:159]
    ds_read_b64_tr_b16 a[172:173], v13 offset:12288
    ds_read_b64_tr_b16 a[174:175], v13 offset:12800
    s_mov_b32 s14, 0x500000
    s_mov_b32 s15, 0x20000
    s_and_b32 s37, s3, 1
    v_mfma_f32_32x32x16_bf16 v[160:175], a[180:183], a[116:119], v[160:175]
    ds_read_b64_tr_b16 a[176:177], v12 offset:6144
    ds_read_b64_tr_b16 a[178:179], v12 offset:6656
    s_lshl_b32 s37, s37, 6
    s_add_u32 s37, s37, s60
    s_add_u32 s32, s4, s37
    s_addc_u32 s33, s5, 0
    buffer_load_dwordx4 a[32:35], v3, s[8:11], s54 offen offset:0 sc1
    v_mfma_f32_32x32x16_bf16 v[176:191], a[184:187], a[116:119], v[176:191]
    ds_read_b64_tr_b16 a[180:181], v12 offset:14336
    ds_read_b64_tr_b16 a[182:183], v12 offset:14848
    s_lshl_b32 s37, s3, 5
    s_add_u32 s37, s37, s60
    s_add_u32 s37, s37, 128
    s_add_u32 s34, s4, s37
    s_addc_u32 s35, s5, 0
    v_mfma_f32_32x32x16_bf16 v[192:207], a[188:191], a[116:119], v[192:207]
    ds_read_b64_tr_b16 a[184:185], v13 offset:6144
    ds_read_b64_tr_b16 a[186:187], v13 offset:6656
    s_mov_b32 s28, s43
    s_mov_b32 s29, s43
    v_and_b32 v62, 15, v1
    v_mul_u32_u24 v20, 640, v62
    s_add_u32 s54, s50, 25600
    buffer_load_dwordx4 a[36:39], v2, s[8:11], s54 offen offset:0 sc1
    s_waitcnt lgkmcnt(6)
    v_mfma_f32_32x32x16_bf16 v[144:159], a[160:163], a[120:123], v[144:159]
    ds_read_b64_tr_b16 a[188:189], v13 offset:14336
    ds_read_b64_tr_b16 a[190:191], v13 offset:14848
    s_waitcnt vmcnt(4)
    v_mov_b32 v61, s43
    buffer_store_dword v61, v27, s[8:11], s61 offen offset:0 sc1
    v_mfma_f32_32x32x16_bf16 v[160:175], a[164:167], a[120:123], v[160:175]
    s_barrier
    ds_read_b64_tr_b16 a[160:161], v12 offset:20480
    ds_read_b64_tr_b16 a[162:163], v12 offset:20992
    v_lshrrev_b32 v63, 4, v1
    v_lshlrev_b32 v11, 2, v63
    buffer_load_dwordx4 a[40:43], v2, s[8:11], s54 offen offset:1024 sc1
    v_mfma_f32_32x32x16_bf16 v[176:191], a[168:171], a[120:123], v[176:191]
    ds_read_b64_tr_b16 a[164:165], v12 offset:28672
    ds_read_b64_tr_b16 a[166:167], v12 offset:29184
    s_lshl_b32 s37, s48, 2
    s_add_u32 s37, s37, s3
    s_mul_i32 s56, s37, 10240
    s_mul_i32 s37, s49, 80
    v_mfma_f32_32x32x16_bf16 v[192:207], a[172:175], a[120:123], v[192:207]
    ds_read_b64_tr_b16 a[168:169], v13 offset:20480
    ds_read_b64_tr_b16 a[170:171], v13 offset:20992
    s_add_u32 s56, s56, s37
    v_add3_u32 v20, v20, v11, s56
    v_lshlrev_b32 v20, 2, v20
    s_lshl_b32 s56, s56, 1
    buffer_load_dwordx4 a[44:47], v2, s[8:11], s54 offen offset:2048 sc1
    s_waitcnt lgkmcnt(6)
    v_mfma_f32_32x32x16_bf16 v[144:159], a[176:179], a[124:127], v[144:159]
    ds_read_b64_tr_b16 a[172:173], v13 offset:28672
    ds_read_b64_tr_b16 a[174:175], v13 offset:29184
    s_mul_i32 s58, s3, 5120
    s_add_u32 s58, s58, 122880
    v_mul_u32_u24 v18, 160, v62
    v_mfma_f32_32x32x16_bf16 v[160:175], a[180:183], a[124:127], v[160:175]
    ds_read_b64_tr_b16 a[176:177], v12 offset:22528
    ds_read_b64_tr_b16 a[178:179], v12 offset:23040
    v_lshlrev_b32 v11, 3, v63
    v_add_u32 v21, 143360, v11
    v_add3_u32 v18, v18, v11, s58
    v_lshlrev_b32 v19, 4, v62
    buffer_load_dwordx4 a[48:51], v2, s[8:11], s54 offen offset:3072 sc1
    v_mfma_f32_32x32x16_bf16 v[176:191], a[184:187], a[124:127], v[176:191]
    ds_read_b64_tr_b16 a[180:181], v12 offset:30720
    ds_read_b64_tr_b16 a[182:183], v12 offset:31232
    v_lshrrev_b32 v11, 1, v63
    v_lshlrev_b32 v11, 8, v11
    v_and_b32 v26, 1, v63
    v_lshlrev_b32 v26, 3, v26
    v_mfma_f32_32x32x16_bf16 v[192:207], a[188:191], a[124:127], v[192:207]
    ds_read_b64_tr_b16 a[184:185], v13 offset:22528
    ds_read_b64_tr_b16 a[186:187], v13 offset:23040
    v_add3_u32 v19, v19, v11, v26
    v_add_u32 v19, s58, v19
    v_add_u32 v11, 0, v1
    v_mul_u32_u24 v26, 205, v11
    buffer_load_dwordx4 a[52:55], v3, s[8:11], s54 offen offset:0 sc1
    s_waitcnt lgkmcnt(6)
    v_mfma_f32_32x32x16_bf16 v[144:159], a[160:163], a[128:131], v[144:159]
    ds_read_b64_tr_b16 a[188:189], v13 offset:30720
    ds_read_b64_tr_b16 a[190:191], v13 offset:31232
    v_lshrrev_b32 v26, 11, v26
    v_mul_u32_u24 v26, 1120, v26
    v_lshlrev_b32 v11, 4, v11
    v_mfma_f32_32x32x16_bf16 v[160:175], a[164:167], a[128:131], v[160:175]
    ds_read_b64_tr_b16 a[160:161], v12 offset:24576
    ds_read_b64_tr_b16 a[162:163], v12 offset:25088
    v_add_u32 v8, v11, v26
    v_add_u32 v11, 64, v1
    v_mul_u32_u24 v26, 205, v11
    v_lshrrev_b32 v26, 11, v26
    s_add_u32 s54, s50, 30720
    buffer_load_dwordx4 a[56:59], v2, s[8:11], s54 offen offset:0 sc1
    v_mfma_f32_32x32x16_bf16 v[176:191], a[168:171], a[128:131], v[176:191]
    ds_read_b64_tr_b16 a[164:165], v12 offset:32768
    ds_read_b64_tr_b16 a[166:167], v12 offset:33280
    v_mul_u32_u24 v26, 1120, v26
    v_lshlrev_b32 v11, 4, v11
    v_add_u32 v9, v11, v26
    v_subrev_u32 v9, 1024, v9
    v_mfma_f32_32x32x16_bf16 v[192:207], a[172:175], a[128:131], v[192:207]
    ds_read_b64_tr_b16 a[168:169], v13 offset:24576
    ds_read_b64_tr_b16 a[170:171], v13 offset:25088
    v_add_u32 v11, 128, v1
    v_mul_u32_u24 v26, 205, v11
    v_lshrrev_b32 v26, 11, v26
    v_mul_u32_u24 v26, 1120, v26
    buffer_load_dwordx4 a[60:63], v2, s[8:11], s54 offen offset:1024 sc1
    s_waitcnt lgkmcnt(6)
    v_mfma_f32_32x32x16_bf16 v[144:159], a[176:179], a[132:135], v[144:159]
    ds_read_b64_tr_b16 a[172:173], v13 offset:32768
    ds_read_b64_tr_b16 a[174:175], v13 offset:33280
    v_lshlrev_b32 v11, 4, v11
    v_add_u32 v10, v11, v26
    v_subrev_u32 v10, 2048, v10
    v_mfma_f32_32x32x16_bf16 v[160:175], a[180:183], a[132:135], v[160:175]
    ds_read_b64_tr_b16 a[176:177], v12 offset:26624
    ds_read_b64_tr_b16 a[178:179], v12 offset:27136
    v_and_b32 v11, 15, v1
    v_lshrrev_b32 v26, 2, v11
    v_lshlrev_b32 v26, 3, v26
    v_and_b32 v11, 3, v11
    buffer_load_dwordx4 a[64:67], v2, s[8:11], s54 offen offset:2048 sc1
    v_mfma_f32_32x32x16_bf16 v[176:191], a[184:187], a[132:135], v[176:191]
    ds_read_b64_tr_b16 a[180:181], v12 offset:34816
    ds_read_b64_tr_b16 a[182:183], v12 offset:35328
    v_add_u32 v26, v26, v11
    s_and_b32 s37, s3, 1
    s_lshl_b32 s37, s37, 2
    v_add_u32 v26, s37, v26
    v_mfma_f32_32x32x16_bf16 v[192:207], a[188:191], a[132:135], v[192:207]
    ds_read_b64_tr_b16 a[184:185], v13 offset:26624
    ds_read_b64_tr_b16 a[186:187], v13 offset:27136
    v_lshlrev_b32 v26, 4, v26
    v_lshrrev_b32 v11, 4, v1
    v_lshlrev_b32 v11, 9, v11
    v_add_u32 v11, v11, v26
    buffer_load_dwordx4 a[68:71], v2, s[8:11], s54 offen offset:3072 sc1
    s_waitcnt lgkmcnt(6)
    v_mfma_f32_32x32x16_bf16 v[144:159], a[160:163], a[136:139], v[144:159]
    ds_read_b64_tr_b16 a[188:189], v13 offset:34816
    ds_read_b64_tr_b16 a[190:191], v13 offset:35328
    s_lshl_b32 s57, s48, 1
    s_lshr_b32 s37, s3, 1
    s_add_u32 s57, s57, s37
    v_mfma_f32_32x32x16_bf16 v[160:175], a[164:167], a[136:139], v[160:175]
    s_barrier
    ds_read_b64_tr_b16 a[160:161], v12 offset:40960
    ds_read_b64_tr_b16 a[162:163], v12 offset:41472
    s_mul_i32 s57, s57, 40960
    s_mul_i32 s37, s49, 5120
    buffer_load_dwordx4 a[72:75], v3, s[8:11], s54 offen offset:0 sc1
    v_mfma_f32_32x32x16_bf16 v[176:191], a[168:171], a[136:139], v[176:191]
    ds_read_b64_tr_b16 a[164:165], v12 offset:49152
    ds_read_b64_tr_b16 a[166:167], v12 offset:49664
    s_add_u32 s57, s57, s37
    s_mul_i32 s59, s49, 160
    s_add_u32 s37, s3, 1
    s_and_b32 s37, s37, 3
    v_mfma_f32_32x32x16_bf16 v[192:207], a[172:175], a[136:139], v[192:207]
    ds_read_b64_tr_b16 a[168:169], v13 offset:40960
    ds_read_b64_tr_b16 a[170:171], v13 offset:41472
    s_mul_i32 s37, s37, 15360
    s_add_u32 s37, s37, 0
    v_add_u32 v14, s37, v2
    s_add_u32 s37, s3, 2
    s_add_u32 s54, s50, 35840
    buffer_load_dwordx4 a[76:79], v2, s[8:11], s54 offen offset:0 sc1
    s_waitcnt lgkmcnt(6)
    v_mfma_f32_32x32x16_bf16 v[144:159], a[176:179], a[140:143], v[144:159]
    ds_read_b64_tr_b16 a[172:173], v13 offset:49152
    ds_read_b64_tr_b16 a[174:175], v13 offset:49664
    s_and_b32 s37, s37, 3
    s_mul_i32 s37, s37, 15360
    s_add_u32 s37, s37, 5120
    v_mfma_f32_32x32x16_bf16 v[160:175], a[180:183], a[140:143], v[160:175]
    ds_read_b64_tr_b16 a[176:177], v12 offset:43008
    ds_read_b64_tr_b16 a[178:179], v12 offset:43520
    v_add_u32 v15, s37, v2
    s_add_u32 s37, s3, 3
    s_and_b32 s37, s37, 3
    s_mul_i32 s37, s37, 15360
    buffer_load_dwordx4 a[80:83], v2, s[8:11], s54 offen offset:1024 sc1
    v_mfma_f32_32x32x16_bf16 v[176:191], a[184:187], a[140:143], v[176:191]
    ds_read_b64_tr_b16 a[180:181], v12 offset:51200
    ds_read_b64_tr_b16 a[182:183], v12 offset:51712
    s_add_u32 s37, s37, 10240
    v_add_u32 v16, s37, v2
    s_mul_i32 s37, s3, 15360
    v_add_u32 v17, s37, v2
    v_mfma_f32_32x32x16_bf16 v[192:207], a[188:191], a[140:143], v[192:207]
    ds_read_b64_tr_b16 a[184:185], v13 offset:43008
    ds_read_b64_tr_b16 a[186:187], v13 offset:43520
    v_add_u32 v244, 61440, v14
    v_add_u32 v245, 61440, v15
    v_add_u32 v246, 61440, v16
    v_add_u32 v247, 61440, v17
    buffer_load_dwordx4 a[84:87], v2, s[8:11], s54 offen offset:2048 sc1
    s_waitcnt lgkmcnt(6)
    v_mfma_f32_32x32x16_bf16 v[144:159], a[160:163], a[144:147], v[144:159]
    ds_read_b64_tr_b16 a[188:189], v13 offset:51200
    ds_read_b64_tr_b16 a[190:191], v13 offset:51712
    v_mov_b32 v250, 1.0
    v_mov_b32 v251, 1.0
    v_mov_b32 v252, s42
    v_mfma_f32_32x32x16_bf16 v[160:175], a[164:167], a[144:147], v[160:175]
    ds_read_b64_tr_b16 a[160:161], v12 offset:45056
    ds_read_b64_tr_b16 a[162:163], v12 offset:45568
    v_mov_b32 v253, s42
    s_mov_b32 m0, s58
    s_nop 0
    buffer_load_dwordx4 v8, s[16:19], s56 offen offset:0 lds
    s_mov_b32 m0, s58
    s_nop 0
    buffer_load_dwordx4 v9, s[16:19], s56 offen offset:1024 lds
    v_mfma_f32_32x32x16_bf16 v[176:191], a[168:171], a[144:147], v[176:191]
    ds_read_b64_tr_b16 a[164:165], v12 offset:53248
    ds_read_b64_tr_b16 a[166:167], v12 offset:53760
    v_mfma_f32_32x32x16_bf16 v[192:207], a[172:175], a[144:147], v[192:207]
    ds_read_b64_tr_b16 a[168:169], v13 offset:45056
    ds_read_b64_tr_b16 a[170:171], v13 offset:45568
    s_mov_b32 m0, s58
    s_mov_b32 exec_hi, 0
    buffer_load_dwordx4 v10, s[16:19], s56 offen offset:2048 lds
    s_mov_b64 exec, -1
    s_waitcnt lgkmcnt(6)
    v_mfma_f32_32x32x16_bf16 v[144:159], a[176:179], a[148:151], v[144:159]
    ds_read_b64_tr_b16 a[172:173], v13 offset:53248
    ds_read_b64_tr_b16 a[174:175], v13 offset:53760
    v_mfma_f32_32x32x16_bf16 v[160:175], a[180:183], a[148:151], v[160:175]
    ds_read_b64_tr_b16 a[176:177], v12 offset:47104
    ds_read_b64_tr_b16 a[178:179], v12 offset:47616
    s_add_u32 m0, s58, 2560
    s_nop 0
    buffer_load_dwordx4 v11, s[8:11], s57 offen offset:0 sc1 lds
    s_add_u32 s57, s57, 1024
    s_add_u32 m0, s58, 2560
    s_nop 0
    buffer_load_dwordx4 v11, s[8:11], s57 offen offset:1024 sc1 lds
    v_mfma_f32_32x32x16_bf16 v[176:191], a[184:187], a[148:151], v[176:191]
    ds_read_b64_tr_b16 a[180:181], v12 offset:55296
    ds_read_b64_tr_b16 a[182:183], v12 offset:55808
    s_add_u32 s57, s57, 1024
    v_mfma_f32_32x32x16_bf16 v[192:207], a[188:191], a[148:151], v[192:207]
    ds_read_b64_tr_b16 a[184:185], v13 offset:47104
    ds_read_b64_tr_b16 a[186:187], v13 offset:47616
    s_add_u32 m0, s58, 2560
    s_mov_b32 exec_hi, 0
    buffer_load_dwordx4 v11, s[8:11], s57 offen offset:2048 sc1 lds
    s_mov_b64 exec, -1
    s_waitcnt lgkmcnt(6)
    v_mfma_f32_32x32x16_bf16 v[144:159], a[160:163], a[152:155], v[144:159]
    ds_read_b64_tr_b16 a[188:189], v13 offset:55296
    ds_read_b64_tr_b16 a[190:191], v13 offset:55808
    v_mfma_f32_32x32x16_bf16 v[160:175], a[164:167], a[152:155], v[160:175]
    s_mov_b32 m0, 143360
    s_mov_b64 exec, 0x3ff
    buffer_load_dwordx4 v2, s[24:27], s59 offen lds
    s_mov_b64 exec, -1
    v_mfma_f32_32x32x16_bf16 v[176:191], a[168:171], a[152:155], v[176:191]
    v_mfma_f32_32x32x16_bf16 v[192:207], a[172:175], a[152:155], v[192:207]
    buffer_load_dwordx4 a[88:91], v2, s[8:11], s54 offen offset:3072 sc1
    s_waitcnt lgkmcnt(0)
    v_mfma_f32_32x32x16_bf16 v[144:159], a[176:179], a[156:159], v[144:159]
    v_mfma_f32_32x32x16_bf16 v[160:175], a[180:183], a[156:159], v[160:175]
    buffer_load_dwordx4 a[92:95], v3, s[8:11], s54 offen offset:0 sc1
    v_mfma_f32_32x32x16_bf16 v[176:191], a[184:187], a[156:159], v[176:191]
    v_mfma_f32_32x32x16_bf16 v[192:207], a[188:191], a[156:159], v[192:207]
    s_add_u32 s54, s50, 40960
    buffer_load_dwordx4 a[96:99], v2, s[8:11], s54 offen offset:0 sc1
    s_load_dwordx16 s[64:79], s[32:33], 0 glc
    s_add_u32 s47, s39, 16384
    s_nop 4
    v_pk_mul_f32 v[160:161], v[144:145], v[160:161]
    v_pk_mul_f32 v[162:163], v[146:147], v[162:163]
    v_pk_mul_f32 v[164:165], v[148:149], v[164:165]
    v_pk_mul_f32 v[166:167], v[150:151], v[166:167]
    v_pk_mul_f32 v[144:145], v[144:145], v[56:57]
    v_pk_mul_f32 v[146:147], v[146:147], v[56:57]
    v_pk_mul_f32 v[148:149], v[148:149], v[56:57]
    v_pk_mul_f32 v[150:151], v[150:151], v[56:57]
    v_exp_f32 v144, v144
    v_exp_f32 v145, v145
    v_exp_f32 v146, v146
    v_exp_f32 v147, v147
    buffer_load_dwordx4 a[100:103], v2, s[8:11], s54 offen offset:1024 sc1
    v_exp_f32 v148, v148
    v_exp_f32 v149, v149
    v_exp_f32 v150, v150
    v_exp_f32 v151, v151
    buffer_load_dwordx4 a[104:107], v2, s[8:11], s54 offen offset:2048 sc1
    v_pk_add_f32 v[144:145], v[144:145], v[54:55]
    v_pk_add_f32 v[146:147], v[146:147], v[54:55]
    v_pk_add_f32 v[148:149], v[148:149], v[54:55]
    v_pk_add_f32 v[150:151], v[150:151], v[54:55]
    v_rcp_f32 v144, v144
    v_rcp_f32 v145, v145
    v_rcp_f32 v146, v146
    v_rcp_f32 v147, v147
    buffer_load_dwordx4 a[108:111], v2, s[8:11], s54 offen offset:3072 sc1
    v_rcp_f32 v148, v148
    v_rcp_f32 v149, v149
    v_rcp_f32 v150, v150
    v_rcp_f32 v151, v151
    buffer_load_dwordx4 a[112:115], v3, s[8:11], s54 offen offset:0 sc1
    v_pk_mul_f32 v[160:161], v[160:161], v[144:145]
    v_pk_mul_f32 v[162:163], v[162:163], v[146:147]
    v_pk_mul_f32 v[164:165], v[164:165], v[148:149]
    v_pk_mul_f32 v[166:167], v[166:167], v[150:151]
    v_cvt_pk_bf16_f32 v144, v160, v161
    v_cvt_pk_bf16_f32 v145, v162, v163
    v_cvt_pk_bf16_f32 v146, v164, v165
    v_cvt_pk_bf16_f32 v147, v166, v167
    buffer_store_dwordx4 v[144:147], v23, s[8:11], s47 offen offset:0 sc1
    v_pk_mul_f32 v[168:169], v[152:153], v[168:169]
    v_pk_mul_f32 v[170:171], v[154:155], v[170:171]
    v_pk_mul_f32 v[172:173], v[156:157], v[172:173]
    v_pk_mul_f32 v[174:175], v[158:159], v[174:175]
    v_pk_mul_f32 v[152:153], v[152:153], v[56:57]
    v_pk_mul_f32 v[154:155], v[154:155], v[56:57]
    v_pk_mul_f32 v[156:157], v[156:157], v[56:57]
    v_pk_mul_f32 v[158:159], v[158:159], v[56:57]
    v_exp_f32 v152, v152
    v_exp_f32 v153, v153
    v_exp_f32 v154, v154
    v_exp_f32 v155, v155
    v_exp_f32 v156, v156
    v_exp_f32 v157, v157
    v_exp_f32 v158, v158
    v_exp_f32 v159, v159
    v_pk_add_f32 v[152:153], v[152:153], v[54:55]
    v_pk_add_f32 v[154:155], v[154:155], v[54:55]
    v_pk_add_f32 v[156:157], v[156:157], v[54:55]
    v_pk_add_f32 v[158:159], v[158:159], v[54:55]
    v_rcp_f32 v152, v152
    v_rcp_f32 v153, v153
    v_rcp_f32 v154, v154
    v_rcp_f32 v155, v155
    v_rcp_f32 v156, v156
    v_rcp_f32 v157, v157
    v_rcp_f32 v158, v158
    v_rcp_f32 v159, v159
    v_pk_mul_f32 v[168:169], v[168:169], v[152:153]
    v_pk_mul_f32 v[170:171], v[170:171], v[154:155]
    v_pk_mul_f32 v[172:173], v[172:173], v[156:157]
    v_pk_mul_f32 v[174:175], v[174:175], v[158:159]
    v_cvt_pk_bf16_f32 v152, v168, v169
    v_cvt_pk_bf16_f32 v153, v170, v171
    v_cvt_pk_bf16_f32 v154, v172, v173
    v_cvt_pk_bf16_f32 v155, v174, v175
    buffer_store_dwordx4 v[152:155], v23, s[8:11], s47 offen offset:512 sc1
    s_waitcnt lgkmcnt(0)
    s_cmp_lg_u64 s[64:65], s[28:29]
    s_cbranch_scc1 FQ0_retry
    s_cmp_lg_u64 s[66:67], s[28:29]
    s_cbranch_scc1 FQ0_retry
    s_cmp_lg_u64 s[68:69], s[28:29]
    s_cbranch_scc1 FQ0_retry
    s_cmp_lg_u64 s[70:71], s[28:29]
    s_cbranch_scc1 FQ0_retry
    s_cmp_lg_u64 s[72:73], s[28:29]
    s_cbranch_scc1 FQ0_retry
    s_cmp_lg_u64 s[74:75], s[28:29]
    s_cbranch_scc1 FQ0_retry
    s_cmp_lg_u64 s[76:77], s[28:29]
    s_cbranch_scc1 FQ0_retry
    s_cmp_lg_u64 s[78:79], s[28:29]
    s_cbranch_scc1 FQ0_retry
FQ0_back:
    s_add_u32 s55, s52, 0
    buffer_load_dwordx4 v[208:211], v4, s[8:11], s55 offen sc1
    buffer_load_dwordx4 v[212:215], v5, s[8:11], s55 offen sc1
    buffer_load_dwordx4 v[216:219], v6, s[8:11], s55 offen sc1
    buffer_load_dwordx4 v[220:223], v7, s[8:11], s55 offen sc1
    s_add_u32 s55, s52, 4096
    buffer_load_dwordx4 v[144:147], v4, s[8:11], s55 offen sc1
    buffer_load_dwordx4 v[148:151], v5, s[8:11], s55 offen sc1
    buffer_load_dwordx4 v[152:155], v6, s[8:11], s55 offen sc1
    buffer_load_dwordx4 v[156:159], v7, s[8:11], s55 offen sc1
    s_add_u32 s55, s52, 8192
    buffer_load_dwordx4 v[160:163], v4, s[8:11], s55 offen sc1
    buffer_load_dwordx4 v[164:167], v5, s[8:11], s55 offen sc1
    buffer_load_dwordx4 v[168:171], v6, s[8:11], s55 offen sc1
    buffer_load_dwordx4 v[172:175], v7, s[8:11], s55 offen sc1
    s_add_u32 s47, s39, 20480
    v_pk_mul_f32 v[192:193], v[176:177], v[192:193]
    v_pk_mul_f32 v[194:195], v[178:179], v[194:195]
    v_pk_mul_f32 v[196:197], v[180:181], v[196:197]
    v_pk_mul_f32 v[198:199], v[182:183], v[198:199]
    v_pk_mul_f32 v[176:177], v[176:177], v[56:57]
    v_pk_mul_f32 v[178:179], v[178:179], v[56:57]
    v_pk_mul_f32 v[180:181], v[180:181], v[56:57]
    v_pk_mul_f32 v[182:183], v[182:183], v[56:57]
    v_exp_f32 v176, v176
    v_exp_f32 v177, v177
    v_exp_f32 v178, v178
    v_exp_f32 v179, v179
    s_add_u32 s54, s50, 46080
    buffer_load_dwordx4 a[116:119], v2, s[8:11], s54 offen offset:0 sc1
    v_exp_f32 v180, v180
    v_exp_f32 v181, v181
    v_exp_f32 v182, v182
    v_exp_f32 v183, v183
    buffer_load_dwordx4 a[120:123], v2, s[8:11], s54 offen offset:1024 sc1
    v_pk_add_f32 v[176:177], v[176:177], v[54:55]
    v_pk_add_f32 v[178:179], v[178:179], v[54:55]
    v_pk_add_f32 v[180:181], v[180:181], v[54:55]
    v_pk_add_f32 v[182:183], v[182:183], v[54:55]
    v_rcp_f32 v176, v176
    v_rcp_f32 v177, v177
    v_rcp_f32 v178, v178
    v_rcp_f32 v179, v179
    buffer_load_dwordx4 a[124:127], v2, s[8:11], s54 offen offset:2048 sc1
    v_rcp_f32 v180, v180
    v_rcp_f32 v181, v181
    v_rcp_f32 v182, v182
    v_rcp_f32 v183, v183
    buffer_load_dwordx4 a[128:131], v2, s[8:11], s54 offen offset:3072 sc1
    v_pk_mul_f32 v[192:193], v[192:193], v[176:177]
    v_pk_mul_f32 v[194:195], v[194:195], v[178:179]
    v_pk_mul_f32 v[196:197], v[196:197], v[180:181]
    v_pk_mul_f32 v[198:199], v[198:199], v[182:183]
    v_cvt_pk_bf16_f32 v176, v192, v193
    v_cvt_pk_bf16_f32 v177, v194, v195
    v_cvt_pk_bf16_f32 v178, v196, v197
    v_cvt_pk_bf16_f32 v179, v198, v199
    buffer_store_dwordx4 v[176:179], v23, s[8:11], s47 offen offset:0 sc1
    v_pk_mul_f32 v[200:201], v[184:185], v[200:201]
    v_pk_mul_f32 v[202:203], v[186:187], v[202:203]
    v_pk_mul_f32 v[204:205], v[188:189], v[204:205]
    v_pk_mul_f32 v[206:207], v[190:191], v[206:207]
    v_pk_mul_f32 v[184:185], v[184:185], v[56:57]
    v_pk_mul_f32 v[186:187], v[186:187], v[56:57]
    v_pk_mul_f32 v[188:189], v[188:189], v[56:57]
    v_pk_mul_f32 v[190:191], v[190:191], v[56:57]
    v_exp_f32 v184, v184
    v_exp_f32 v185, v185
    v_exp_f32 v186, v186
    v_exp_f32 v187, v187
    v_exp_f32 v188, v188
    v_exp_f32 v189, v189
    v_exp_f32 v190, v190
    v_exp_f32 v191, v191
    v_pk_add_f32 v[184:185], v[184:185], v[54:55]
    v_pk_add_f32 v[186:187], v[186:187], v[54:55]
    v_pk_add_f32 v[188:189], v[188:189], v[54:55]
    v_pk_add_f32 v[190:191], v[190:191], v[54:55]
    v_rcp_f32 v184, v184
    v_rcp_f32 v185, v185
    v_rcp_f32 v186, v186
    v_rcp_f32 v187, v187
    v_rcp_f32 v188, v188
    v_rcp_f32 v189, v189
    v_rcp_f32 v190, v190
    v_rcp_f32 v191, v191
    v_pk_mul_f32 v[200:201], v[200:201], v[184:185]
    v_pk_mul_f32 v[202:203], v[202:203], v[186:187]
    v_pk_mul_f32 v[204:205], v[204:205], v[188:189]
    v_pk_mul_f32 v[206:207], v[206:207], v[190:191]
    v_cvt_pk_bf16_f32 v184, v200, v201
    v_cvt_pk_bf16_f32 v185, v202, v203
    v_cvt_pk_bf16_f32 v186, v204, v205
    v_cvt_pk_bf16_f32 v187, v206, v207
    buffer_store_dwordx4 v[184:187], v23, s[8:11], s47 offen offset:512 sc1
    s_waitcnt vmcnt(17)
    v_mfma_f32_16x16x32_bf16 v[64:67], a[192:195], v[208:211], 0
    s_add_u32 s55, s52, 12288
    buffer_load_dwordx4 v[176:179], v4, s[8:11], s55 offen sc1
    v_mfma_f32_16x16x32_bf16 v[68:71], a[196:199], v[208:211], 0
    buffer_load_dwordx4 v[180:183], v5, s[8:11], s55 offen sc1
    v_mfma_f32_16x16x32_bf16 v[72:75], a[200:203], v[208:211], 0
    buffer_load_dwordx4 v[184:187], v6, s[8:11], s55 offen sc1
    v_mfma_f32_16x16x32_bf16 v[76:79], a[204:207], v[208:211], 0
    buffer_load_dwordx4 v[188:191], v7, s[8:11], s55 offen sc1
    v_mfma_f32_16x16x32_bf16 v[80:83], a[208:211], v[208:211], 0
    s_waitcnt vmcnt(20)
    v_mfma_f32_16x16x32_bf16 v[84:87], a[192:195], v[212:215], 0
    v_mfma_f32_16x16x32_bf16 v[88:91], a[196:199], v[212:215], 0
    v_mfma_f32_16x16x32_bf16 v[92:95], a[200:203], v[212:215], 0
    s_add_u32 s55, s52, 16384
    buffer_load_dwordx4 v[192:195], v4, s[8:11], s55 offen sc1
    v_mfma_f32_16x16x32_bf16 v[96:99], a[204:207], v[212:215], 0
    v_mfma_f32_16x16x32_bf16 v[100:103], a[208:211], v[212:215], 0
    s_waitcnt vmcnt(20)
    v_mfma_f32_16x16x32_bf16 v[104:107], a[192:195], v[216:219], 0
    v_mfma_f32_16x16x32_bf16 v[108:111], a[196:199], v[216:219], 0
    buffer_load_dwordx4 v[196:199], v5, s[8:11], s55 offen sc1
    v_mfma_f32_16x16x32_bf16 v[112:115], a[200:203], v[216:219], 0
    v_mfma_f32_16x16x32_bf16 v[116:119], a[204:207], v[216:219], 0
    v_mfma_f32_16x16x32_bf16 v[120:123], a[208:211], v[216:219], 0
    s_waitcnt vmcnt(20)
    v_mfma_f32_16x16x32_bf16 v[124:127], a[192:195], v[220:223], 0
    buffer_load_dwordx4 v[200:203], v6, s[8:11], s55 offen sc1
    v_mfma_f32_16x16x32_bf16 v[128:131], a[196:199], v[220:223], 0
    v_mfma_f32_16x16x32_bf16 v[132:135], a[200:203], v[220:223], 0
    v_mfma_f32_16x16x32_bf16 v[136:139], a[204:207], v[220:223], 0
    v_mfma_f32_16x16x32_bf16 v[140:143], a[208:211], v[220:223], 0
    buffer_load_dwordx4 v[204:207], v7, s[8:11], s55 offen sc1
    s_waitcnt vmcnt(21)
    v_mfma_f32_16x16x32_bf16 v[64:67], a[212:215], v[144:147], v[64:67]
    s_waitcnt vmcnt(8)
    v_mov_b32 v61, s43
    v_mfma_f32_16x16x32_bf16 v[68:71], a[216:219], v[144:147], v[68:71]
    buffer_store_dword v61, v27, s[8:11], s61 offen offset:128 sc1
    v_mfma_f32_16x16x32_bf16 v[72:75], a[220:223], v[144:147], v[72:75]
    ds_read_b64 v[28:29], v18 offset:0
    ds_read_b64 v[38:39], v19 offset:2560
    v_mfma_f32_16x16x32_bf16 v[76:79], a[224:227], v[144:147], v[76:79]
    ds_read_b64 v[48:49], v21 offset:0
    ds_read_b64 v[30:31], v18 offset:32
    v_mfma_f32_16x16x32_bf16 v[80:83], a[228:231], v[144:147], v[80:83]
    ds_read_b64 v[40:41], v19 offset:3072
    v_mfma_f32_16x16x32_bf16 v[84:87], a[212:215], v[148:151], v[84:87]
    s_add_u32 s55, s52, 20480
    buffer_load_dwordx4 v[208:211], v4, s[8:11], s55 offen sc1
    v_mfma_f32_16x16x32_bf16 v[88:91], a[216:219], v[148:151], v[88:91]
    ds_read_b64 v[50:51], v21 offset:32
    ds_read_b64 v[32:33], v18 offset:64
    v_mfma_f32_16x16x32_bf16 v[92:95], a[220:223], v[148:151], v[92:95]
    ds_read_b64 v[42:43], v19 offset:3584
    ds_read_b64 v[52:53], v21 offset:64
    v_mfma_f32_16x16x32_bf16 v[96:99], a[224:227], v[148:151], v[96:99]
    ds_read_b64 v[34:35], v18 offset:96
    ds_read_b64 v[44:45], v19 offset:4096
    v_mfma_f32_16x16x32_bf16 v[100:103], a[228:231], v[148:151], v[100:103]
    buffer_load_dwordx4 v[212:215], v5, s[8:11], s55 offen sc1
    v_mfma_f32_16x16x32_bf16 v[104:107], a[212:215], v[152:155], v[104:107]
    ds_read_b64 v[54:55], v21 offset:96
    ds_read_b64 v[36:37], v18 offset:128
    v_mfma_f32_16x16x32_bf16 v[108:111], a[216:219], v[152:155], v[108:111]
    ds_read_b64 v[46:47], v19 offset:4608
    ds_read_b64 v[56:57], v21 offset:128
    v_mfma_f32_16x16x32_bf16 v[112:115], a[220:223], v[152:155], v[112:115]
    v_mfma_f32_16x16x32_bf16 v[116:119], a[224:227], v[152:155], v[116:119]
    buffer_load_dwordx4 v[216:219], v6, s[8:11], s55 offen sc1
    v_mfma_f32_16x16x32_bf16 v[120:123], a[228:231], v[152:155], v[120:123]
    v_mfma_f32_16x16x32_bf16 v[124:127], a[212:215], v[156:159], v[124:127]
    v_mfma_f32_16x16x32_bf16 v[128:131], a[216:219], v[156:159], v[128:131]
    v_mfma_f32_16x16x32_bf16 v[132:135], a[220:223], v[156:159], v[132:135]
    buffer_load_dwordx4 v[220:223], v7, s[8:11], s55 offen sc1
    v_mfma_f32_16x16x32_bf16 v[136:139], a[224:227], v[156:159], v[136:139]
    v_mfma_f32_16x16x32_bf16 v[140:143], a[228:231], v[156:159], v[140:143]
    v_mfma_f32_16x16x32_bf16 v[64:67], a[232:235], v[160:163], v[64:67]
    v_mfma_f32_16x16x32_bf16 v[68:71], a[236:239], v[160:163], v[68:71]
    s_add_u32 s55, s52, 24576
    buffer_load_dwordx4 v[144:147], v4, s[8:11], s55 offen sc1
    v_mfma_f32_16x16x32_bf16 v[72:75], a[240:243], v[160:163], v[72:75]
    v_mfma_f32_16x16x32_bf16 v[76:79], a[244:247], v[160:163], v[76:79]
    v_mfma_f32_16x16x32_bf16 v[80:83], a[248:251], v[160:163], v[80:83]
    v_mfma_f32_16x16x32_bf16 v[84:87], a[232:235], v[164:167], v[84:87]
    buffer_load_dwordx4 v[148:151], v5, s[8:11], s55 offen sc1
    v_mfma_f32_16x16x32_bf16 v[88:91], a[236:239], v[164:167], v[88:91]
    v_mfma_f32_16x16x32_bf16 v[92:95], a[240:243], v[164:167], v[92:95]
    v_mfma_f32_16x16x32_bf16 v[96:99], a[244:247], v[164:167], v[96:99]
    v_mfma_f32_16x16x32_bf16 v[100:103], a[248:251], v[164:167], v[100:103]
    buffer_load_dwordx4 v[152:155], v6, s[8:11], s55 offen sc1
    v_mfma_f32_16x16x32_bf16 v[104:107], a[232:235], v[168:171], v[104:107]
    v_mfma_f32_16x16x32_bf16 v[108:111], a[236:239], v[168:171], v[108:111]
    v_mfma_f32_16x16x32_bf16 v[112:115], a[240:243], v[168:171], v[112:115]
    v_mfma_f32_16x16x32_bf16 v[116:119], a[244:247], v[168:171], v[116:119]
    buffer_load_dwordx4 v[156:159], v7, s[8:11], s55 offen sc1
    v_mfma_f32_16x16x32_bf16 v[120:123], a[248:251], v[168:171], v[120:123]
    v_mfma_f32_16x16x32_bf16 v[124:127], a[232:235], v[172:175], v[124:127]
    v_mfma_f32_16x16x32_bf16 v[128:131], a[236:239], v[172:175], v[128:131]
    v_mfma_f32_16x16x32_bf16 v[132:135], a[240:243], v[172:175], v[132:135]
    s_add_u32 s55, s52, 28672
    buffer_load_dwordx4 v[160:163], v4, s[8:11], s55 offen sc1
    v_mfma_f32_16x16x32_bf16 v[136:139], a[244:247], v[172:175], v[136:139]
    v_mfma_f32_16x16x32_bf16 v[140:143], a[248:251], v[172:175], v[140:143]
    s_waitcnt vmcnt(17)
    v_mfma_f32_16x16x32_bf16 v[64:67], a[252:255], v[176:179], v[64:67]
    v_mfma_f32_16x16x32_bf16 v[68:71], a[0:3], v[176:179], v[68:71]
    buffer_load_dwordx4 v[164:167], v5, s[8:11], s55 offen sc1
    v_mfma_f32_16x16x32_bf16 v[72:75], a[4:7], v[176:179], v[72:75]
    v_mfma_f32_16x16x32_bf16 v[76:79], a[8:11], v[176:179], v[76:79]
    v_mfma_f32_16x16x32_bf16 v[80:83], a[12:15], v[176:179], v[80:83]
    s_waitcnt vmcnt(17)
    v_mfma_f32_16x16x32_bf16 v[84:87], a[252:255], v[180:183], v[84:87]
    buffer_load_dwordx4 v[168:171], v6, s[8:11], s55 offen sc1
    v_mfma_f32_16x16x32_bf16 v[88:91], a[0:3], v[180:183], v[88:91]
    v_mfma_f32_16x16x32_bf16 v[92:95], a[4:7], v[180:183], v[92:95]
    v_mfma_f32_16x16x32_bf16 v[96:99], a[8:11], v[180:183], v[96:99]
    v_mfma_f32_16x16x32_bf16 v[100:103], a[12:15], v[180:183], v[100:103]
    buffer_load_dwordx4 v[172:175], v7, s[8:11], s55 offen sc1
    s_waitcnt vmcnt(18)
    v_mfma_f32_16x16x32_bf16 v[104:107], a[252:255], v[184:187], v[104:107]
    v_mfma_f32_16x16x32_bf16 v[108:111], a[0:3], v[184:187], v[108:111]
    v_mfma_f32_16x16x32_bf16 v[112:115], a[4:7], v[184:187], v[112:115]
    v_mfma_f32_16x16x32_bf16 v[116:119], a[8:11], v[184:187], v[116:119]
    s_add_u32 s55, s52, 32768
    buffer_load_dwordx4 v[176:179], v4, s[8:11], s55 offen sc1
    v_mfma_f32_16x16x32_bf16 v[120:123], a[12:15], v[184:187], v[120:123]
    s_waitcnt vmcnt(18)
    v_mfma_f32_16x16x32_bf16 v[124:127], a[252:255], v[188:191], v[124:127]
    v_mfma_f32_16x16x32_bf16 v[128:131], a[0:3], v[188:191], v[128:131]
    v_mfma_f32_16x16x32_bf16 v[132:135], a[4:7], v[188:191], v[132:135]
    buffer_load_dwordx4 v[180:183], v5, s[8:11], s55 offen sc1
    v_mfma_f32_16x16x32_bf16 v[136:139], a[8:11], v[188:191], v[136:139]
    v_mfma_f32_16x16x32_bf16 v[140:143], a[12:15], v[188:191], v[140:143]
    s_load_dwordx8 s[64:71], s[34:35], 0 glc
    s_waitcnt vmcnt(18)
    v_mfma_f32_16x16x32_bf16 v[64:67], a[16:19], v[192:195], v[64:67]
    v_mfma_f32_16x16x32_bf16 v[68:71], a[20:23], v[192:195], v[68:71]
    buffer_load_dwordx4 v[184:187], v6, s[8:11], s55 offen sc1
    v_mfma_f32_16x16x32_bf16 v[72:75], a[24:27], v[192:195], v[72:75]
    v_mfma_f32_16x16x32_bf16 v[76:79], a[28:31], v[192:195], v[76:79]
    v_mfma_f32_16x16x32_bf16 v[80:83], a[32:35], v[192:195], v[80:83]
    s_waitcnt vmcnt(18)
    v_mfma_f32_16x16x32_bf16 v[84:87], a[16:19], v[196:199], v[84:87]
    buffer_load_dwordx4 v[188:191], v7, s[8:11], s55 offen sc1
    v_mfma_f32_16x16x32_bf16 v[88:91], a[20:23], v[196:199], v[88:91]
    v_mfma_f32_16x16x32_bf16 v[92:95], a[24:27], v[196:199], v[92:95]
    v_mfma_f32_16x16x32_bf16 v[96:99], a[28:31], v[196:199], v[96:99]
    v_mfma_f32_16x16x32_bf16 v[100:103], a[32:35], v[196:199], v[100:103]
    buffer_load_dwordx4 a[132:135], v3, s[8:11], s54 offen offset:0 sc1
    s_waitcnt vmcnt(19)
    v_mfma_f32_16x16x32_bf16 v[104:107], a[16:19], v[200:203], v[104:107]
    v_mfma_f32_16x16x32_bf16 v[108:111], a[20:23], v[200:203], v[108:111]
    v_mfma_f32_16x16x32_bf16 v[112:115], a[24:27], v[200:203], v[112:115]
    v_mfma_f32_16x16x32_bf16 v[116:119], a[28:31], v[200:203], v[116:119]
    s_add_u32 s55, s52, 36864
    buffer_load_dwordx4 v[192:195], v4, s[8:11], s55 offen sc1
    v_mfma_f32_16x16x32_bf16 v[120:123], a[32:35], v[200:203], v[120:123]
    s_waitcnt vmcnt(19)
    v_mfma_f32_16x16x32_bf16 v[124:127], a[16:19], v[204:207], v[124:127]
    v_mfma_f32_16x16x32_bf16 v[128:131], a[20:23], v[204:207], v[128:131]
    v_mfma_f32_16x16x32_bf16 v[132:135], a[24:27], v[204:207], v[132:135]
    buffer_load_dwordx4 v[196:199], v5, s[8:11], s55 offen sc1
    v_mfma_f32_16x16x32_bf16 v[136:139], a[28:31], v[204:207], v[136:139]
    v_mfma_f32_16x16x32_bf16 v[140:143], a[32:35], v[204:207], v[140:143]
    s_waitcnt vmcnt(18)
    v_mfma_f32_16x16x32_bf16 v[64:67], a[36:39], v[208:211], v[64:67]
    v_mfma_f32_16x16x32_bf16 v[68:71], a[40:43], v[208:211], v[68:71]
    buffer_load_dwordx4 v[200:203], v6, s[8:11], s55 offen sc1
    v_mfma_f32_16x16x32_bf16 v[72:75], a[44:47], v[208:211], v[72:75]
    v_mfma_f32_16x16x32_bf16 v[76:79], a[48:51], v[208:211], v[76:79]
    v_mfma_f32_16x16x32_bf16 v[80:83], a[52:55], v[208:211], v[80:83]
    s_waitcnt vmcnt(18)
    v_mfma_f32_16x16x32_bf16 v[84:87], a[36:39], v[212:215], v[84:87]
    buffer_load_dwordx4 v[204:207], v7, s[8:11], s55 offen sc1
    v_mfma_f32_16x16x32_bf16 v[88:91], a[40:43], v[212:215], v[88:91]
    v_mfma_f32_16x16x32_bf16 v[92:95], a[44:47], v[212:215], v[92:95]
    v_mfma_f32_16x16x32_bf16 v[96:99], a[48:51], v[212:215], v[96:99]
    v_mfma_f32_16x16x32_bf16 v[100:103], a[52:55], v[212:215], v[100:103]
    s_add_u32 s54, s51, 0
    buffer_load_dwordx4 a[136:139], v2, s[8:11], s54 offen offset:0 sc1
    s_waitcnt vmcnt(19)
    v_mfma_f32_16x16x32_bf16 v[104:107], a[36:39], v[216:219], v[104:107]
    v_mfma_f32_16x16x32_bf16 v[108:111], a[40:43], v[216:219], v[108:111]
    v_mfma_f32_16x16x32_bf16 v[112:115], a[44:47], v[216:219], v[112:115]
    v_mfma_f32_16x16x32_bf16 v[116:119], a[48:51], v[216:219], v[116:119]
    buffer_load_dwordx4 a[140:143], v2, s[8:11], s54 offen offset:1024 sc1
    v_mfma_f32_16x16x32_bf16 v[120:123], a[52:55], v[216:219], v[120:123]
    s_waitcnt vmcnt(19)
    v_mfma_f32_16x16x32_bf16 v[124:127], a[36:39], v[220:223], v[124:127]
    v_mfma_f32_16x16x32_bf16 v[128:131], a[40:43], v[220:223], v[128:131]
    v_mfma_f32_16x16x32_bf16 v[132:135], a[44:47], v[220:223], v[132:135]
    buffer_load_dwordx4 a[144:147], v2, s[8:11], s54 offen offset:2048 sc1
    v_mfma_f32_16x16x32_bf16 v[136:139], a[48:51], v[220:223], v[136:139]
    v_mfma_f32_16x16x32_bf16 v[140:143], a[52:55], v[220:223], v[140:143]
    s_waitcnt lgkmcnt(0)
    s_cmp_lg_u64 s[64:65], s[28:29]
    s_cbranch_scc1 FQ1_retry
    s_cmp_lg_u64 s[66:67], s[28:29]
    s_cbranch_scc1 FQ1_retry
    s_cmp_lg_u64 s[68:69], s[28:29]
    s_cbranch_scc1 FQ1_retry
    s_cmp_lg_u64 s[70:71], s[28:29]
    s_cbranch_scc1 FQ1_retry
FQ1_back:
    s_waitcnt vmcnt(19)
    v_mfma_f32_16x16x32_bf16 v[64:67], a[56:59], v[144:147], v[64:67]
    v_mfma_f32_16x16x32_bf16 v[68:71], a[60:63], v[144:147], v[68:71]
    buffer_load_dwordx4 a[148:151], v2, s[8:11], s54 offen offset:3072 sc1
    v_mfma_f32_16x16x32_bf16 v[72:75], a[64:67], v[144:147], v[72:75]
    v_mfma_f32_16x16x32_bf16 v[76:79], a[68:71], v[144:147], v[76:79]
    v_mfma_f32_16x16x32_bf16 v[80:83], a[72:75], v[144:147], v[80:83]
    s_waitcnt vmcnt(19)
    v_mfma_f32_16x16x32_bf16 v[84:87], a[56:59], v[148:151], v[84:87]
    buffer_load_dwordx4 a[152:155], v3, s[8:11], s54 offen offset:0 sc1
    v_mfma_f32_16x16x32_bf16 v[88:91], a[60:63], v[148:151], v[88:91]
    v_mfma_f32_16x16x32_bf16 v[92:95], a[64:67], v[148:151], v[92:95]
    v_mfma_f32_16x16x32_bf16 v[96:99], a[68:71], v[148:151], v[96:99]
    v_mfma_f32_16x16x32_bf16 v[100:103], a[72:75], v[148:151], v[100:103]
    s_add_u32 s55, s53, 0
    buffer_load_dwordx4 a[156:159], v4, s[8:11], s55 offen sc1
    s_waitcnt vmcnt(20)
    v_mfma_f32_16x16x32_bf16 v[104:107], a[56:59], v[152:155], v[104:107]
    v_mfma_f32_16x16x32_bf16 v[108:111], a[60:63], v[152:155], v[108:111]
    v_mfma_f32_16x16x32_bf16 v[112:115], a[64:67], v[152:155], v[112:115]
    v_mfma_f32_16x16x32_bf16 v[116:119], a[68:71], v[152:155], v[116:119]
    buffer_load_dwordx4 a[160:163], v5, s[8:11], s55 offen sc1
    v_mfma_f32_16x16x32_bf16 v[120:123], a[72:75], v[152:155], v[120:123]
    s_waitcnt vmcnt(20)
    v_mfma_f32_16x16x32_bf16 v[124:127], a[56:59], v[156:159], v[124:127]
    v_mfma_f32_16x16x32_bf16 v[128:131], a[60:63], v[156:159], v[128:131]
    v_mfma_f32_16x16x32_bf16 v[132:135], a[64:67], v[156:159], v[132:135]
    buffer_load_dwordx4 a[164:167], v6, s[8:11], s55 offen sc1
    v_mfma_f32_16x16x32_bf16 v[136:139], a[68:71], v[156:159], v[136:139]
    v_mfma_f32_16x16x32_bf16 v[140:143], a[72:75], v[156:159], v[140:143]
    s_waitcnt vmcnt(20)
    v_mfma_f32_16x16x32_bf16 v[64:67], a[76:79], v[160:163], v[64:67]
    buffer_load_dwordx4 a[168:171], v7, s[8:11], s55 offen sc1
    v_mfma_f32_16x16x32_bf16 v[68:71], a[80:83], v[160:163], v[68:71]
    v_mfma_f32_16x16x32_bf16 v[72:75], a[84:87], v[160:163], v[72:75]
    v_mfma_f32_16x16x32_bf16 v[76:79], a[88:91], v[160:163], v[76:79]
    v_mfma_f32_16x16x32_bf16 v[80:83], a[92:95], v[160:163], v[80:83]
    s_add_u32 s54, s51, 5120
    buffer_load_dwordx4 a[172:175], v2, s[8:11], s54 offen offset:0 sc1
    s_waitcnt vmcnt(21)
    v_mfma_f32_16x16x32_bf16 v[84:87], a[76:79], v[164:167], v[84:87]
    v_mfma_f32_16x16x32_bf16 v[88:91], a[80:83], v[164:167], v[88:91]
    v_mfma_f32_16x16x32_bf16 v[92:95], a[84:87], v[164:167], v[92:95]
    v_mfma_f32_16x16x32_bf16 v[96:99], a[88:91], v[164:167], v[96:99]
    buffer_load_dwordx4 a[176:179], v2, s[8:11], s54 offen offset:1024 sc1
    v_mfma_f32_16x16x32_bf16 v[100:103], a[92:95], v[164:167], v[100:103]
    s_waitcnt vmcnt(21)
    v_mfma_f32_16x16x32_bf16 v[104:107], a[76:79], v[168:171], v[104:107]
    v_mfma_f32_16x16x32_bf16 v[108:111], a[80:83], v[168:171], v[108:111]
    v_mfma_f32_16x16x32_bf16 v[112:115], a[84:87], v[168:171], v[112:115]
    buffer_load_dwordx4 a[180:183], v2, s[8:11], s54 offen offset:2048 sc1
    v_mfma_f32_16x16x32_bf16 v[116:119], a[88:91], v[168:171], v[116:119]
    v_mfma_f32_16x16x32_bf16 v[120:123], a[92:95], v[168:171], v[120:123]
    s_waitcnt vmcnt(21)
    v_mfma_f32_16x16x32_bf16 v[124:127], a[76:79], v[172:175], v[124:127]
    v_mfma_f32_16x16x32_bf16 v[128:131], a[80:83], v[172:175], v[128:131]
    buffer_load_dwordx4 a[184:187], v2, s[8:11], s54 offen offset:3072 sc1
    v_mfma_f32_16x16x32_bf16 v[132:135], a[84:87], v[172:175], v[132:135]
    v_mfma_f32_16x16x32_bf16 v[136:139], a[88:91], v[172:175], v[136:139]
    v_mfma_f32_16x16x32_bf16 v[140:143], a[92:95], v[172:175], v[140:143]
    s_waitcnt vmcnt(21)
    v_mfma_f32_16x16x32_bf16 v[64:67], a[96:99], v[176:179], v[64:67]
    buffer_load_dwordx4 a[188:191], v3, s[8:11], s54 offen offset:0 sc1
    v_mfma_f32_16x16x32_bf16 v[68:71], a[100:103], v[176:179], v[68:71]
    s_add_u32 s55, s53, 4096
    buffer_load_dwordx4 a[192:195], v4, s[8:11], s55 offen sc1
    v_mfma_f32_16x16x32_bf16 v[72:75], a[104:107], v[176:179], v[72:75]
    buffer_load_dwordx4 a[196:199], v5, s[8:11], s55 offen sc1
    v_mfma_f32_16x16x32_bf16 v[76:79], a[108:111], v[176:179], v[76:79]
    buffer_load_dwordx4 a[200:203], v6, s[8:11], s55 offen sc1
    v_mfma_f32_16x16x32_bf16 v[80:83], a[112:115], v[176:179], v[80:83]
    buffer_load_dwordx4 a[204:207], v7, s[8:11], s55 offen sc1
    s_waitcnt vmcnt(25)
    v_mfma_f32_16x16x32_bf16 v[84:87], a[96:99], v[180:183], v[84:87]
    v_mfma_f32_16x16x32_bf16 v[88:91], a[100:103], v[180:183], v[88:91]
    v_mfma_f32_16x16x32_bf16 v[92:95], a[104:107], v[180:183], v[92:95]
    v_mfma_f32_16x16x32_bf16 v[96:99], a[108:111], v[180:183], v[96:99]
    s_add_u32 s54, s51, 10240
    buffer_load_dwordx4 a[208:211], v2, s[8:11], s54 offen offset:0 sc1
    v_mfma_f32_16x16x32_bf16 v[100:103], a[112:115], v[180:183], v[100:103]
    s_waitcnt vmcnt(25)
    v_mfma_f32_16x16x32_bf16 v[104:107], a[96:99], v[184:187], v[104:107]
    v_mfma_f32_16x16x32_bf16 v[108:111], a[100:103], v[184:187], v[108:111]
    v_mfma_f32_16x16x32_bf16 v[112:115], a[104:107], v[184:187], v[112:115]
    buffer_load_dwordx4 a[212:215], v2, s[8:11], s54 offen offset:1024 sc1
    v_mfma_f32_16x16x32_bf16 v[116:119], a[108:111], v[184:187], v[116:119]
    v_mfma_f32_16x16x32_bf16 v[120:123], a[112:115], v[184:187], v[120:123]
    s_waitcnt vmcnt(25)
    v_mfma_f32_16x16x32_bf16 v[124:127], a[96:99], v[188:191], v[124:127]
    v_mfma_f32_16x16x32_bf16 v[128:131], a[100:103], v[188:191], v[128:131]
    buffer_load_dwordx4 a[216:219], v2, s[8:11], s54 offen offset:2048 sc1
    v_mfma_f32_16x16x32_bf16 v[132:135], a[104:107], v[188:191], v[132:135]
    v_mfma_f32_16x16x32_bf16 v[136:139], a[108:111], v[188:191], v[136:139]
    v_mfma_f32_16x16x32_bf16 v[140:143], a[112:115], v[188:191], v[140:143]
    s_waitcnt vmcnt(24)
    v_mfma_f32_16x16x32_bf16 v[64:67], a[116:119], v[192:195], v[64:67]
    buffer_load_dwordx4 a[220:223], v2, s[8:11], s54 offen offset:3072 sc1
    v_mfma_f32_16x16x32_bf16 v[68:71], a[120:123], v[192:195], v[68:71]
    buffer_load_dwordx4 a[224:227], v3, s[8:11], s54 offen offset:0 sc1
    v_mfma_f32_16x16x32_bf16 v[72:75], a[124:127], v[192:195], v[72:75]
    s_add_u32 s55, s53, 8192
    buffer_load_dwordx4 a[228:231], v4, s[8:11], s55 offen sc1
    v_mfma_f32_16x16x32_bf16 v[76:79], a[128:131], v[192:195], v[76:79]
    buffer_load_dwordx4 a[232:235], v5, s[8:11], s55 offen sc1
    v_mfma_f32_16x16x32_bf16 v[80:83], a[132:135], v[192:195], v[80:83]
    buffer_load_dwordx4 a[236:239], v6, s[8:11], s55 offen sc1
    s_waitcnt vmcnt(28)
    v_mfma_f32_16x16x32_bf16 v[84:87], a[116:119], v[196:199], v[84:87]
    buffer_load_dwordx4 a[240:243], v7, s[8:11], s55 offen sc1
    v_mfma_f32_16x16x32_bf16 v[88:91], a[120:123], v[196:199], v[88:91]
    v_mfma_f32_16x16x32_bf16 v[92:95], a[124:127], v[196:199], v[92:95]
    v_mfma_f32_16x16x32_bf16 v[96:99], a[128:131], v[196:199], v[96:99]
    v_mfma_f32_16x16x32_bf16 v[100:103], a[132:135], v[196:199], v[100:103]
    s_add_u32 s54, s51, 15360
    buffer_load_dwordx4 a[244:247], v2, s[8:11], s54 offen offset:0 sc1
    s_waitcnt vmcnt(29)
    v_mfma_f32_16x16x32_bf16 v[104:107], a[116:119], v[200:203], v[104:107]
    v_mfma_f32_16x16x32_bf16 v[108:111], a[120:123], v[200:203], v[108:111]
    v_mfma_f32_16x16x32_bf16 v[112:115], a[124:127], v[200:203], v[112:115]
    v_mfma_f32_16x16x32_bf16 v[116:119], a[128:131], v[200:203], v[116:119]
    buffer_load_dwordx4 a[248:251], v2, s[8:11], s54 offen offset:1024 sc1
    v_mfma_f32_16x16x32_bf16 v[120:123], a[132:135], v[200:203], v[120:123]
    s_waitcnt vmcnt(29)
    v_mfma_f32_16x16x32_bf16 v[124:127], a[116:119], v[204:207], v[124:127]
    v_mfma_f32_16x16x32_bf16 v[128:131], a[120:123], v[204:207], v[128:131]
    v_mfma_f32_16x16x32_bf16 v[132:135], a[124:127], v[204:207], v[132:135]
    buffer_load_dwordx4 a[252:255], v2, s[8:11], s54 offen offset:2048 sc1
    v_mfma_f32_16x16x32_bf16 v[136:139], a[128:131], v[204:207], v[136:139]
    v_mfma_f32_16x16x32_bf16 v[140:143], a[132:135], v[204:207], v[140:143]
    s_waitcnt vmcnt(24)
    v_mfma_f32_16x16x32_bf16 v[144:147], a[136:139], a[156:159], 0
    buffer_load_dwordx4 a[0:3], v2, s[8:11], s54 offen offset:3072 sc1
    v_lshlrev_b32 v224, 16, v28
    v_lshlrev_b32 v62, 16, v38
    v_mfma_f32_16x16x32_bf16 v[148:151], a[140:143], a[156:159], 0
    buffer_load_dwordx4 a[4:7], v3, s[8:11], s54 offen offset:0 sc1
    v_lshlrev_b32 v63, 16, v48
    v_fmac_f32 v64, v62, v63
    v_mfma_f32_16x16x32_bf16 v[152:155], a[144:147], a[156:159], 0
    s_add_u32 s55, s53, 12288
    buffer_load_dwordx4 a[8:11], v4, s[8:11], s55 offen sc1
    v_and_b32 v225, 0xffff0000, v28
    v_mfma_f32_16x16x32_bf16 v[156:159], a[148:151], a[156:159], 0
    buffer_load_dwordx4 a[12:15], v5, s[8:11], s55 offen sc1
    v_and_b32 v62, 0xffff0000, v38
    v_and_b32 v63, 0xffff0000, v48
    v_mfma_f32_16x16x32_bf16 v[160:163], a[152:155], a[156:159], 0
    buffer_load_dwordx4 a[16:19], v6, s[8:11], s55 offen sc1
    v_fmac_f32 v65, v62, v63
    s_waitcnt vmcnt(28)
    v_mfma_f32_16x16x32_bf16 v[164:167], a[136:139], a[160:163], 0
    buffer_load_dwordx4 a[20:23], v7, s[8:11], s55 offen sc1
    v_lshlrev_b32 v226, 16, v29
    v_lshlrev_b32 v62, 16, v39
    v_mfma_f32_16x16x32_bf16 v[168:171], a[140:143], a[160:163], 0
    v_lshlrev_b32 v63, 16, v49
    v_fmac_f32 v66, v62, v63
    v_and_b32 v227, 0xffff0000, v29
    v_mfma_f32_16x16x32_bf16 v[172:175], a[144:147], a[160:163], 0
    v_and_b32 v62, 0xffff0000, v39
    v_and_b32 v63, 0xffff0000, v49
    v_fmac_f32 v67, v62, v63
    v_mfma_f32_16x16x32_bf16 v[176:179], a[148:151], a[160:163], 0
    v_lshlrev_b32 v228, 16, v30
    v_lshlrev_b32 v62, 16, v40
    v_lshlrev_b32 v63, 16, v50
    v_mfma_f32_16x16x32_bf16 v[180:183], a[152:155], a[160:163], 0
    s_add_u32 s54, s51, 20480
    buffer_load_dwordx4 a[24:27], v2, s[8:11], s54 offen offset:0 sc1
    s_waitcnt vmcnt(29)
    v_mfma_f32_16x16x32_bf16 v[184:187], a[136:139], a[164:167], 0
    v_fmac_f32 v68, v62, v63
    v_and_b32 v229, 0xffff0000, v30
    v_and_b32 v62, 0xffff0000, v40
    v_mfma_f32_16x16x32_bf16 v[188:191], a[140:143], a[164:167], 0
    v_and_b32 v63, 0xffff0000, v50
    v_fmac_f32 v69, v62, v63
    v_lshlrev_b32 v230, 16, v31
    v_mfma_f32_16x16x32_bf16 v[192:195], a[144:147], a[164:167], 0
    v_lshlrev_b32 v62, 16, v41
    v_lshlrev_b32 v63, 16, v51
    v_fmac_f32 v70, v62, v63
    v_mfma_f32_16x16x32_bf16 v[196:199], a[148:151], a[164:167], 0
    buffer_load_dwordx4 a[28:31], v2, s[8:11], s54 offen offset:1024 sc1
    v_and_b32 v231, 0xffff0000, v31
    v_and_b32 v62, 0xffff0000, v41
    v_mfma_f32_16x16x32_bf16 v[200:203], a[152:155], a[164:167], 0
    v_and_b32 v63, 0xffff0000, v51
    v_fmac_f32 v71, v62, v63
    s_waitcnt vmcnt(29)
    v_mfma_f32_16x16x32_bf16 v[204:207], a[136:139], a[168:171], 0
    v_lshlrev_b32 v232, 16, v32
    v_lshlrev_b32 v62, 16, v42
    v_lshlrev_b32 v63, 16, v52
    v_mfma_f32_16x16x32_bf16 v[208:211], a[140:143], a[168:171], 0
    v_fmac_f32 v72, v62, v63
    v_and_b32 v233, 0xffff0000, v32
    v_and_b32 v62, 0xffff0000, v42
    v_mfma_f32_16x16x32_bf16 v[212:215], a[144:147], a[168:171], 0
    buffer_load_dwordx4 a[32:35], v2, s[8:11], s54 offen offset:2048 sc1
    v_and_b32 v63, 0xffff0000, v52
    v_fmac_f32 v73, v62, v63
    v_mfma_f32_16x16x32_bf16 v[216:219], a[148:151], a[168:171], 0
    v_lshlrev_b32 v234, 16, v33
    v_lshlrev_b32 v62, 16, v43
    v_lshlrev_b32 v63, 16, v53
    v_mfma_f32_16x16x32_bf16 v[220:223], a[152:155], a[168:171], 0
    v_fmac_f32 v74, v62, v63
    v_and_b32 v235, 0xffff0000, v33
    s_waitcnt vmcnt(24)
    v_mfma_f32_16x16x32_bf16 v[144:147], a[172:175], a[192:195], v[144:147]
    buffer_load_dwordx4 a[36:39], v2, s[8:11], s54 offen offset:3072 sc1
    v_and_b32 v62, 0xffff0000, v43
    v_and_b32 v63, 0xffff0000, v53
    v_mfma_f32_16x16x32_bf16 v[148:151], a[176:179], a[192:195], v[148:151]
    buffer_load_dwordx4 a[40:43], v3, s[8:11], s54 offen offset:0 sc1
    v_fmac_f32 v75, v62, v63
    v_lshlrev_b32 v236, 16, v34
    v_mfma_f32_16x16x32_bf16 v[152:155], a[180:183], a[192:195], v[152:155]
    s_add_u32 s55, s53, 16384
    buffer_load_dwordx4 a[44:47], v4, s[8:11], s55 offen sc1
    v_lshlrev_b32 v62, 16, v44
    v_mfma_f32_16x16x32_bf16 v[156:159], a[184:187], a[192:195], v[156:159]
    buffer_load_dwordx4 a[48:51], v5, s[8:11], s55 offen sc1
    v_lshlrev_b32 v63, 16, v54
    v_fmac_f32 v76, v62, v63
    v_mfma_f32_16x16x32_bf16 v[160:163], a[188:191], a[192:195], v[160:163]
    buffer_load_dwordx4 a[52:55], v6, s[8:11], s55 offen sc1
    v_and_b32 v237, 0xffff0000, v34
    s_waitcnt vmcnt(28)
    v_mfma_f32_16x16x32_bf16 v[164:167], a[172:175], a[196:199], v[164:167]
    buffer_load_dwordx4 a[56:59], v7, s[8:11], s55 offen sc1
    v_and_b32 v62, 0xffff0000, v44
    v_and_b32 v63, 0xffff0000, v54
    v_mfma_f32_16x16x32_bf16 v[168:171], a[176:179], a[196:199], v[168:171]
    v_fmac_f32 v77, v62, v63
    v_lshlrev_b32 v238, 16, v35
    v_lshlrev_b32 v62, 16, v45
    v_mfma_f32_16x16x32_bf16 v[172:175], a[180:183], a[196:199], v[172:175]
    v_lshlrev_b32 v63, 16, v55
    v_fmac_f32 v78, v62, v63
    v_and_b32 v239, 0xffff0000, v35
    v_mfma_f32_16x16x32_bf16 v[176:179], a[184:187], a[196:199], v[176:179]
    v_and_b32 v62, 0xffff0000, v45
    v_and_b32 v63, 0xffff0000, v55
    v_fmac_f32 v79, v62, v63
    v_mfma_f32_16x16x32_bf16 v[180:183], a[188:191], a[196:199], v[180:183]
    s_add_u32 s54, s51, 25600
    buffer_load_dwordx4 a[60:63], v2, s[8:11], s54 offen offset:0 sc1
    s_waitcnt vmcnt(29)
    v_mfma_f32_16x16x32_bf16 v[184:187], a[172:175], a[200:203], v[184:187]
    v_lshlrev_b32 v240, 16, v36
    v_lshlrev_b32 v62, 16, v46
    v_lshlrev_b32 v63, 16, v56
    v_mfma_f32_16x16x32_bf16 v[188:191], a[176:179], a[200:203], v[188:191]
    v_fmac_f32 v80, v62, v63
    v_and_b32 v241, 0xffff0000, v36
    v_and_b32 v62, 0xffff0000, v46
    v_mfma_f32_16x16x32_bf16 v[192:195], a[180:183], a[200:203], v[192:195]
    v_and_b32 v63, 0xffff0000, v56
    v_fmac_f32 v81, v62, v63
    v_lshlrev_b32 v242, 16, v37
    v_mfma_f32_16x16x32_bf16 v[196:199], a[184:187], a[200:203], v[196:199]
    buffer_load_dwordx4 a[64:67], v2, s[8:11], s54 offen offset:1024 sc1
    v_lshlrev_b32 v62, 16, v47
    v_lshlrev_b32 v63, 16, v57
    v_mfma_f32_16x16x32_bf16 v[200:203], a[188:191], a[200:203], v[200:203]
    v_fmac_f32 v82, v62, v63
    v_and_b32 v243, 0xffff0000, v37
    s_waitcnt vmcnt(29)
    v_mfma_f32_16x16x32_bf16 v[204:207], a[172:175], a[204:207], v[204:207]
    v_and_b32 v62, 0xffff0000, v47
    v_and_b32 v63, 0xffff0000, v57
    v_fmac_f32 v83, v62, v63
    v_mfma_f32_16x16x32_bf16 v[208:211], a[176:179], a[204:207], v[208:211]
    ds_write_b128 v14, v[84:87] offset:0
    ds_write_b128 v14, v[88:91] offset:1024
    ds_write_b128 v14, v[92:95] offset:2048
    v_mfma_f32_16x16x32_bf16 v[212:215], a[180:183], a[204:207], v[212:215]
    buffer_load_dwordx4 a[68:71], v2, s[8:11], s54 offen offset:2048 sc1
    ds_write_b128 v14, v[96:99] offset:3072
    ds_write_b128 v14, v[100:103] offset:4096
    v_mfma_f32_16x16x32_bf16 v[216:219], a[184:187], a[204:207], v[216:219]
    ds_write_b128 v15, v[104:107] offset:0
    ds_write_b128 v15, v[108:111] offset:1024
    ds_write_b128 v15, v[112:115] offset:2048
    v_mfma_f32_16x16x32_bf16 v[220:223], a[188:191], a[204:207], v[220:223]
    ds_write_b128 v15, v[116:119] offset:3072
    ds_write_b128 v15, v[120:123] offset:4096
    s_waitcnt vmcnt(24)
    v_mfma_f32_16x16x32_bf16 v[144:147], a[208:211], a[228:231], v[144:147]
    buffer_load_dwordx4 a[72:75], v2, s[8:11], s54 offen offset:3072 sc1
    ds_write_b128 v16, v[124:127] offset:0
    ds_write_b128 v16, v[128:131] offset:1024
    v_mfma_f32_16x16x32_bf16 v[148:151], a[212:215], a[228:231], v[148:151]
    buffer_load_dwordx4 a[76:79], v3, s[8:11], s54 offen offset:0 sc1
    ds_write_b128 v16, v[132:135] offset:2048
    ds_write_b128 v16, v[136:139] offset:3072
    v_mfma_f32_16x16x32_bf16 v[152:155], a[216:219], a[228:231], v[152:155]
    s_add_u32 s55, s53, 20480
    buffer_load_dwordx4 a[80:83], v4, s[8:11], s55 offen sc1
    ds_write_b128 v16, v[140:143] offset:4096
    v_mfma_f32_16x16x32_bf16 v[156:159], a[220:223], a[228:231], v[156:159]
    buffer_load_dwordx4 a[84:87], v5, s[8:11], s55 offen sc1
    v_mfma_f32_16x16x32_bf16 v[160:163], a[224:227], a[228:231], v[160:163]
    buffer_load_dwordx4 a[88:91], v6, s[8:11], s55 offen sc1
    s_waitcnt vmcnt(28)
    v_mfma_f32_16x16x32_bf16 v[164:167], a[208:211], a[232:235], v[164:167]
    buffer_load_dwordx4 a[92:95], v7, s[8:11], s55 offen sc1
    v_mfma_f32_16x16x32_bf16 v[168:171], a[212:215], a[232:235], v[168:171]
    v_mfma_f32_16x16x32_bf16 v[172:175], a[216:219], a[232:235], v[172:175]
    v_mfma_f32_16x16x32_bf16 v[176:179], a[220:223], a[232:235], v[176:179]
    v_mfma_f32_16x16x32_bf16 v[180:183], a[224:227], a[232:235], v[180:183]
    s_add_u32 s54, s51, 30720
    buffer_load_dwordx4 a[96:99], v2, s[8:11], s54 offen offset:0 sc1
    s_waitcnt vmcnt(29)
    v_mfma_f32_16x16x32_bf16 v[184:187], a[208:211], a[236:239], v[184:187]
    v_mfma_f32_16x16x32_bf16 v[188:191], a[212:215], a[236:239], v[188:191]
    v_mfma_f32_16x16x32_bf16 v[192:195], a[216:219], a[236:239], v[192:195]
    v_mfma_f32_16x16x32_bf16 v[196:199], a[220:223], a[236:239], v[196:199]
    buffer_load_dwordx4 a[100:103], v2, s[8:11], s54 offen offset:1024 sc1
    v_mfma_f32_16x16x32_bf16 v[200:203], a[224:227], a[236:239], v[200:203]
    s_waitcnt vmcnt(29)
    v_mfma_f32_16x16x32_bf16 v[204:207], a[208:211], a[240:243], v[204:207]
    v_mfma_f32_16x16x32_bf16 v[208:211], a[212:215], a[240:243], v[208:211]
    v_mfma_f32_16x16x32_bf16 v[212:215], a[216:219], a[240:243], v[212:215]
    buffer_load_dwordx4 a[104:107], v2, s[8:11], s54 offen offset:2048 sc1
    v_mfma_f32_16x16x32_bf16 v[216:219], a[220:223], a[240:243], v[216:219]
    v_mfma_f32_16x16x32_bf16 v[220:223], a[224:227], a[240:243], v[220:223]
    s_waitcnt vmcnt(24)
    v_mfma_f32_16x16x32_bf16 v[144:147], a[244:247], a[8:11], v[144:147]
    buffer_load_dwordx4 a[108:111], v2, s[8:11], s54 offen offset:3072 sc1
    v_mfma_f32_16x16x32_bf16 v[148:151], a[248:251], a[8:11], v[148:151]
    buffer_load_dwordx4 a[112:115], v3, s[8:11], s54 offen offset:0 sc1
    v_mfma_f32_16x16x32_bf16 v[152:155], a[252:255], a[8:11], v[152:155]
    s_add_u32 s55, s53, 24576
    buffer_load_dwordx4 a[116:119], v4, s[8:11], s55 offen sc1
    v_mfma_f32_16x16x32_bf16 v[156:159], a[0:3], a[8:11], v[156:159]
    buffer_load_dwordx4 a[120:123], v5, s[8:11], s55 offen sc1
    v_mfma_f32_16x16x32_bf16 v[160:163], a[4:7], a[8:11], v[160:163]
    buffer_load_dwordx4 a[124:127], v6, s[8:11], s55 offen sc1
    s_waitcnt vmcnt(28)
    v_mfma_f32_16x16x32_bf16 v[164:167], a[244:247], a[12:15], v[164:167]
    buffer_load_dwordx4 a[128:131], v7, s[8:11], s55 offen sc1
    v_mfma_f32_16x16x32_bf16 v[168:171], a[248:251], a[12:15], v[168:171]
    v_mfma_f32_16x16x32_bf16 v[172:175], a[252:255], a[12:15], v[172:175]
    v_mfma_f32_16x16x32_bf16 v[176:179], a[0:3], a[12:15], v[176:179]
    v_mfma_f32_16x16x32_bf16 v[180:183], a[4:7], a[12:15], v[180:183]
    s_add_u32 s54, s51, 35840
    buffer_load_dwordx4 a[132:135], v2, s[8:11], s54 offen offset:0 sc1
    s_waitcnt vmcnt(29)
    v_mfma_f32_16x16x32_bf16 v[184:187], a[244:247], a[16:19], v[184:187]
    v_mfma_f32_16x16x32_bf16 v[188:191], a[248:251], a[16:19], v[188:191]
    v_mfma_f32_16x16x32_bf16 v[192:195], a[252:255], a[16:19], v[192:195]
    v_mfma_f32_16x16x32_bf16 v[196:199], a[0:3], a[16:19], v[196:199]
    buffer_load_dwordx4 a[156:159], v2, s[8:11], s54 offen offset:1024 sc1
    v_mfma_f32_16x16x32_bf16 v[200:203], a[4:7], a[16:19], v[200:203]
    s_waitcnt vmcnt(29)
    v_mfma_f32_16x16x32_bf16 v[204:207], a[244:247], a[20:23], v[204:207]
    v_mfma_f32_16x16x32_bf16 v[208:211], a[248:251], a[20:23], v[208:211]
    v_mfma_f32_16x16x32_bf16 v[212:215], a[252:255], a[20:23], v[212:215]
    buffer_load_dwordx4 a[160:163], v2, s[8:11], s54 offen offset:2048 sc1
    v_mfma_f32_16x16x32_bf16 v[216:219], a[0:3], a[20:23], v[216:219]
    v_mfma_f32_16x16x32_bf16 v[220:223], a[4:7], a[20:23], v[220:223]
    s_waitcnt vmcnt(24)
    v_mfma_f32_16x16x32_bf16 v[144:147], a[24:27], a[44:47], v[144:147]
    buffer_load_dwordx4 a[164:167], v2, s[8:11], s54 offen offset:3072 sc1
    v_mfma_f32_16x16x32_bf16 v[148:151], a[28:31], a[44:47], v[148:151]
    buffer_load_dwordx4 a[136:139], v3, s[8:11], s54 offen offset:0 sc1
    v_mfma_f32_16x16x32_bf16 v[152:155], a[32:35], a[44:47], v[152:155]
    s_add_u32 s55, s53, 28672
    buffer_load_dwordx4 a[140:143], v4, s[8:11], s55 offen sc1
    v_mfma_f32_16x16x32_bf16 v[156:159], a[36:39], a[44:47], v[156:159]
    buffer_load_dwordx4 a[144:147], v5, s[8:11], s55 offen sc1
    v_mfma_f32_16x16x32_bf16 v[160:163], a[40:43], a[44:47], v[160:163]
    buffer_load_dwordx4 a[148:151], v6, s[8:11], s55 offen sc1
    s_waitcnt vmcnt(28)
    v_mfma_f32_16x16x32_bf16 v[164:167], a[24:27], a[48:51], v[164:167]
    buffer_load_dwordx4 a[152:155], v7, s[8:11], s55 offen sc1
    v_mfma_f32_16x16x32_bf16 v[168:171], a[28:31], a[48:51], v[168:171]
    v_mfma_f32_16x16x32_bf16 v[172:175], a[32:35], a[48:51], v[172:175]
    v_mfma_f32_16x16x32_bf16 v[176:179], a[36:39], a[48:51], v[176:179]
    v_mfma_f32_16x16x32_bf16 v[180:183], a[40:43], a[48:51], v[180:183]
    s_add_u32 s54, s51, 40960
    buffer_load_dwordx4 a[168:171], v2, s[8:11], s54 offen offset:0 sc1
    s_waitcnt vmcnt(29)
    v_mfma_f32_16x16x32_bf16 v[184:187], a[24:27], a[52:55], v[184:187]
    v_mfma_f32_16x16x32_bf16 v[188:191], a[28:31], a[52:55], v[188:191]
    v_mfma_f32_16x16x32_bf16 v[192:195], a[32:35], a[52:55], v[192:195]
    v_mfma_f32_16x16x32_bf16 v[196:199], a[36:39], a[52:55], v[196:199]
    buffer_load_dwordx4 a[192:195], v2, s[8:11], s54 offen offset:1024 sc1
    v_mfma_f32_16x16x32_bf16 v[200:203], a[40:43], a[52:55], v[200:203]
    s_waitcnt vmcnt(29)
    v_mfma_f32_16x16x32_bf16 v[204:207], a[24:27], a[56:59], v[204:207]
    v_mfma_f32_16x16x32_bf16 v[208:211], a[28:31], a[56:59], v[208:211]
    v_mfma_f32_16x16x32_bf16 v[212:215], a[32:35], a[56:59], v[212:215]
    buffer_load_dwordx4 a[196:199], v2, s[8:11], s54 offen offset:2048 sc1
    v_mfma_f32_16x16x32_bf16 v[216:219], a[36:39], a[56:59], v[216:219]
    v_mfma_f32_16x16x32_bf16 v[220:223], a[40:43], a[56:59], v[220:223]
    s_waitcnt vmcnt(24)
    v_mfma_f32_16x16x32_bf16 v[144:147], a[60:63], a[80:83], v[144:147]
    buffer_load_dwordx4 a[200:203], v2, s[8:11], s54 offen offset:3072 sc1
    v_mfma_f32_16x16x32_bf16 v[148:151], a[64:67], a[80:83], v[148:151]
    buffer_load_dwordx4 a[172:175], v3, s[8:11], s54 offen offset:0 sc1
    v_mfma_f32_16x16x32_bf16 v[152:155], a[68:71], a[80:83], v[152:155]
    s_add_u32 s55, s53, 32768
    buffer_load_dwordx4 a[176:179], v4, s[8:11], s55 offen sc1
    v_mfma_f32_16x16x32_bf16 v[156:159], a[72:75], a[80:83], v[156:159]
    buffer_load_dwordx4 a[180:183], v5, s[8:11], s55 offen sc1
    v_mfma_f32_16x16x32_bf16 v[160:163], a[76:79], a[80:83], v[160:163]
    buffer_load_dwordx4 a[184:187], v6, s[8:11], s55 offen sc1
    s_waitcnt vmcnt(28)
    v_mfma_f32_16x16x32_bf16 v[164:167], a[60:63], a[84:87], v[164:167]
    buffer_load_dwordx4 a[188:191], v7, s[8:11], s55 offen sc1
    v_mfma_f32_16x16x32_bf16 v[168:171], a[64:67], a[84:87], v[168:171]
    v_mfma_f32_16x16x32_bf16 v[172:175], a[68:71], a[84:87], v[172:175]
    v_mfma_f32_16x16x32_bf16 v[176:179], a[72:75], a[84:87], v[176:179]
    v_mfma_f32_16x16x32_bf16 v[180:183], a[76:79], a[84:87], v[180:183]
    s_add_u32 s54, s51, 46080
    buffer_load_dwordx4 a[204:207], v2, s[8:11], s54 offen offset:0 sc1
    s_waitcnt vmcnt(29)
    v_mfma_f32_16x16x32_bf16 v[184:187], a[60:63], a[88:91], v[184:187]
    v_mfma_f32_16x16x32_bf16 v[188:191], a[64:67], a[88:91], v[188:191]
    v_mfma_f32_16x16x32_bf16 v[192:195], a[68:71], a[88:91], v[192:195]
    v_mfma_f32_16x16x32_bf16 v[196:199], a[72:75], a[88:91], v[196:199]
    buffer_load_dwordx4 a[228:231], v2, s[8:11], s54 offen offset:1024 sc1
    v_mfma_f32_16x16x32_bf16 v[200:203], a[76:79], a[88:91], v[200:203]
    s_waitcnt vmcnt(29)
    v_mfma_f32_16x16x32_bf16 v[204:207], a[60:63], a[92:95], v[204:207]
    v_mfma_f32_16x16x32_bf16 v[208:211], a[64:67], a[92:95], v[208:211]
    v_mfma_f32_16x16x32_bf16 v[212:215], a[68:71], a[92:95], v[212:215]
    buffer_load_dwordx4 a[232:235], v2, s[8:11], s54 offen offset:2048 sc1
    v_mfma_f32_16x16x32_bf16 v[216:219], a[72:75], a[92:95], v[216:219]
    v_mfma_f32_16x16x32_bf16 v[220:223], a[76:79], a[92:95], v[220:223]
    s_waitcnt lgkmcnt(0)
    s_barrier
    s_waitcnt vmcnt(24)
    v_mfma_f32_16x16x32_bf16 v[144:147], a[96:99], a[116:119], v[144:147]
    buffer_load_dwordx4 a[236:239], v2, s[8:11], s54 offen offset:3072 sc1
    ds_read_b128 v[84:87], v17 offset:0
    ds_read_b128 v[88:91], v17 offset:1024
    v_mfma_f32_16x16x32_bf16 v[148:151], a[100:103], a[116:119], v[148:151]
    buffer_load_dwordx4 a[208:211], v3, s[8:11], s54 offen offset:0 sc1
    ds_read_b128 v[92:95], v17 offset:2048
    ds_read_b128 v[96:99], v17 offset:3072
    v_mfma_f32_16x16x32_bf16 v[152:155], a[104:107], a[116:119], v[152:155]
    s_add_u32 s55, s53, 36864
    buffer_load_dwordx4 a[212:215], v4, s[8:11], s55 offen sc1
    ds_read_b128 v[100:103], v17 offset:4096
    v_mfma_f32_16x16x32_bf16 v[156:159], a[108:111], a[116:119], v[156:159]
    buffer_load_dwordx4 a[216:219], v5, s[8:11], s55 offen sc1
    ds_read_b128 v[104:107], v17 offset:5120
    ds_read_b128 v[108:111], v17 offset:6144
    v_mfma_f32_16x16x32_bf16 v[160:163], a[112:115], a[116:119], v[160:163]
    buffer_load_dwordx4 a[220:223], v6, s[8:11], s55 offen sc1
    ds_read_b128 v[112:115], v17 offset:7168
    s_waitcnt vmcnt(28)
    v_mfma_f32_16x16x32_bf16 v[164:167], a[96:99], a[120:123], v[164:167]
    buffer_load_dwordx4 a[224:227], v7, s[8:11], s55 offen sc1
    ds_read_b128 v[116:119], v17 offset:8192
    ds_read_b128 v[120:123], v17 offset:9216
    v_mfma_f32_16x16x32_bf16 v[168:171], a[100:103], a[120:123], v[168:171]
    ds_read_b128 v[124:127], v17 offset:10240
    ds_read_b128 v[128:131], v17 offset:11264
    ds_read_b128 v[132:135], v17 offset:12288
    v_mfma_f32_16x16x32_bf16 v[172:175], a[104:107], a[120:123], v[172:175]
    ds_read_b128 v[136:139], v17 offset:13312
    ds_read_b128 v[140:143], v17 offset:14336
    s_waitcnt lgkmcnt(14)
    v_add_f32 v64, v64, v84
    v_mfma_f32_16x16x32_bf16 v[176:179], a[108:111], a[120:123], v[176:179]
    v_add_f32 v65, v65, v85
    v_add_f32 v66, v66, v86
    v_add_f32 v67, v67, v87
    v_mfma_f32_16x16x32_bf16 v[180:183], a[112:115], a[120:123], v[180:183]
    s_add_u32 s54, s51, 51200
    buffer_load_dwordx4 a[240:243], v2, s[8:11], s54 offen offset:0 sc1
    s_waitcnt vmcnt(29)
    v_mfma_f32_16x16x32_bf16 v[184:187], a[96:99], a[124:127], v[184:187]
    s_waitcnt lgkmcnt(13)
    v_add_f32 v68, v68, v88
    v_add_f32 v69, v69, v89
    v_add_f32 v70, v70, v90
    v_mfma_f32_16x16x32_bf16 v[188:191], a[100:103], a[124:127], v[188:191]
    v_add_f32 v71, v71, v91
    s_waitcnt lgkmcnt(12)
    v_add_f32 v72, v72, v92
    v_add_f32 v73, v73, v93
    v_mfma_f32_16x16x32_bf16 v[192:195], a[104:107], a[124:127], v[192:195]
    v_add_f32 v74, v74, v94
    v_add_f32 v75, v75, v95
    s_waitcnt lgkmcnt(11)
    v_add_f32 v76, v76, v96
    v_mfma_f32_16x16x32_bf16 v[196:199], a[108:111], a[124:127], v[196:199]
    buffer_load_dwordx4 a[8:11], v2, s[8:11], s54 offen offset:1024 sc1
    v_add_f32 v77, v77, v97
    v_add_f32 v78, v78, v98
    v_mfma_f32_16x16x32_bf16 v[200:203], a[112:115], a[124:127], v[200:203]
    v_add_f32 v79, v79, v99
    s_waitcnt lgkmcnt(10)
    v_add_f32 v80, v80, v100
    s_waitcnt vmcnt(29)
    v_mfma_f32_16x16x32_bf16 v[204:207], a[96:99], a[128:131], v[204:207]
    v_add_f32 v81, v81, v101
    v_add_f32 v82, v82, v102
    v_add_f32 v83, v83, v103
    v_mfma_f32_16x16x32_bf16 v[208:211], a[100:103], a[128:131], v[208:211]
    s_waitcnt lgkmcnt(9)
    v_add_f32 v64, v64, v104
    v_add_f32 v65, v65, v105
    v_add_f32 v66, v66, v106
    v_mfma_f32_16x16x32_bf16 v[212:215], a[104:107], a[128:131], v[212:215]
    buffer_load_dwordx4 a[12:15], v2, s[8:11], s54 offen offset:2048 sc1
    v_add_f32 v67, v67, v107
    s_waitcnt lgkmcnt(8)
    v_add_f32 v68, v68, v108
    v_mfma_f32_16x16x32_bf16 v[216:219], a[108:111], a[128:131], v[216:219]
    v_add_f32 v69, v69, v109
    v_add_f32 v70, v70, v110
    v_add_f32 v71, v71, v111
    v_mfma_f32_16x16x32_bf16 v[220:223], a[112:115], a[128:131], v[220:223]
    s_waitcnt lgkmcnt(7)
    v_add_f32 v72, v72, v112
    v_add_f32 v73, v73, v113
    s_waitcnt vmcnt(24)
    v_mfma_f32_16x16x32_bf16 v[144:147], a[132:135], a[140:143], v[144:147]
    buffer_load_dwordx4 a[16:19], v2, s[8:11], s54 offen offset:3072 sc1
    v_add_f32 v74, v74, v114
    v_add_f32 v75, v75, v115
    v_mfma_f32_16x16x32_bf16 v[148:151], a[156:159], a[140:143], v[148:151]
    buffer_load_dwordx4 a[244:247], v3, s[8:11], s54 offen offset:0 sc1
    s_waitcnt lgkmcnt(6)
    v_add_f32 v76, v76, v116
    v_add_f32 v77, v77, v117
    v_mfma_f32_16x16x32_bf16 v[152:155], a[160:163], a[140:143], v[152:155]
    s_add_u32 s54, s51, 56320
    buffer_load_dwordx4 a[248:251], v2, s[8:11], s54 offen offset:0 sc1
    v_add_f32 v78, v78, v118
    v_mfma_f32_16x16x32_bf16 v[156:159], a[164:167], a[140:143], v[156:159]
    buffer_load_dwordx4 a[252:255], v2, s[8:11], s54 offen offset:1024 sc1
    v_add_f32 v79, v79, v119
    s_waitcnt lgkmcnt(5)
    v_add_f32 v80, v80, v120
    v_mfma_f32_16x16x32_bf16 v[160:163], a[136:139], a[140:143], v[160:163]
    buffer_load_dwordx4 a[0:3], v2, s[8:11], s54 offen offset:2048 sc1
    v_add_f32 v81, v81, v121
    s_waitcnt vmcnt(28)
    v_mfma_f32_16x16x32_bf16 v[164:167], a[132:135], a[144:147], v[164:167]
    buffer_load_dwordx4 a[4:7], v2, s[8:11], s54 offen offset:3072 sc1
    v_add_f32 v82, v82, v122
    v_add_f32 v83, v83, v123
    v_mfma_f32_16x16x32_bf16 v[168:171], a[156:159], a[144:147], v[168:171]
    buffer_load_dwordx4 a[20:23], v3, s[8:11], s54 offen offset:0 sc1
    s_waitcnt lgkmcnt(4)
    v_add_f32 v64, v64, v124
    v_add_f32 v65, v65, v125
    v_mfma_f32_16x16x32_bf16 v[172:175], a[160:163], a[144:147], v[172:175]
    s_add_u32 s55, s53, 40960
    buffer_load_dwordx4 a[44:47], v5, s[8:11], s55 offen sc1
    v_add_f32 v66, v66, v126
    v_mfma_f32_16x16x32_bf16 v[176:179], a[164:167], a[144:147], v[176:179]
    s_add_u32 s55, s53, 45056
    buffer_load_dwordx4 a[48:51], v5, s[8:11], s55 offen sc1
    v_add_f32 v67, v67, v127
    v_mfma_f32_16x16x32_bf16 v[180:183], a[136:139], a[144:147], v[180:183]
    s_add_u32 s55, s53, 40960
    buffer_load_dwordx4 a[52:55], v6, s[8:11], s55 offen sc1
    s_waitcnt vmcnt(32)
    v_mfma_f32_16x16x32_bf16 v[184:187], a[132:135], a[148:151], v[184:187]
    s_add_u32 s55, s53, 45056
    buffer_load_dwordx4 a[24:27], v6, s[8:11], s55 offen sc1
    s_waitcnt lgkmcnt(3)
    v_add_f32 v68, v68, v128
    v_mfma_f32_16x16x32_bf16 v[188:191], a[156:159], a[148:151], v[188:191]
    v_add_f32 v69, v69, v129
    v_add_f32 v70, v70, v130
    v_add_f32 v71, v71, v131
    v_mfma_f32_16x16x32_bf16 v[192:195], a[160:163], a[148:151], v[192:195]
    s_waitcnt lgkmcnt(2)
    v_add_f32 v72, v72, v132
    v_add_f32 v73, v73, v133
    v_add_f32 v74, v74, v134
    v_mfma_f32_16x16x32_bf16 v[196:199], a[164:167], a[148:151], v[196:199]
    v_add_f32 v75, v75, v135
    s_waitcnt lgkmcnt(1)
    v_add_f32 v76, v76, v136
    v_add_f32 v77, v77, v137
    v_mfma_f32_16x16x32_bf16 v[200:203], a[136:139], a[148:151], v[200:203]
    s_add_u32 s55, s53, 40960
    buffer_load_dwordx4 a[28:31], v7, s[8:11], s55 offen sc1
    s_waitcnt vmcnt(33)
    v_mfma_f32_16x16x32_bf16 v[204:207], a[132:135], a[152:155], v[204:207]
    v_add_f32 v78, v78, v138
    v_add_f32 v79, v79, v139
    s_waitcnt lgkmcnt(0)
    v_add_f32 v80, v80, v140
    v_mfma_f32_16x16x32_bf16 v[208:211], a[156:159], a[152:155], v[208:211]
    v_add_f32 v81, v81, v141
    v_add_f32 v82, v82, v142
    v_add_f32 v83, v83, v143
    v_mfma_f32_16x16x32_bf16 v[212:215], a[160:163], a[152:155], v[212:215]
    v_mfma_f32_16x16x32_bf16 v[216:219], a[164:167], a[152:155], v[216:219]
    s_add_u32 s55, s53, 45056
    buffer_load_dwordx4 a[32:35], v7, s[8:11], s55 offen sc1
    v_mfma_f32_16x16x32_bf16 v[220:223], a[136:139], a[152:155], v[220:223]
    s_waitcnt vmcnt(28)
    v_mfma_f32_16x16x32_bf16 v[144:147], a[168:171], a[176:179], v[144:147]
    s_add_u32 s55, s53, 40960
    buffer_load_dwordx4 a[36:39], v4, s[8:11], s55 offen sc1
    v_mfma_f32_16x16x32_bf16 v[148:151], a[192:195], a[176:179], v[148:151]
    s_add_u32 s55, s53, 45056
    buffer_load_dwordx4 a[40:43], v4, s[8:11], s55 offen sc1
    v_mfma_f32_16x16x32_bf16 v[152:155], a[196:199], a[176:179], v[152:155]
    v_mfma_f32_16x16x32_bf16 v[156:159], a[200:203], a[176:179], v[156:159]
    v_mfma_f32_16x16x32_bf16 v[160:163], a[172:175], a[176:179], v[160:163]
    s_waitcnt vmcnt(29)
    v_mfma_f32_16x16x32_bf16 v[164:167], a[168:171], a[180:183], v[164:167]
    v_mfma_f32_16x16x32_bf16 v[168:171], a[192:195], a[180:183], v[168:171]
    v_mfma_f32_16x16x32_bf16 v[172:175], a[196:199], a[180:183], v[172:175]
    v_mfma_f32_16x16x32_bf16 v[176:179], a[200:203], a[180:183], v[176:179]
    v_mfma_f32_16x16x32_bf16 v[180:183], a[172:175], a[180:183], v[180:183]
    s_waitcnt vmcnt(28)
    v_mfma_f32_16x16x32_bf16 v[184:187], a[168:171], a[184:187], v[184:187]
    v_mfma_f32_16x16x32_bf16 v[188:191], a[192:195], a[184:187], v[188:191]
    v_mfma_f32_16x16x32_bf16 v[192:195], a[196:199], a[184:187], v[192:195]
    v_mfma_f32_16x16x32_bf16 v[196:199], a[200:203], a[184:187], v[196:199]
    v_mfma_f32_16x16x32_bf16 v[200:203], a[172:175], a[184:187], v[200:203]
    s_waitcnt vmcnt(27)
    v_mfma_f32_16x16x32_bf16 v[204:207], a[168:171], a[188:191], v[204:207]
    v_mfma_f32_16x16x32_bf16 v[208:211], a[192:195], a[188:191], v[208:211]
    v_mfma_f32_16x16x32_bf16 v[212:215], a[196:199], a[188:191], v[212:215]
    v_mfma_f32_16x16x32_bf16 v[216:219], a[200:203], a[188:191], v[216:219]
    v_mfma_f32_16x16x32_bf16 v[220:223], a[172:175], a[188:191], v[220:223]
    s_waitcnt vmcnt(21)
    v_mfma_f32_16x16x32_bf16 v[144:147], a[204:207], a[212:215], v[144:147]
    v_mfma_f32_16x16x32_bf16 v[148:151], a[228:231], a[212:215], v[148:151]
    v_mfma_f32_16x16x32_bf16 v[152:155], a[232:235], a[212:215], v[152:155]
    v_mfma_f32_16x16x32_bf16 v[156:159], a[236:239], a[212:215], v[156:159]
    v_mfma_f32_16x16x32_bf16 v[160:163], a[208:211], a[212:215], v[160:163]
    s_waitcnt vmcnt(20)
    v_mfma_f32_16x16x32_bf16 v[164:167], a[204:207], a[216:219], v[164:167]
    v_mfma_f32_16x16x32_bf16 v[168:171], a[228:231], a[216:219], v[168:171]
    v_mfma_f32_16x16x32_bf16 v[172:175], a[232:235], a[216:219], v[172:175]
    v_mfma_f32_16x16x32_bf16 v[176:179], a[236:239], a[216:219], v[176:179]
    v_mfma_f32_16x16x32_bf16 v[180:183], a[208:211], a[216:219], v[180:183]
    s_waitcnt vmcnt(19)
    v_mfma_f32_16x16x32_bf16 v[184:187], a[204:207], a[220:223], v[184:187]
    v_mfma_f32_16x16x32_bf16 v[188:191], a[228:231], a[220:223], v[188:191]
    v_mfma_f32_16x16x32_bf16 v[192:195], a[232:235], a[220:223], v[192:195]
    v_mfma_f32_16x16x32_bf16 v[196:199], a[236:239], a[220:223], v[196:199]
    v_mfma_f32_16x16x32_bf16 v[200:203], a[208:211], a[220:223], v[200:203]
    s_waitcnt vmcnt(18)
    v_mfma_f32_16x16x32_bf16 v[204:207], a[204:207], a[224:227], v[204:207]
    v_mfma_f32_16x16x32_bf16 v[208:211], a[228:231], a[224:227], v[208:211]
    v_mfma_f32_16x16x32_bf16 v[212:215], a[232:235], a[224:227], v[212:215]
    v_mfma_f32_16x16x32_bf16 v[216:219], a[236:239], a[224:227], v[216:219]
    v_mfma_f32_16x16x32_bf16 v[220:223], a[208:211], a[224:227], v[220:223]
    s_waitcnt vmcnt(7)
    v_mfma_f32_16x16x32_bf16 v[164:167], a[240:243], a[44:47], v[164:167]
    v_mfma_f32_16x16x32_bf16 v[168:171], a[8:11], a[44:47], v[168:171]
    v_mfma_f32_16x16x32_bf16 v[172:175], a[12:15], a[44:47], v[172:175]
    v_mfma_f32_16x16x32_bf16 v[176:179], a[16:19], a[44:47], v[176:179]
    v_mfma_f32_16x16x32_bf16 v[180:183], a[244:247], a[44:47], v[180:183]
    s_waitcnt vmcnt(6)
    v_mfma_f32_16x16x32_bf16 v[164:167], a[248:251], a[48:51], v[164:167]
    v_mfma_f32_16x16x32_bf16 v[168:171], a[252:255], a[48:51], v[168:171]
    v_mfma_f32_16x16x32_bf16 v[172:175], a[0:3], a[48:51], v[172:175]
    v_mfma_f32_16x16x32_bf16 v[176:179], a[4:7], a[48:51], v[176:179]
    v_mfma_f32_16x16x32_bf16 v[180:183], a[20:23], a[48:51], v[180:183]
    s_waitcnt vmcnt(5)
    v_mfma_f32_16x16x32_bf16 v[184:187], a[240:243], a[52:55], v[184:187]
    v_mfma_f32_16x16x32_bf16 v[188:191], a[8:11], a[52:55], v[188:191]
    v_mfma_f32_16x16x32_bf16 v[192:195], a[12:15], a[52:55], v[192:195]
    ds_write_b128 v244, v[164:167] offset:0
    v_mfma_f32_16x16x32_bf16 v[196:199], a[16:19], a[52:55], v[196:199]
    ds_write_b128 v244, v[168:171] offset:1024
    v_mfma_f32_16x16x32_bf16 v[200:203], a[244:247], a[52:55], v[200:203]
    ds_write_b128 v244, v[172:175] offset:2048
    s_waitcnt vmcnt(4)
    v_mfma_f32_16x16x32_bf16 v[184:187], a[248:251], a[24:27], v[184:187]
    ds_write_b128 v244, v[176:179] offset:3072
    v_mfma_f32_16x16x32_bf16 v[188:191], a[252:255], a[24:27], v[188:191]
    ds_write_b128 v244, v[180:183] offset:4096
    v_mfma_f32_16x16x32_bf16 v[192:195], a[0:3], a[24:27], v[192:195]
    v_mfma_f32_16x16x32_bf16 v[196:199], a[4:7], a[24:27], v[196:199]
    v_mfma_f32_16x16x32_bf16 v[200:203], a[20:23], a[24:27], v[200:203]
    s_waitcnt vmcnt(3)
    v_mfma_f32_16x16x32_bf16 v[204:207], a[240:243], a[28:31], v[204:207]
    v_mfma_f32_16x16x32_bf16 v[208:211], a[8:11], a[28:31], v[208:211]
    v_mfma_f32_16x16x32_bf16 v[212:215], a[12:15], a[28:31], v[212:215]
    ds_write_b128 v245, v[184:187] offset:0
    v_mfma_f32_16x16x32_bf16 v[216:219], a[16:19], a[28:31], v[216:219]
    ds_write_b128 v245, v[188:191] offset:1024
    v_mfma_f32_16x16x32_bf16 v[220:223], a[244:247], a[28:31], v[220:223]
    ds_write_b128 v245, v[192:195] offset:2048
    s_waitcnt vmcnt(2)
    v_mfma_f32_16x16x32_bf16 v[204:207], a[248:251], a[32:35], v[204:207]
    ds_write_b128 v245, v[196:199] offset:3072
    v_mfma_f32_16x16x32_bf16 v[208:211], a[252:255], a[32:35], v[208:211]
    ds_write_b128 v245, v[200:203] offset:4096
    v_mfma_f32_16x16x32_bf16 v[212:215], a[0:3], a[32:35], v[212:215]
    v_mfma_f32_16x16x32_bf16 v[216:219], a[4:7], a[32:35], v[216:219]
    v_mfma_f32_16x16x32_bf16 v[220:223], a[20:23], a[32:35], v[220:223]
    s_waitcnt vmcnt(1)
    v_mfma_f32_16x16x32_bf16 v[144:147], a[240:243], a[36:39], v[144:147]
    v_mfma_f32_16x16x32_bf16 v[148:151], a[8:11], a[36:39], v[148:151]
    v_mfma_f32_16x16x32_bf16 v[152:155], a[12:15], a[36:39], v[152:155]
    ds_write_b128 v246, v[204:207] offset:0
    v_mfma_f32_16x16x32_bf16 v[156:159], a[16:19], a[36:39], v[156:159]
    ds_write_b128 v246, v[208:211] offset:1024
    v_mfma_f32_16x16x32_bf16 v[160:163], a[244:247], a[36:39], v[160:163]
    ds_write_b128 v246, v[212:215] offset:2048
    s_waitcnt vmcnt(0)
    v_mfma_f32_16x16x32_bf16 v[144:147], a[248:251], a[40:43], v[144:147]
    ds_write_b128 v246, v[216:219] offset:3072
    v_mfma_f32_16x16x32_bf16 v[148:151], a[252:255], a[40:43], v[148:151]
    ds_write_b128 v246, v[220:223] offset:4096
    v_mfma_f32_16x16x32_bf16 v[152:155], a[0:3], a[40:43], v[152:155]
    v_mfma_f32_16x16x32_bf16 v[156:159], a[4:7], a[40:43], v[156:159]
    v_mfma_f32_16x16x32_bf16 v[160:163], a[20:23], a[40:43], v[160:163]
    s_lshl_b32 s37, s48, 3
    s_add_u32 s37, s37, s49
    s_cmp_eq_u32 s37, 248
    s_cselect_b32 s37, 0, 0x80000000
    s_add_u32 s37, s37, 0x11f2000
    v_mov_b32 v62, s37
    v_mov_b32 v63, s43
    buffer_store_dword v63, v62, s[8:11], 0 offen sc1
    s_waitcnt lgkmcnt(0)
    s_barrier
    ds_read_b128 v[84:87], v247 offset:0
    ds_read_b128 v[104:107], v247 offset:5120
    ds_read_b128 v[124:127], v247 offset:10240
    ds_read_b128 v[88:91], v247 offset:1024
    ds_read_b128 v[108:111], v247 offset:6144
    ds_read_b128 v[128:131], v247 offset:11264
    ds_read_b128 v[92:95], v247 offset:2048
    ds_read_b128 v[112:115], v247 offset:7168
    ds_read_b128 v[132:135], v247 offset:12288
    ds_read_b128 v[96:99], v247 offset:3072
    ds_read_b128 v[116:119], v247 offset:8192
    ds_read_b128 v[136:139], v247 offset:13312
    ds_read_b128 v[100:103], v247 offset:4096
    ds_read_b128 v[120:123], v247 offset:9216
    ds_read_b128 v[140:143], v247 offset:14336
    s_waitcnt lgkmcnt(13)
    v_pk_add_f32 v[84:85], v[84:85], v[104:105]
    v_pk_add_f32 v[86:87], v[86:87], v[106:107]
    s_waitcnt lgkmcnt(12)
    v_pk_add_f32 v[144:145], v[144:145], v[124:125]
    v_pk_add_f32 v[146:147], v[146:147], v[126:127]
    v_pk_add_f32 v[144:145], v[144:145], v[84:85]
    v_pk_add_f32 v[146:147], v[146:147], v[86:87]
    v_pk_mul_f32 v[164:165], v[144:145], v[252:253]
    v_pk_mul_f32 v[166:167], v[146:147], v[252:253]
    v_exp_f32 v164, v164
    v_exp_f32 v165, v165
    v_exp_f32 v166, v166
    v_exp_f32 v167, v167
    s_waitcnt lgkmcnt(10)
    v_pk_add_f32 v[88:89], v[88:89], v[108:109]
    v_pk_add_f32 v[90:91], v[90:91], v[110:111]
    s_waitcnt lgkmcnt(9)
    v_pk_add_f32 v[148:149], v[148:149], v[128:129]
    v_pk_add_f32 v[150:151], v[150:151], v[130:131]
    v_pk_add_f32 v[148:149], v[148:149], v[88:89]
    v_pk_add_f32 v[150:151], v[150:151], v[90:91]
    v_pk_mul_f32 v[168:169], v[148:149], v[252:253]
    v_pk_mul_f32 v[170:171], v[150:151], v[252:253]
    v_pk_add_f32 v[164:165], v[164:165], v[250:251]
    v_pk_add_f32 v[166:167], v[166:167], v[250:251]
    v_pk_mul_f32 v[144:145], v[144:145], v[64:65]
    v_pk_mul_f32 v[146:147], v[146:147], v[66:67]
    v_rcp_f32 v164, v164
    v_rcp_f32 v165, v165
    v_rcp_f32 v166, v166
    v_rcp_f32 v167, v167
    v_exp_f32 v168, v168
    v_exp_f32 v169, v169
    v_exp_f32 v170, v170
    v_exp_f32 v171, v171
    s_waitcnt lgkmcnt(7)
    v_pk_add_f32 v[92:93], v[92:93], v[112:113]
    v_pk_add_f32 v[94:95], v[94:95], v[114:115]
    s_waitcnt lgkmcnt(6)
    v_pk_add_f32 v[152:153], v[152:153], v[132:133]
    v_pk_add_f32 v[154:155], v[154:155], v[134:135]
    v_pk_add_f32 v[152:153], v[152:153], v[92:93]
    v_pk_add_f32 v[154:155], v[154:155], v[94:95]
    v_pk_mul_f32 v[172:173], v[152:153], v[252:253]
    v_pk_mul_f32 v[174:175], v[154:155], v[252:253]
    v_pk_add_f32 v[168:169], v[168:169], v[250:251]
    v_pk_add_f32 v[170:171], v[170:171], v[250:251]
    v_pk_mul_f32 v[148:149], v[148:149], v[68:69]
    v_pk_mul_f32 v[150:151], v[150:151], v[70:71]
    v_rcp_f32 v168, v168
    v_rcp_f32 v169, v169
    v_rcp_f32 v170, v170
    v_rcp_f32 v171, v171
    v_pk_fma_f32 v[224:225], v[144:145], v[164:165], v[224:225]
    v_pk_fma_f32 v[226:227], v[146:147], v[166:167], v[226:227]
    buffer_store_dwordx4 v[224:227], v20, s[12:15], 0 offen offset:0 sc1
    v_exp_f32 v172, v172
    v_exp_f32 v173, v173
    v_exp_f32 v174, v174
    v_exp_f32 v175, v175
    s_waitcnt lgkmcnt(4)
    v_pk_add_f32 v[96:97], v[96:97], v[116:117]
    v_pk_add_f32 v[98:99], v[98:99], v[118:119]
    s_waitcnt lgkmcnt(3)
    v_pk_add_f32 v[156:157], v[156:157], v[136:137]
    v_pk_add_f32 v[158:159], v[158:159], v[138:139]
    v_pk_add_f32 v[156:157], v[156:157], v[96:97]
    v_pk_add_f32 v[158:159], v[158:159], v[98:99]
    v_pk_mul_f32 v[176:177], v[156:157], v[252:253]
    v_pk_mul_f32 v[178:179], v[158:159], v[252:253]
    v_pk_add_f32 v[172:173], v[172:173], v[250:251]
    v_pk_add_f32 v[174:175], v[174:175], v[250:251]
    v_pk_mul_f32 v[152:153], v[152:153], v[72:73]
    v_pk_mul_f32 v[154:155], v[154:155], v[74:75]
    v_rcp_f32 v172, v172
    v_rcp_f32 v173, v173
    v_rcp_f32 v174, v174
    v_rcp_f32 v175, v175
    v_pk_fma_f32 v[228:229], v[148:149], v[168:169], v[228:229]
    v_pk_fma_f32 v[230:231], v[150:151], v[170:171], v[230:231]
    buffer_store_dwordx4 v[228:231], v20, s[12:15], 0 offen offset:64 sc1
    v_exp_f32 v176, v176
    v_exp_f32 v177, v177
    v_exp_f32 v178, v178
    v_exp_f32 v179, v179
    s_waitcnt lgkmcnt(1)
    v_pk_add_f32 v[100:101], v[100:101], v[120:121]
    v_pk_add_f32 v[102:103], v[102:103], v[122:123]
    s_waitcnt lgkmcnt(0)
    v_pk_add_f32 v[160:161], v[160:161], v[140:141]
    v_pk_add_f32 v[162:163], v[162:163], v[142:143]
    v_pk_add_f32 v[160:161], v[160:161], v[100:101]
    v_pk_add_f32 v[162:163], v[162:163], v[102:103]
    v_pk_mul_f32 v[180:181], v[160:161], v[252:253]
    v_pk_mul_f32 v[182:183], v[162:163], v[252:253]
    v_pk_add_f32 v[176:177], v[176:177], v[250:251]
    v_pk_add_f32 v[178:179], v[178:179], v[250:251]
    v_pk_mul_f32 v[156:157], v[156:157], v[76:77]
    v_pk_mul_f32 v[158:159], v[158:159], v[78:79]
    v_rcp_f32 v176, v176
    v_rcp_f32 v177, v177
    v_rcp_f32 v178, v178
    v_rcp_f32 v179, v179
    v_pk_fma_f32 v[232:233], v[152:153], v[172:173], v[232:233]
    v_pk_fma_f32 v[234:235], v[154:155], v[174:175], v[234:235]
    buffer_store_dwordx4 v[232:235], v20, s[12:15], 0 offen offset:128 sc1
    v_exp_f32 v180, v180
    v_exp_f32 v181, v181
    v_exp_f32 v182, v182
    v_exp_f32 v183, v183
    v_pk_add_f32 v[180:181], v[180:181], v[250:251]
    v_pk_add_f32 v[182:183], v[182:183], v[250:251]
    v_pk_mul_f32 v[160:161], v[160:161], v[80:81]
    v_pk_mul_f32 v[162:163], v[162:163], v[82:83]
    v_rcp_f32 v180, v180
    v_rcp_f32 v181, v181
    v_rcp_f32 v182, v182
    v_rcp_f32 v183, v183
    v_pk_fma_f32 v[236:237], v[156:157], v[176:177], v[236:237]
    v_pk_fma_f32 v[238:239], v[158:159], v[178:179], v[238:239]
    buffer_store_dwordx4 v[236:239], v20, s[12:15], 0 offen offset:192 sc1
    v_pk_fma_f32 v[240:241], v[160:161], v[180:181], v[240:241]
    v_pk_fma_f32 v[242:243], v[162:163], v[182:183], v[242:243]
    buffer_store_dwordx4 v[240:243], v20, s[12:15], 0 offen offset:256 sc1
    s_endpgm
K1Q_retry:
    s_add_u32 s44, s44, 1
    s_cmp_gt_u32 s44, 200000
    s_cbranch_scc1 K1Q_back
    buffer_load_dwordx2 v[224:225], v28, s[20:23], 0 offen offset:0 sc1
    buffer_load_dwordx2 v[226:227], v28, s[20:23], 0 offen offset:2048 sc1
    buffer_load_dwordx2 v[228:229], v29, s[20:23], 0 offen offset:0 sc1
    buffer_load_dwordx2 v[230:231], v29, s[20:23], 0 offen offset:2048 sc1
    buffer_load_dwordx2 v[232:233], v30, s[20:23], 0 offen offset:0 sc1
    buffer_load_dwordx2 v[234:235], v30, s[20:23], 0 offen offset:2048 sc1
    buffer_load_dwordx2 v[236:237], v31, s[20:23], 0 offen offset:0 sc1
    buffer_load_dwordx2 v[238:239], v31, s[20:23], 0 offen offset:2048 sc1
    s_waitcnt vmcnt(0)
    v_mov_b32 v26, 0
    v_cmp_eq_u32 s[64:65], s43, v225
    v_cmp_eq_u32 s[66:67], s43, v227
    v_cmp_eq_u32 s[68:69], s43, v229
    v_cmp_eq_u32 s[70:71], s43, v231
    v_cmp_eq_u32 s[72:73], s43, v233
    v_cmp_eq_u32 s[74:75], s43, v235
    v_cmp_eq_u32 s[76:77], s43, v237
    v_cmp_eq_u32 s[78:79], s43, v239
    v_addc_co_u32 v26, vcc, 0, v26, s[64:65]
    v_addc_co_u32 v26, vcc, 0, v26, s[66:67]
    v_addc_co_u32 v26, vcc, 0, v26, s[68:69]
    v_addc_co_u32 v26, vcc, 0, v26, s[70:71]
    v_addc_co_u32 v26, vcc, 0, v26, s[72:73]
    v_addc_co_u32 v26, vcc, 0, v26, s[74:75]
    v_addc_co_u32 v26, vcc, 0, v26, s[76:77]
    v_addc_co_u32 v26, vcc, 0, v26, s[78:79]
    v_cmp_ne_u32 vcc, v26, v25
    s_cbranch_vccnz K1Q_retry
    s_branch K1Q_back
FQ0_retry:
    s_add_u32 s44, s44, 1
    s_cmp_gt_u32 s44, 200000
    s_cbranch_scc1 FQ0_back
    s_load_dwordx16 s[64:79], s[32:33], 0 glc
    s_waitcnt lgkmcnt(0)
    s_cmp_lg_u64 s[64:65], s[28:29]
    s_cbranch_scc1 FQ0_retry
    s_cmp_lg_u64 s[66:67], s[28:29]
    s_cbranch_scc1 FQ0_retry
    s_cmp_lg_u64 s[68:69], s[28:29]
    s_cbranch_scc1 FQ0_retry
    s_cmp_lg_u64 s[70:71], s[28:29]
    s_cbranch_scc1 FQ0_retry
    s_cmp_lg_u64 s[72:73], s[28:29]
    s_cbranch_scc1 FQ0_retry
    s_cmp_lg_u64 s[74:75], s[28:29]
    s_cbranch_scc1 FQ0_retry
    s_cmp_lg_u64 s[76:77], s[28:29]
    s_cbranch_scc1 FQ0_retry
    s_cmp_lg_u64 s[78:79], s[28:29]
    s_cbranch_scc1 FQ0_retry
    s_branch FQ0_back
FQ1_retry:
    s_add_u32 s44, s44, 1
    s_cmp_gt_u32 s44, 200000
    s_cbranch_scc1 FQ1_back
    s_load_dwordx8 s[64:71], s[34:35], 0 glc
    s_waitcnt lgkmcnt(0)
    s_cmp_lg_u64 s[64:65], s[28:29]
    s_cbranch_scc1 FQ1_retry
    s_cmp_lg_u64 s[66:67], s[28:29]
    s_cbranch_scc1 FQ1_retry
    s_cmp_lg_u64 s[68:69], s[28:29]
    s_cbranch_scc1 FQ1_retry
    s_cmp_lg_u64 s[70:71], s[28:29]
    s_cbranch_scc1 FQ1_retry
    s_branch FQ1_back
XQ_retry:
    s_add_u32 s44, s44, 1
    s_cmp_gt_u32 s44, 200000
    s_cbranch_scc1 XQ_back
    s_load_dwordx16 s[64:79], s[46:47], 0 glc
    s_waitcnt lgkmcnt(0)
    s_cmp_lg_u64 s[64:65], s[100:101]
    s_cbranch_scc1 XQ_retry
    s_cmp_lg_u64 s[66:67], s[100:101]
    s_cbranch_scc1 XQ_retry
    s_cmp_lg_u64 s[68:69], s[100:101]
    s_cbranch_scc1 XQ_retry
    s_cmp_lg_u64 s[70:71], s[100:101]
    s_cbranch_scc1 XQ_retry
    s_cmp_lg_u64 s[72:73], s[100:101]
    s_cbranch_scc1 XQ_retry
    s_cmp_lg_u64 s[74:75], s[100:101]
    s_cbranch_scc1 XQ_retry
    s_cmp_lg_u64 s[76:77], s[100:101]
    s_cbranch_scc1 XQ_retry
    s_cmp_lg_u64 s[78:79], s[100:101]
    s_cbranch_scc1 XQ_retry
    s_branch XQ_back
PFQ_retry:
    s_add_u32 s44, s44, 1
    s_cmp_gt_u32 s44, 200000
    s_cbranch_scc1 PFQ_back
    s_and_b32 s6, s2, 7
    s_lshl_b32 s6, s6, 10
    s_add_u32 s6, s6, 0x11f0000
    buffer_load_dwordx4 v[248:251], v2, s[8:11], s6 offen sc1
    s_waitcnt vmcnt(0)
    v_xor_b32 v248, s43, v248
    v_xor_b32 v249, s43, v249
    v_xor_b32 v250, s43, v250
    v_xor_b32 v251, s43, v251
    v_or3_b32 v248, v248, v249, v250
    v_or_b32 v248, v248, v251
    v_cmp_ne_u32 vcc, 0, v248
    s_cbranch_vccnz PFQ_retry
    s_branch PFQ_back
K1_done:
    s_endpgm
CODE_END:
    s_endpgm
.section .rodata,"a"
.p2align 6
.amdhsa_kernel recurrent_scan__ssm_conv_s5__glu_gated_swiglu__prompt_kernel
  .amdhsa_next_free_vgpr 512
  .amdhsa_next_free_sgpr 102
  .amdhsa_accum_offset 256
  .amdhsa_group_segment_fixed_size 0
  .amdhsa_kernarg_size 128
  .amdhsa_user_sgpr_count 2
  .amdhsa_user_sgpr_kernarg_segment_ptr 1
  .amdhsa_system_sgpr_workgroup_id_x 1
.end_amdhsa_kernel
.text
```
